```python
import torch

def _softmax(x, axis=-1):
    return torch.softmax(x, dim=axis)

def _gelu(x):
    return torch.nn.functional.gelu(x, approximate='tanh')

def _silu(x):
    return torch.nn.functional.silu(x)

def _sigmoid(x):
    return torch.sigmoid(x)

def _layernorm(x, axis=-1, eps=1e-05):
    m = x.mean(dim=axis, keepdim=True)
    v = x.var(dim=axis, keepdim=True, unbiased=False)
    return (x - m) / torch.sqrt(v + eps)

def _scatter_add(tgt, idx, src, axis=0):
    return tgt.clone().index_add_(axis, idx, src)

def _segment_sum(src, seg, n):
    out = torch.zeros((n,) + src.shape[1:], dtype=src.dtype)
    return out.index_add_(0, seg, src)

def _pad(x, pw):
    flat = tuple((v for pair in reversed(pw) for v in pair))
    return torch.nn.functional.pad(x, flat)
kernel_name = 'adaLN_cond__softmax_full_mha__mixer_gmlp__prompt'

def setup_inputs():

    _w = lambda a: (lambda t: t.to(torch.bfloat16) if t.is_floating_point() else t)(torch.as_tensor(a))

    def _A_setup():
        B, S, D = (1, 2048, 1024)
        return {'x': _w((lambda *s: torch.randn(*s, dtype=torch.bfloat16) * 0.05)(B, S, D)), 'wqkv': _w((lambda *s: torch.randn(*s, dtype=torch.bfloat16) * 0.05)(D, 3 * D)), 'wo': _w((lambda *s: torch.randn(*s, dtype=torch.bfloat16) * 0.05)(D, D))}
    _A_in = _A_setup()

    def _B_setup():
        B, S, D, F = (1, 2048, 1024, 3584)
        Fh = F // 2
        return {'x': _w((lambda *s: torch.randn(*s, dtype=torch.bfloat16) * 0.05)(B, S, D)), 'w_in': _w((lambda *s: torch.randn(*s, dtype=torch.bfloat16) * 0.8)(D, 2 * Fh)), 'w_sp': _w(0.01 * (lambda *s: torch.randn(*s, dtype=torch.bfloat16) * 0.8)(S, S)), 'b_sp': _w(1.0 + 0.01 * (lambda *s: torch.randn(*s, dtype=torch.bfloat16) * 0.05)(S)), 'w_out': _w((lambda *s: torch.randn(*s, dtype=torch.bfloat16) * 0.05)(Fh, D))}
    _B_in = _B_setup()
    return {'A_x': _A_in['x'], 'A_wqkv': _A_in['wqkv'], 'A_wo': _A_in['wo'], 'B_x': _B_in['x'], 'B_w_in': _B_in['w_in'], 'B_w_sp': _B_in['w_sp'], 'B_b_sp': _B_in['b_sp'], 'B_w_out': _B_in['w_out'], 'c': _w((lambda *s: torch.randn(*s, dtype=torch.bfloat16) * 0.2)(1, 1024) * 8.0), 'w_mod': _w((lambda *s: torch.randn(*s, dtype=torch.bfloat16) * 0.2)(1024, 6 * 1024) * 1024 ** (-0.5) * 8.0)}

def reference(A_x, A_wqkv, A_wo, B_x, B_w_in, B_w_sp, B_b_sp, B_w_out, c, w_mod):

    def _A_ref(x, wqkv, wo):
        B, S, D = x.shape
        H = 32
        Dh = D // H
        qkv = (lambda x, *d: x.permute(*d))((x @ wqkv).reshape(B, S, 3, H, Dh), 2, 0, 3, 1, 4)
        q, k, v = (qkv[0], qkv[1], qkv[2])
        scale = Dh ** (-0.5)
        scores = torch.einsum('bhqd,bhkd->bhqk', q, k) * scale
        p = _softmax(scores, axis=-1)
        o = torch.einsum('bhqk,bhkd->bhqd', p, v)
        return (lambda x, *d: x.permute(*d))(o, 0, 2, 1, 3).reshape(B, S, D) @ wo

    def _B_ref(x, w_in, w_sp, b_sp, w_out):
        B, S, D = x.shape
        F = w_in.shape[-1]
        Fh = F // 2
        z = _gelu(torch.einsum('bsd,df->bsf', x, w_in))
        z1 = z[..., :Fh].clone()
        z2 = _layernorm(z[..., Fh:], axis=-1)
        g = torch.einsum('ts,bsf->btf', w_sp, z2) + b_sp[None, :, None]
        return torch.einsum('bsf,fd->bsd', z1 * g, w_out)
    x = A_x
    mod = (_silu(c) @ w_mod).reshape(c.shape[0], 6, 1, -1)
    sa, ca, ga, sb, cb, gb = (mod[:, 0].clone(), mod[:, 1].clone(), mod[:, 2].clone(), mod[:, 3].clone(), mod[:, 4].clone(), mod[:, 5].clone())
    h = _layernorm(x, axis=-1) * (1 + ca) + sa
    x = x + ga * _A_ref(h, A_wqkv, A_wo)
    h = _layernorm(x, axis=-1) * (1 + cb) + sb
    x = x + gb * _B_ref(h, B_w_in, B_w_sp, B_b_sp, B_w_out)
    return x
```

```asm
; @launch kernel=k1_kernel grid=(385,1,1) block=(256,1,1) lds=45056
; @launch kernel=mm_kernel grid=(256,1,1) block=(512,1,1) lds=163776
.amdgcn_target "amdgcn-amd-amdhsa--gfx950"
.text
.globl k1_kernel
.p2align 8
.type k1_kernel,@function
k1_kernel:
    s_cmp_ge_u32 s2, 385
    s_cbranch_scc1 L_k1_kernel_end_1
    s_load_dwordx4 s[56:59], s[0:1], 0
    s_load_dwordx4 s[8:11], s[0:1], 64
    s_load_dwordx4 s[4:7], s[0:1], 88
    s_cmp_ge_u32 s2, 129
    s_cbranch_scc1 L_k1_kernel_ln_2
    s_cmp_lt_u32 s2, 1
    s_cbranch_scc1 L_k1_kernel_rp_3
    s_sub_u32 s13, s2, 1
    s_lshr_b32 s12, s13, 2
    s_and_b32 s13, s13, 3
    v_lshrrev_b32 v2, 6, v0
    v_and_b32 v1, 63, v0
    v_readfirstlane_b32 s3, v2
    v_lshrrev_b32 v8, 3, v1
    v_and_b32 v15, 7, v1
    s_lshl_b32 s14, s13, 2
    s_add_u32 s14, s14, s3
    s_mov_b32 s15, 12288
    v_mul_lo_u32 v4, v8, s15
    v_lshl_add_u32 v4, v15, 4, v4
    s_mul_i32 s32, s14, 786432
    s_lshl_b32 s15, s12, 7
    s_add_u32 s32, s32, s15
    s_add_u32 s33, s32, 98304
    s_add_u32 s34, s32, 196608
    s_add_u32 s35, s32, 294912
    s_add_u32 s36, s32, 393216
    s_add_u32 s37, s32, 491520
    s_add_u32 s38, s32, 589824
    s_add_u32 s39, s32, 688128
    s_lshl_b32 s14, s14, 7
    v_lshlrev_b32 v5, 1, v1
    s_lshl_b32 s15, s3, 8
    v_lshl_add_u32 v6, v1, 2, s15
    v_lshl_add_u32 v7, v8, 2, s15
    s_waitcnt lgkmcnt(0)
    s_mov_b32 s20, s8
    s_mov_b32 s21, s9
    s_mov_b32 s22, 2048
    s_mov_b32 s23, 0x20000
    s_mov_b32 s24, s10
    s_mov_b32 s25, s11
    s_mov_b32 s26, 12582912
    s_mov_b32 s27, 0x20000
    buffer_load_ushort v12, v5, s[20:23], s14 offen
    buffer_load_dwordx4 v[16:19], v4, s[24:27], s32 offen
    buffer_load_dwordx4 v[20:23], v4, s[24:27], s33 offen
    buffer_load_dwordx4 v[24:27], v4, s[24:27], s34 offen
    buffer_load_dwordx4 v[28:31], v4, s[24:27], s35 offen
    buffer_load_dwordx4 v[32:35], v4, s[24:27], s36 offen
    buffer_load_dwordx4 v[36:39], v4, s[24:27], s37 offen
    buffer_load_dwordx4 v[40:43], v4, s[24:27], s38 offen
    buffer_load_dwordx4 v[44:47], v4, s[24:27], s39 offen
    s_add_u32 s28, s6, 0
    s_addc_u32 s29, s7, 0
    s_mov_b32 s30, 98304
    s_mov_b32 s31, 0x20000
    s_mov_b32 s48, s4
    s_mov_b32 s49, s5
    s_mov_b32 s50, 256
    s_mov_b32 s51, 0x20000
    s_add_u32 s52, s6, 135168
    s_addc_u32 s53, s7, 0
    s_mov_b32 s54, 2048
    s_mov_b32 s55, 0x20000
    s_waitcnt vmcnt(8)
    v_lshlrev_b32 v12, 16, v12
    v_mul_f32 v13, 0xbfb8aa3b, v12
    v_exp_f32 v13, v13
    s_nop 0
    v_add_f32 v13, 1.0, v13
    v_rcp_f32 v13, v13
    s_nop 0
    v_mul_f32 v12, v12, v13
    v_cvt_pk_bf16_f32 v14, v12, v12
    v_lshlrev_b32 v12, 16, v14
    ds_write_b32 v6, v12
    ds_read_b32 v48, v7 offset:0
    ds_read_b32 v49, v7 offset:32
    ds_read_b32 v50, v7 offset:64
    ds_read_b32 v51, v7 offset:96
    ds_read_b32 v52, v7 offset:128
    ds_read_b32 v53, v7 offset:160
    ds_read_b32 v54, v7 offset:192
    ds_read_b32 v55, v7 offset:224
    v_mov_b32 v56, 0
    v_mov_b32 v57, 0
    v_mov_b32 v58, 0
    v_mov_b32 v59, 0
    v_mov_b32 v60, 0
    v_mov_b32 v61, 0
    v_mov_b32 v62, 0
    v_mov_b32 v63, 0
    v_mov_b32 v2, 0
    s_cmp_eq_u32 s3, 0
    s_cselect_b32 s17, 0, 0x7f000000
    s_waitcnt lgkmcnt(0)
    s_waitcnt vmcnt(7)
    v_lshlrev_b32 v64, 16, v16
    v_and_b32 v65, 0xffff0000, v16
    v_fmac_f32 v56, v64, v48
    v_fmac_f32 v57, v65, v48
    v_lshlrev_b32 v66, 16, v17
    v_and_b32 v67, 0xffff0000, v17
    v_fmac_f32 v58, v66, v48
    v_fmac_f32 v59, v67, v48
    v_lshlrev_b32 v64, 16, v18
    v_and_b32 v65, 0xffff0000, v18
    v_fmac_f32 v60, v64, v48
    v_fmac_f32 v61, v65, v48
    v_lshlrev_b32 v66, 16, v19
    v_and_b32 v67, 0xffff0000, v19
    v_fmac_f32 v62, v66, v48
    v_fmac_f32 v63, v67, v48
    s_waitcnt vmcnt(6)
    v_lshlrev_b32 v64, 16, v20
    v_and_b32 v65, 0xffff0000, v20
    v_fmac_f32 v56, v64, v49
    v_fmac_f32 v57, v65, v49
    v_lshlrev_b32 v66, 16, v21
    v_and_b32 v67, 0xffff0000, v21
    v_fmac_f32 v58, v66, v49
    v_fmac_f32 v59, v67, v49
    v_lshlrev_b32 v64, 16, v22
    v_and_b32 v65, 0xffff0000, v22
    v_fmac_f32 v60, v64, v49
    v_fmac_f32 v61, v65, v49
    v_lshlrev_b32 v66, 16, v23
    v_and_b32 v67, 0xffff0000, v23
    v_fmac_f32 v62, v66, v49
    v_fmac_f32 v63, v67, v49
    s_waitcnt vmcnt(5)
    v_lshlrev_b32 v64, 16, v24
    v_and_b32 v65, 0xffff0000, v24
    v_fmac_f32 v56, v64, v50
    v_fmac_f32 v57, v65, v50
    v_lshlrev_b32 v66, 16, v25
    v_and_b32 v67, 0xffff0000, v25
    v_fmac_f32 v58, v66, v50
    v_fmac_f32 v59, v67, v50
    v_lshlrev_b32 v64, 16, v26
    v_and_b32 v65, 0xffff0000, v26
    v_fmac_f32 v60, v64, v50
    v_fmac_f32 v61, v65, v50
    v_lshlrev_b32 v66, 16, v27
    v_and_b32 v67, 0xffff0000, v27
    v_fmac_f32 v62, v66, v50
    v_fmac_f32 v63, v67, v50
    s_waitcnt vmcnt(4)
    v_lshlrev_b32 v64, 16, v28
    v_and_b32 v65, 0xffff0000, v28
    v_fmac_f32 v56, v64, v51
    v_fmac_f32 v57, v65, v51
    v_lshlrev_b32 v66, 16, v29
    v_and_b32 v67, 0xffff0000, v29
    v_fmac_f32 v58, v66, v51
    v_fmac_f32 v59, v67, v51
    v_lshlrev_b32 v64, 16, v30
    v_and_b32 v65, 0xffff0000, v30
    v_fmac_f32 v60, v64, v51
    v_fmac_f32 v61, v65, v51
    v_lshlrev_b32 v66, 16, v31
    v_and_b32 v67, 0xffff0000, v31
    v_fmac_f32 v62, v66, v51
    v_fmac_f32 v63, v67, v51
    s_waitcnt vmcnt(3)
    buffer_load_dword v3, v2, s[48:51], s17 offen sc1
    v_lshlrev_b32 v64, 16, v32
    v_and_b32 v65, 0xffff0000, v32
    v_fmac_f32 v56, v64, v52
    v_fmac_f32 v57, v65, v52
    v_lshlrev_b32 v66, 16, v33
    v_and_b32 v67, 0xffff0000, v33
    v_fmac_f32 v58, v66, v52
    v_fmac_f32 v59, v67, v52
    v_lshlrev_b32 v64, 16, v34
    v_and_b32 v65, 0xffff0000, v34
    v_fmac_f32 v60, v64, v52
    v_fmac_f32 v61, v65, v52
    v_lshlrev_b32 v66, 16, v35
    v_and_b32 v67, 0xffff0000, v35
    v_fmac_f32 v62, v66, v52
    v_fmac_f32 v63, v67, v52
    s_waitcnt vmcnt(3)
    v_lshlrev_b32 v64, 16, v36
    v_and_b32 v65, 0xffff0000, v36
    v_fmac_f32 v56, v64, v53
    v_fmac_f32 v57, v65, v53
    v_lshlrev_b32 v66, 16, v37
    v_and_b32 v67, 0xffff0000, v37
    v_fmac_f32 v58, v66, v53
    v_fmac_f32 v59, v67, v53
    v_lshlrev_b32 v64, 16, v38
    v_and_b32 v65, 0xffff0000, v38
    v_fmac_f32 v60, v64, v53
    v_fmac_f32 v61, v65, v53
    v_lshlrev_b32 v66, 16, v39
    v_and_b32 v67, 0xffff0000, v39
    v_fmac_f32 v62, v66, v53
    v_fmac_f32 v63, v67, v53
    s_waitcnt vmcnt(2)
    v_lshlrev_b32 v64, 16, v40
    v_and_b32 v65, 0xffff0000, v40
    v_fmac_f32 v56, v64, v54
    v_fmac_f32 v57, v65, v54
    v_lshlrev_b32 v66, 16, v41
    v_and_b32 v67, 0xffff0000, v41
    v_fmac_f32 v58, v66, v54
    v_fmac_f32 v59, v67, v54
    v_lshlrev_b32 v64, 16, v42
    v_and_b32 v65, 0xffff0000, v42
    v_fmac_f32 v60, v64, v54
    v_fmac_f32 v61, v65, v54
    v_lshlrev_b32 v66, 16, v43
    v_and_b32 v67, 0xffff0000, v43
    v_fmac_f32 v62, v66, v54
    v_fmac_f32 v63, v67, v54
    s_waitcnt vmcnt(1)
    v_lshlrev_b32 v64, 16, v44
    v_and_b32 v65, 0xffff0000, v44
    v_fmac_f32 v56, v64, v55
    v_fmac_f32 v57, v65, v55
    v_lshlrev_b32 v66, 16, v45
    v_and_b32 v67, 0xffff0000, v45
    v_fmac_f32 v58, v66, v55
    v_fmac_f32 v59, v67, v55
    v_lshlrev_b32 v64, 16, v46
    v_and_b32 v65, 0xffff0000, v46
    v_fmac_f32 v60, v64, v55
    v_fmac_f32 v61, v65, v55
    v_lshlrev_b32 v66, 16, v47
    v_and_b32 v67, 0xffff0000, v47
    v_fmac_f32 v62, v66, v55
    v_fmac_f32 v63, v67, v55
    v_permlane32_swap_b32 v56, v60
    v_permlane32_swap_b32 v57, v61
    v_permlane32_swap_b32 v58, v62
    v_permlane32_swap_b32 v59, v63
    v_add_f32 v56, v56, v60
    v_add_f32 v57, v57, v61
    v_add_f32 v58, v58, v62
    v_add_f32 v59, v59, v63
    s_nop 0
    v_permlane16_swap_b32 v56, v58
    s_nop 0
    v_permlane16_swap_b32 v57, v59
    v_add_f32 v56, v56, v58
    v_add_f32 v57, v57, v59
    s_nop 0
    v_add_f32_dpp v56, v56, v56 row_ror:8 row_mask:0xf bank_mask:0xf
    s_nop 0
    v_add_f32_dpp v57, v57, v57 row_ror:8 row_mask:0xf bank_mask:0xf
    v_lshlrev_b32 v10, 5, v15
    v_lshrrev_b32 v9, 4, v1
    v_lshl_add_u32 v10, v9, 3, v10
    v_add_u32 v10, s15, v10
    ds_write_b64 v10, v[56:57] offset:1024
    v_lshlrev_b32 v13, 2, v1
    s_mul_i32 s33, s13, 24576
    s_lshl_b32 s16, s12, 8
    s_add_u32 s33, s33, s16
    s_waitcnt lgkmcnt(0)
    s_barrier
    s_cmp_lg_u32 s3, 0
    s_cbranch_scc1 L_k1_kernel_notw0_4
    ds_read_b32 v48, v13 offset:1024
    ds_read_b32 v49, v13 offset:1280
    ds_read_b32 v50, v13 offset:1536
    ds_read_b32 v51, v13 offset:1792
    s_waitcnt lgkmcnt(0)
    v_add_f32 v48, v48, v49
    v_add_f32 v50, v50, v51
    v_add_f32 v48, v48, v50
    s_getreg_b32 s18, hwreg(HW_REG_IB_STS, 0, 4)
    buffer_store_dword v48, v13, s[28:31], s33 offen sc1
    s_waitcnt vmcnt(1)
    s_cmp_lg_u32 s18, 0
    s_cbranch_scc1 L_k1_kernel_repair_5
    v_cmp_eq_u32 vcc, 0, v3
    s_cbranch_vccz L_k1_kernel_notw0_4
L_k1_kernel_repair_5:
    s_mov_b32 s16, 0
    s_branch L_k1_kernel_chk_8
L_k1_kernel_wait_6:
    buffer_load_dword v3, v2, s[48:51], 0 offen sc1
L_k1_kernel_chk_8:
    s_waitcnt vmcnt(0)
    v_cmp_eq_u32 vcc, 0, v3
    s_cbranch_vccz L_k1_kernel_go_7
    s_sleep 4
    s_add_u32 s16, s16, 1
    s_cmp_lt_u32 s16, 0x100000
    s_cbranch_scc1 L_k1_kernel_wait_6
L_k1_kernel_go_7:
    buffer_store_dword v48, v13, s[28:31], s33 offen sc1
L_k1_kernel_notw0_4:
    buffer_store_short v14, v5, s[52:55], s14 offen
    s_endpgm
L_k1_kernel_rp_3:
    v_lshlrev_b32 v1, 4, v0
    v_mov_b32 v4, -1
    v_mov_b32 v5, -1
    v_mov_b32 v6, -1
    v_mov_b32 v7, -1
    v_mov_b32 v2, 0
    s_waitcnt lgkmcnt(0)
    s_add_u32 s28, s6, 0
    s_addc_u32 s29, s7, 0
    s_mov_b32 s30, 98304
    s_mov_b32 s31, 0x20000
    s_mov_b32 s48, s4
    s_mov_b32 s49, s5
    s_mov_b32 s50, 256
    s_mov_b32 s51, 0x20000
    s_mov_b32 s12, 0
    buffer_store_dwordx4 v[4:7], v1, s[28:31], s12 offen sc1
    s_mov_b32 s12, 4096
    buffer_store_dwordx4 v[4:7], v1, s[28:31], s12 offen sc1
    s_mov_b32 s12, 24576
    buffer_store_dwordx4 v[4:7], v1, s[28:31], s12 offen sc1
    s_mov_b32 s12, 28672
    buffer_store_dwordx4 v[4:7], v1, s[28:31], s12 offen sc1
    s_mov_b32 s12, 49152
    buffer_store_dwordx4 v[4:7], v1, s[28:31], s12 offen sc1
    s_mov_b32 s12, 53248
    buffer_store_dwordx4 v[4:7], v1, s[28:31], s12 offen sc1
    s_mov_b32 s12, 73728
    buffer_store_dwordx4 v[4:7], v1, s[28:31], s12 offen sc1
    s_mov_b32 s12, 77824
    buffer_store_dwordx4 v[4:7], v1, s[28:31], s12 offen sc1
    s_waitcnt vmcnt(0)
    s_barrier
    v_cmp_eq_u32 vcc, 0, v0
    s_nop 0
    s_and_saveexec_b64 s[60:61], vcc
    s_cbranch_execz L_k1_kernel_end_1
    buffer_store_dword v4, v2, s[48:51], 0 offen sc1
    s_endpgm
L_k1_kernel_ln_2:
    s_sub_u32 s12, s2, 129
    v_bfe_u32 v1, v0, 3, 3
    v_and_b32 v2, 7, v0
    v_lshrrev_b32 v5, 6, v0
    v_lshlrev_b32 v3, 11, v1
    v_lshl_add_u32 v3, v2, 4, v3
    v_lshl_add_u32 v3, v5, 9, v3
    s_lshl_b32 s13, s12, 14
    v_lshrrev_b32 v6, 2, v2
    v_lshlrev_b32 v6, 14, v6
    v_lshl_add_u32 v6, v5, 17, v6
    v_and_b32 v7, 3, v2
    v_lshl_add_u32 v6, v7, 8, v6
    v_lshl_add_u32 v64, v1, 4, v6
    v_lshlrev_b32 v65, 6, v2
    v_lshl_add_u32 v65, v5, 11, v65
    s_and_b32 s16, s12, 1
    s_lshl_b32 s16, s16, 7
    s_lshr_b32 s18, s12, 5
    s_lshl_b32 s18, s18, 19
    s_bfe_u32 s17, s12, 0x40001
    s_lshl_b32 s17, s17, 10
    s_add_u32 s18, s18, s17
    s_add_u32 s18, s18, s16
    s_add_u32 s36, s18, 0
    s_add_u32 s37, s18, 32768
    s_add_u32 s38, s18, 65536
    s_add_u32 s39, s18, 98304
    s_waitcnt lgkmcnt(0)
    s_mov_b32 s20, s56
    s_mov_b32 s21, s57
    s_mov_b32 s22, 4194304
    s_mov_b32 s23, 0x20000
    buffer_load_dwordx4 v[16:19], v3, s[20:23], s13 offen offset:0
    buffer_load_dwordx4 v[20:23], v3, s[20:23], s13 offen offset:128
    buffer_load_dwordx4 v[24:27], v3, s[20:23], s13 offen offset:256
    buffer_load_dwordx4 v[28:31], v3, s[20:23], s13 offen offset:384
    s_add_u32 s24, s6, 22020096
    s_addc_u32 s25, s7, 0
    s_mov_b32 s26, 4194304
    s_mov_b32 s27, 0x20000
    s_add_u32 s28, s6, 57147392
    s_addc_u32 s29, s7, 0
    s_mov_b32 s30, 327680
    s_mov_b32 s31, 0x20000
    s_mov_b32 s48, s4
    s_mov_b32 s49, s5
    s_mov_b32 s50, 256
    s_mov_b32 s51, 0x20000
    s_add_u32 s44, s6, 0
    s_addc_u32 s45, s7, 0
    s_mov_b32 s46, 98304
    s_mov_b32 s47, 0x20000
    v_mov_b32 v8, -1.0
    v_min_u32 v4, 159, v0
    v_lshlrev_b32 v4, 2, v4
    s_mul_i32 s14, s12, 640
    s_add_u32 s14, s14, 98304
    buffer_store_dword v8, v4, s[28:31], s14 offen
    s_add_u32 s52, s6, 57409536
    s_addc_u32 s53, s7, 0
    s_mov_b32 s54, 1024
    s_mov_b32 s55, 0x20000
    v_mov_b32 v4, 0
    s_lshl_b32 s14, s12, 2
    buffer_store_dword v8, v4, s[52:55], s14 offen
    v_lshlrev_b32 v4, 4, v0
    v_readfirstlane_b32 s3, v5
    v_and_b32 v100, 63, v0
    s_mov_b32 s40, s58
    s_mov_b32 s41, s59
    s_mov_b32 s42, 6291456
    s_mov_b32 s43, 0x20000
    v_lshrrev_b32 v2, 3, v100
    s_mov_b32 s16, 6144
    v_mul_lo_u32 v101, v2, s16
    v_and_b32 v2, 7, v100
    v_lshl_add_u32 v101, v2, 4, v101
    s_lshl_b32 s19, s3, 13
    s_add_u32 s19, s19, 12288
    s_mul_i32 s14, s12, 6
    s_add_u32 s14, s14, s3
    s_add_u32 s14, s14, 0
    s_mul_i32 s68, s14, 10923
    s_lshr_b32 s68, s68, 19
    s_mul_i32 s15, s68, 48
    s_sub_u32 s69, s14, s15
    s_mul_i32 s15, s68, 196608
    s_lshl_b32 s16, s69, 7
    s_add_u32 s15, s15, s16
    s_add_u32 m0, s19, 0
    s_add_u32 s16, s15, 0
    buffer_load_dwordx4 v101, s[40:43], s16 offen lds
    s_add_u32 m0, s19, 1024
    s_add_u32 s16, s15, 49152
    buffer_load_dwordx4 v101, s[40:43], s16 offen lds
    s_add_u32 m0, s19, 2048
    s_add_u32 s16, s15, 98304
    buffer_load_dwordx4 v101, s[40:43], s16 offen lds
    s_add_u32 m0, s19, 3072
    s_add_u32 s16, s15, 147456
    buffer_load_dwordx4 v101, s[40:43], s16 offen lds
    s_mul_i32 s14, s12, 6
    s_add_u32 s14, s14, s3
    s_add_u32 s14, s14, 4
    s_mul_i32 s70, s14, 10923
    s_lshr_b32 s70, s70, 19
    s_mul_i32 s15, s70, 48
    s_sub_u32 s71, s14, s15
    s_mul_i32 s15, s70, 196608
    s_lshl_b32 s16, s71, 7
    s_add_u32 s15, s15, s16
    s_cmp_ge_u32 s3, 2
    s_cselect_b32 s72, 0x7f000000, 0
    s_or_b32 s15, s15, s72
    s_add_u32 m0, s19, 4096
    s_add_u32 s16, s15, 0
    buffer_load_dwordx4 v101, s[40:43], s16 offen lds
    s_add_u32 m0, s19, 5120
    s_add_u32 s16, s15, 49152
    buffer_load_dwordx4 v101, s[40:43], s16 offen lds
    s_add_u32 m0, s19, 6144
    s_add_u32 s16, s15, 98304
    buffer_load_dwordx4 v101, s[40:43], s16 offen lds
    s_add_u32 m0, s19, 7168
    s_add_u32 s16, s15, 147456
    buffer_load_dwordx4 v101, s[40:43], s16 offen lds
    v_mov_b32 v10, 0
    v_mov_b32 v11, 0
    v_mov_b32 v12, 0
    v_mov_b32 v13, 0
    s_waitcnt vmcnt(13)
    v_lshlrev_b32 v32, 16, v16
    v_and_b32 v33, 0xffff0000, v16
    v_pk_add_f32 v[10:11], v[10:11], v[32:33]
    v_pk_fma_f32 v[12:13], v[32:33], v[32:33], v[12:13]
    v_lshlrev_b32 v34, 16, v17
    v_and_b32 v35, 0xffff0000, v17
    v_pk_add_f32 v[10:11], v[10:11], v[34:35]
    v_pk_fma_f32 v[12:13], v[34:35], v[34:35], v[12:13]
    v_lshlrev_b32 v36, 16, v18
    v_and_b32 v37, 0xffff0000, v18
    v_pk_add_f32 v[10:11], v[10:11], v[36:37]
    v_pk_fma_f32 v[12:13], v[36:37], v[36:37], v[12:13]
    v_lshlrev_b32 v38, 16, v19
    v_and_b32 v39, 0xffff0000, v19
    v_pk_add_f32 v[10:11], v[10:11], v[38:39]
    v_pk_fma_f32 v[12:13], v[38:39], v[38:39], v[12:13]
    s_waitcnt vmcnt(12)
    v_lshlrev_b32 v40, 16, v20
    v_and_b32 v41, 0xffff0000, v20
    v_pk_add_f32 v[10:11], v[10:11], v[40:41]
    v_pk_fma_f32 v[12:13], v[40:41], v[40:41], v[12:13]
    v_lshlrev_b32 v42, 16, v21
    v_and_b32 v43, 0xffff0000, v21
    v_pk_add_f32 v[10:11], v[10:11], v[42:43]
    v_pk_fma_f32 v[12:13], v[42:43], v[42:43], v[12:13]
    v_lshlrev_b32 v44, 16, v22
    v_and_b32 v45, 0xffff0000, v22
    v_pk_add_f32 v[10:11], v[10:11], v[44:45]
    v_pk_fma_f32 v[12:13], v[44:45], v[44:45], v[12:13]
    v_lshlrev_b32 v46, 16, v23
    v_and_b32 v47, 0xffff0000, v23
    v_pk_add_f32 v[10:11], v[10:11], v[46:47]
    v_pk_fma_f32 v[12:13], v[46:47], v[46:47], v[12:13]
    s_waitcnt vmcnt(11)
    v_lshlrev_b32 v48, 16, v24
    v_and_b32 v49, 0xffff0000, v24
    v_pk_add_f32 v[10:11], v[10:11], v[48:49]
    v_pk_fma_f32 v[12:13], v[48:49], v[48:49], v[12:13]
    v_lshlrev_b32 v50, 16, v25
    v_and_b32 v51, 0xffff0000, v25
    v_pk_add_f32 v[10:11], v[10:11], v[50:51]
    v_pk_fma_f32 v[12:13], v[50:51], v[50:51], v[12:13]
    v_lshlrev_b32 v52, 16, v26
    v_and_b32 v53, 0xffff0000, v26
    v_pk_add_f32 v[10:11], v[10:11], v[52:53]
    v_pk_fma_f32 v[12:13], v[52:53], v[52:53], v[12:13]
    v_lshlrev_b32 v54, 16, v27
    v_and_b32 v55, 0xffff0000, v27
    v_pk_add_f32 v[10:11], v[10:11], v[54:55]
    v_pk_fma_f32 v[12:13], v[54:55], v[54:55], v[12:13]
    s_waitcnt vmcnt(10)
    v_lshlrev_b32 v56, 16, v28
    v_and_b32 v57, 0xffff0000, v28
    v_pk_add_f32 v[10:11], v[10:11], v[56:57]
    v_pk_fma_f32 v[12:13], v[56:57], v[56:57], v[12:13]
    v_lshlrev_b32 v58, 16, v29
    v_and_b32 v59, 0xffff0000, v29
    v_pk_add_f32 v[10:11], v[10:11], v[58:59]
    v_pk_fma_f32 v[12:13], v[58:59], v[58:59], v[12:13]
    v_lshlrev_b32 v60, 16, v30
    v_and_b32 v61, 0xffff0000, v30
    v_pk_add_f32 v[10:11], v[10:11], v[60:61]
    v_pk_fma_f32 v[12:13], v[60:61], v[60:61], v[12:13]
    v_lshlrev_b32 v62, 16, v31
    v_and_b32 v63, 0xffff0000, v31
    v_pk_add_f32 v[10:11], v[10:11], v[62:63]
    v_pk_fma_f32 v[12:13], v[62:63], v[62:63], v[12:13]
    v_add_f32 v10, v10, v11
    v_add_f32 v11, v12, v13
    s_nop 0
    v_add_f32_dpp v10, v10, v10 quad_perm:[1,0,3,2] row_mask:0xf bank_mask:0xf
    s_nop 0
    v_add_f32_dpp v11, v11, v11 quad_perm:[1,0,3,2] row_mask:0xf bank_mask:0xf
    s_nop 0
    v_add_f32_dpp v10, v10, v10 quad_perm:[2,3,0,1] row_mask:0xf bank_mask:0xf
    s_nop 0
    v_add_f32_dpp v11, v11, v11 quad_perm:[2,3,0,1] row_mask:0xf bank_mask:0xf
    s_nop 0
    v_add_f32_dpp v10, v10, v10 row_half_mirror row_mask:0xf bank_mask:0xf
    s_nop 0
    v_add_f32_dpp v11, v11, v11 row_half_mirror row_mask:0xf bank_mask:0xf
    v_lshlrev_b32 v7, 5, v1
    v_lshl_add_u32 v8, v5, 3, v7
    ds_write_b64 v8, v[10:11] offset:8192
    s_waitcnt lgkmcnt(0)
    s_getpc_b64 s[74:75]
L_k1_kernel_pc_9:
    s_add_u32 s74, s74, mm_kernel-L_k1_kernel_pc_9
    s_addc_u32 s75, s75, 0
    v_lshlrev_b32 v104, 7, v0
    v_min_u32 v104, L_mm_kernel_codeend-mm_kernel-4, v104
    v_mov_b32 v105, s75
    v_add_co_u32 v104, vcc, s74, v104
    s_nop 1
    v_addc_co_u32 v105, vcc, 0, v105, vcc
    global_load_dword v106, v[104:105], off
    s_cmp_lg_u32 s3, 3
    s_cbranch_scc1 L_k1_kernel_go_10
    v_mov_b32 v2, 0
    s_mov_b32 s16, 0
L_k1_kernel_wait_11:
    buffer_load_dword v3, v2, s[48:51], 0 offen sc1
L_k1_kernel_chk_13:
    s_waitcnt vmcnt(0)
    v_cmp_eq_u32 vcc, 0, v3
    s_cbranch_vccz L_k1_kernel_go_12
    s_sleep 4
    s_add_u32 s16, s16, 1
    s_cmp_lt_u32 s16, 0x100000
    s_cbranch_scc1 L_k1_kernel_wait_11
L_k1_kernel_go_12:
L_k1_kernel_go_10:
    s_waitcnt lgkmcnt(0)
    s_barrier
    s_mov_b32 s60, 4096
    s_mov_b32 s61, 28672
    s_mov_b32 s62, 53248
    s_mov_b32 s63, 77824
    s_mov_b32 s64, 0
    s_mov_b32 s65, 24576
    s_mov_b32 s66, 49152
    s_mov_b32 s67, 73728
    ds_read_b128 v[8:11], v7 offset:8192
    ds_read_b128 v[12:15], v7 offset:8208
    s_waitcnt lgkmcnt(0)
    v_pk_add_f32 v[8:9], v[8:9], v[10:11]
    v_pk_add_f32 v[12:13], v[12:13], v[14:15]
    v_pk_add_f32 v[8:9], v[8:9], v[12:13]
    v_mul_f32 v2, 0x3a800000, v8
    v_mul_f32 v3, v2, v2
    v_mul_f32 v9, 0x3a800000, v9
    v_sub_f32 v3, v9, v3
    v_max_f32 v3, 0, v3
    v_add_f32 v3, 0x3727c5ac, v3
    v_rsq_f32 v8, v3
    s_nop 0
    v_mul_f32 v9, v2, v8
    v_sub_f32 v9, 0, v9
    v_pk_fma_f32 v[32:33], v[32:33], v[8:9], v[8:9] op_sel:[0,0,1] op_sel_hi:[1,0,1]
    v_pk_fma_f32 v[34:35], v[34:35], v[8:9], v[8:9] op_sel:[0,0,1] op_sel_hi:[1,0,1]
    v_pk_fma_f32 v[36:37], v[36:37], v[8:9], v[8:9] op_sel:[0,0,1] op_sel_hi:[1,0,1]
    v_pk_fma_f32 v[38:39], v[38:39], v[8:9], v[8:9] op_sel:[0,0,1] op_sel_hi:[1,0,1]
    v_pk_fma_f32 v[40:41], v[40:41], v[8:9], v[8:9] op_sel:[0,0,1] op_sel_hi:[1,0,1]
    v_pk_fma_f32 v[42:43], v[42:43], v[8:9], v[8:9] op_sel:[0,0,1] op_sel_hi:[1,0,1]
    v_pk_fma_f32 v[44:45], v[44:45], v[8:9], v[8:9] op_sel:[0,0,1] op_sel_hi:[1,0,1]
    v_pk_fma_f32 v[46:47], v[46:47], v[8:9], v[8:9] op_sel:[0,0,1] op_sel_hi:[1,0,1]
    v_pk_fma_f32 v[48:49], v[48:49], v[8:9], v[8:9] op_sel:[0,0,1] op_sel_hi:[1,0,1]
    v_pk_fma_f32 v[50:51], v[50:51], v[8:9], v[8:9] op_sel:[0,0,1] op_sel_hi:[1,0,1]
    v_pk_fma_f32 v[52:53], v[52:53], v[8:9], v[8:9] op_sel:[0,0,1] op_sel_hi:[1,0,1]
    v_pk_fma_f32 v[54:55], v[54:55], v[8:9], v[8:9] op_sel:[0,0,1] op_sel_hi:[1,0,1]
    v_pk_fma_f32 v[56:57], v[56:57], v[8:9], v[8:9] op_sel:[0,0,1] op_sel_hi:[1,0,1]
    v_pk_fma_f32 v[58:59], v[58:59], v[8:9], v[8:9] op_sel:[0,0,1] op_sel_hi:[1,0,1]
    v_pk_fma_f32 v[60:61], v[60:61], v[8:9], v[8:9] op_sel:[0,0,1] op_sel_hi:[1,0,1]
    v_pk_fma_f32 v[62:63], v[62:63], v[8:9], v[8:9] op_sel:[0,0,1] op_sel_hi:[1,0,1]
    s_add_u32 s40, s6, 26214400
    s_addc_u32 s41, s7, 0
    s_mov_b32 s42, 6291456
    s_mov_b32 s43, 0x20000
    v_bfe_u32 v2, v100, 2, 2
    v_and_b32 v3, 3, v100
    v_lshlrev_b32 v101, 3, v3
    v_lshl_add_u32 v101, v2, 7, v101
    v_lshrrev_b32 v2, 4, v100
    v_lshl_add_u32 v101, v2, 10, v101
    v_add_u32 v101, s19, v101
    v_lshlrev_b32 v100, 4, v100
    s_and_b32 s15, s69, 15
    s_mul_i32 s15, s15, 393216
    s_mul_i32 s16, s68, 6144
    s_add_u32 s15, s15, s16
    s_lshr_b32 s16, s69, 4
    s_lshl_b32 s16, s16, 11
    s_add_u32 s15, s15, s16
    s_add_u32 s16, s15, 196608
    s_waitcnt vmcnt(0)
    ds_read_b64_tr_b16 v[108:109], v101 offset:0
    ds_read_b64_tr_b16 v[110:111], v101 offset:512
    ds_read_b64_tr_b16 v[112:113], v101 offset:32
    ds_read_b64_tr_b16 v[114:115], v101 offset:544
    ds_read_b64_tr_b16 v[116:117], v101 offset:64
    ds_read_b64_tr_b16 v[118:119], v101 offset:576
    ds_read_b64_tr_b16 v[120:121], v101 offset:96
    ds_read_b64_tr_b16 v[122:123], v101 offset:608
    s_waitcnt lgkmcnt(6)
    buffer_store_dwordx4 v[108:111], v100, s[40:43], s15 offen offset:0 sc1
    s_waitcnt lgkmcnt(4)
    buffer_store_dwordx4 v[112:115], v100, s[40:43], s15 offen offset:1024 sc1
    s_waitcnt lgkmcnt(2)
    buffer_store_dwordx4 v[116:119], v100, s[40:43], s16 offen offset:0 sc1
    s_waitcnt lgkmcnt(0)
    buffer_store_dwordx4 v[120:123], v100, s[40:43], s16 offen offset:1024 sc1
    s_and_b32 s15, s71, 15
    s_mul_i32 s15, s15, 393216
    s_mul_i32 s16, s70, 6144
    s_add_u32 s15, s15, s16
    s_lshr_b32 s16, s71, 4
    s_lshl_b32 s16, s16, 11
    s_add_u32 s15, s15, s16
    s_or_b32 s15, s15, s72
    s_add_u32 s16, s15, 196608
    ds_read_b64_tr_b16 v[124:125], v101 offset:4096
    ds_read_b64_tr_b16 v[126:127], v101 offset:4608
    ds_read_b64_tr_b16 v[128:129], v101 offset:4128
    ds_read_b64_tr_b16 v[130:131], v101 offset:4640
    ds_read_b64_tr_b16 v[132:133], v101 offset:4160
    ds_read_b64_tr_b16 v[134:135], v101 offset:4672
    ds_read_b64_tr_b16 v[136:137], v101 offset:4192
    ds_read_b64_tr_b16 v[138:139], v101 offset:4704
    s_waitcnt lgkmcnt(6)
    buffer_store_dwordx4 v[124:127], v100, s[40:43], s15 offen offset:0 sc1
    s_waitcnt lgkmcnt(4)
    buffer_store_dwordx4 v[128:131], v100, s[40:43], s15 offen offset:1024 sc1
    s_waitcnt lgkmcnt(2)
    buffer_store_dwordx4 v[132:135], v100, s[40:43], s16 offen offset:0 sc1
    s_waitcnt lgkmcnt(0)
    buffer_store_dwordx4 v[136:139], v100, s[40:43], s16 offen offset:1024 sc1
    s_waitcnt vmcnt(0)
    buffer_load_dwordx4 v[68:71], v4, s[44:47], s60 offen sc1
    buffer_load_dwordx4 v[72:75], v4, s[44:47], s61 offen sc1
    buffer_load_dwordx4 v[76:79], v4, s[44:47], s62 offen sc1
    buffer_load_dwordx4 v[80:83], v4, s[44:47], s63 offen sc1
    buffer_load_dwordx4 v[84:87], v4, s[44:47], s64 offen sc1
    buffer_load_dwordx4 v[88:91], v4, s[44:47], s65 offen sc1
    buffer_load_dwordx4 v[92:95], v4, s[44:47], s66 offen sc1
    buffer_load_dwordx4 v[96:99], v4, s[44:47], s67 offen sc1
    v_lshrrev_b32 v2, 1, v0
    v_lshlrev_b32 v2, 6, v2
    v_and_b32 v3, 1, v0
    v_lshl_add_u32 v2, v3, 4, v2
    s_mov_b32 s16, 0
    s_waitcnt vmcnt(0)
L_k1_kernel_retry_14:
    v_max_u32 v3, v68, v69
    v_max3_u32 v3, v3, v70, v71
    v_max3_u32 v3, v3, v72, v73
    v_max3_u32 v3, v3, v74, v75
    v_max3_u32 v3, v3, v76, v77
    v_max3_u32 v3, v3, v78, v79
    v_max3_u32 v3, v3, v80, v81
    v_max3_u32 v3, v3, v82, v83
    v_max3_u32 v3, v3, v84, v85
    v_max3_u32 v3, v3, v86, v87
    v_max3_u32 v3, v3, v88, v89
    v_max3_u32 v3, v3, v90, v91
    v_max3_u32 v3, v3, v92, v93
    v_max3_u32 v3, v3, v94, v95
    v_max3_u32 v3, v3, v96, v97
    v_max3_u32 v3, v3, v98, v99
    v_cmp_eq_u32 vcc, -1, v3
    s_cbranch_vccz L_k1_kernel_ok_15
    s_sleep 4
    buffer_load_dwordx4 v[68:71], v4, s[44:47], s60 offen sc1
    buffer_load_dwordx4 v[72:75], v4, s[44:47], s61 offen sc1
    buffer_load_dwordx4 v[76:79], v4, s[44:47], s62 offen sc1
    buffer_load_dwordx4 v[80:83], v4, s[44:47], s63 offen sc1
    buffer_load_dwordx4 v[84:87], v4, s[44:47], s64 offen sc1
    buffer_load_dwordx4 v[88:91], v4, s[44:47], s65 offen sc1
    buffer_load_dwordx4 v[92:95], v4, s[44:47], s66 offen sc1
    buffer_load_dwordx4 v[96:99], v4, s[44:47], s67 offen sc1
    s_add_u32 s16, s16, 1
    s_cmp_lt_u32 s16, 0x100000
    s_waitcnt vmcnt(0)
    s_cbranch_scc1 L_k1_kernel_retry_14
L_k1_kernel_ok_15:
    v_pk_add_f32 v[68:69], v[68:69], v[72:73]
    v_pk_add_f32 v[70:71], v[70:71], v[74:75]
    v_pk_add_f32 v[76:77], v[76:77], v[80:81]
    v_pk_add_f32 v[78:79], v[78:79], v[82:83]
    v_pk_add_f32 v[68:69], v[68:69], v[76:77]
    v_pk_add_f32 v[70:71], v[70:71], v[78:79]
    v_cvt_pk_bf16_f32 v3, v68, v69
    v_lshlrev_b32 v68, 16, v3
    v_and_b32 v69, 0xffff0000, v3
    v_cvt_pk_bf16_f32 v3, v70, v71
    v_lshlrev_b32 v70, 16, v3
    v_and_b32 v71, 0xffff0000, v3
    v_pk_add_f32 v[84:85], v[84:85], v[88:89]
    v_pk_add_f32 v[86:87], v[86:87], v[90:91]
    v_pk_add_f32 v[92:93], v[92:93], v[96:97]
    v_pk_add_f32 v[94:95], v[94:95], v[98:99]
    v_pk_add_f32 v[84:85], v[84:85], v[92:93]
    v_pk_add_f32 v[86:87], v[86:87], v[94:95]
    v_cvt_pk_bf16_f32 v3, v84, v85
    v_lshlrev_b32 v84, 16, v3
    v_and_b32 v85, 0xffff0000, v3
    v_cvt_pk_bf16_f32 v3, v86, v87
    v_lshlrev_b32 v86, 16, v3
    v_and_b32 v87, 0xffff0000, v3
    v_add_f32 v68, 1.0, v68
    v_add_f32 v69, 1.0, v69
    v_add_f32 v70, 1.0, v70
    v_add_f32 v71, 1.0, v71
    v_cvt_pk_bf16_f32 v3, v68, v69
    v_lshlrev_b32 v68, 16, v3
    v_and_b32 v69, 0xffff0000, v3
    v_cvt_pk_bf16_f32 v3, v70, v71
    v_lshlrev_b32 v70, 16, v3
    v_and_b32 v71, 0xffff0000, v3
    ds_write_b128 v2, v[68:71]
    ds_write_b128 v2, v[84:87] offset:32
    s_waitcnt lgkmcnt(0)
    ds_read_b128 v[68:71], v65 offset:0
    ds_read_b128 v[72:75], v65 offset:16
    ds_read_b128 v[76:79], v65 offset:32
    ds_read_b128 v[80:83], v65 offset:48
    ds_read_b128 v[84:87], v65 offset:512
    ds_read_b128 v[88:91], v65 offset:528
    ds_read_b128 v[92:95], v65 offset:544
    ds_read_b128 v[96:99], v65 offset:560
    s_waitcnt lgkmcnt(4)
    v_pk_fma_f32 v[32:33], v[32:33], v[68:69], v[76:77]
    v_pk_fma_f32 v[34:35], v[34:35], v[70:71], v[78:79]
    v_pk_fma_f32 v[36:37], v[36:37], v[72:73], v[80:81]
    v_pk_fma_f32 v[38:39], v[38:39], v[74:75], v[82:83]
    ds_read_b128 v[68:71], v65 offset:1024
    ds_read_b128 v[72:75], v65 offset:1040
    ds_read_b128 v[76:79], v65 offset:1056
    ds_read_b128 v[80:83], v65 offset:1072
    v_cvt_pk_bf16_f32 v16, v32, v33
    v_cvt_pk_bf16_f32 v17, v34, v35
    v_cvt_pk_bf16_f32 v18, v36, v37
    v_cvt_pk_bf16_f32 v19, v38, v39
    buffer_store_dwordx4 v[16:19], v64, s[24:27], s36 offen
    s_waitcnt lgkmcnt(4)
    v_pk_fma_f32 v[40:41], v[40:41], v[84:85], v[92:93]
    v_pk_fma_f32 v[42:43], v[42:43], v[86:87], v[94:95]
    v_pk_fma_f32 v[44:45], v[44:45], v[88:89], v[96:97]
    v_pk_fma_f32 v[46:47], v[46:47], v[90:91], v[98:99]
    ds_read_b128 v[84:87], v65 offset:1536
    ds_read_b128 v[88:91], v65 offset:1552
    ds_read_b128 v[92:95], v65 offset:1568
    ds_read_b128 v[96:99], v65 offset:1584
    v_cvt_pk_bf16_f32 v20, v40, v41
    v_cvt_pk_bf16_f32 v21, v42, v43
    v_cvt_pk_bf16_f32 v22, v44, v45
    v_cvt_pk_bf16_f32 v23, v46, v47
    buffer_store_dwordx4 v[20:23], v64, s[24:27], s37 offen
    s_waitcnt lgkmcnt(4)
    v_pk_fma_f32 v[48:49], v[48:49], v[68:69], v[76:77]
    v_pk_fma_f32 v[50:51], v[50:51], v[70:71], v[78:79]
    v_pk_fma_f32 v[52:53], v[52:53], v[72:73], v[80:81]
    v_pk_fma_f32 v[54:55], v[54:55], v[74:75], v[82:83]
    v_cvt_pk_bf16_f32 v24, v48, v49
    v_cvt_pk_bf16_f32 v25, v50, v51
    v_cvt_pk_bf16_f32 v26, v52, v53
    v_cvt_pk_bf16_f32 v27, v54, v55
    buffer_store_dwordx4 v[24:27], v64, s[24:27], s38 offen
    s_waitcnt lgkmcnt(0)
    v_pk_fma_f32 v[56:57], v[56:57], v[84:85], v[92:93]
    v_pk_fma_f32 v[58:59], v[58:59], v[86:87], v[94:95]
    v_pk_fma_f32 v[60:61], v[60:61], v[88:89], v[96:97]
    v_pk_fma_f32 v[62:63], v[62:63], v[90:91], v[98:99]
    v_cvt_pk_bf16_f32 v28, v56, v57
    v_cvt_pk_bf16_f32 v29, v58, v59
    v_cvt_pk_bf16_f32 v30, v60, v61
    v_cvt_pk_bf16_f32 v31, v62, v63
    buffer_store_dwordx4 v[28:31], v64, s[24:27], s39 offen
L_k1_kernel_end_1:
    s_endpgm
L_k1_kernel_codeend:
.section .rodata,"a"
.p2align 6
.amdhsa_kernel k1_kernel
  .amdhsa_next_free_vgpr 140
  .amdhsa_next_free_sgpr 80
  .amdhsa_accum_offset 140
  .amdhsa_group_segment_fixed_size 0
  .amdhsa_kernarg_size 104
  .amdhsa_user_sgpr_count 2
  .amdhsa_user_sgpr_kernarg_segment_ptr 1
  .amdhsa_system_sgpr_workgroup_id_x 1
  .amdhsa_float_denorm_mode_32 3
  .amdhsa_float_denorm_mode_16_64 3
.end_amdhsa_kernel

.text
.globl mm_kernel
.p2align 8
.type mm_kernel,@function
mm_kernel:
    s_cmp_ge_u32 s2, 256
    s_cbranch_scc1 L_mm_kernel_end_1
    s_load_dwordx2 s[6:7], s[0:1], 96
    v_lshrrev_b32 v2, 6, v0
    v_and_b32 v1, 63, v0
    v_readfirstlane_b32 s19, v2
    s_and_b32 s48, s2, 7
    s_lshr_b32 s49, s2, 3
    s_and_b32 s50, s49, 3
    s_lshr_b32 s51, s49, 2
    s_and_b32 s52, s48, 1
    s_lshl_b32 s52, s52, 2
    s_add_u32 s20, s52, s50
    s_lshr_b32 s52, s48, 1
    s_mul_i32 s52, s52, 8
    s_add_u32 s21, s52, s51
    s_mov_b32 s3, s19
    s_cmp_lt_u32 s19, 4
    s_cbranch_scc1 L_mm_kernel_rest_2
    s_sub_u32 s3, s19, 4
    s_mul_i32 s50, s3, 3072
    v_lshl_add_u32 v8, v1, 4, s50
    s_mul_i32 s80, s21, 196608
    s_lshl_b32 s81, s20, 19
    s_mov_b32 s82, 0
    s_lshl_b32 s50, s3, 13
    v_lshl_add_u32 v5, v1, 4, s50
    v_add_u32 v6, 4096, v5
    s_mov_b32 s68, s82
    s_mul_i32 s72, s3, 8192
    s_add_u32 s72, s72, 0
    s_add_u32 s74, s72, 98304
    s_mov_b32 s69, s82
    s_mul_i32 s73, s3, 3072
    s_add_u32 s73, s73, 98304
    s_add_u32 s75, s73, 36864
    s_waitcnt lgkmcnt(0)
    s_add_u32 s26, s81, 22020096
    s_add_u32 s24, s6, s26
    s_addc_u32 s25, s7, 0
    s_mov_b32 s26, 524288
    s_mov_b32 s27, 0x20000
    s_add_u32 s30, s80, 26214400
    s_add_u32 s28, s6, s30
    s_addc_u32 s29, s7, 0
    s_mov_b32 s30, 196608
    s_mov_b32 s31, 0x20000
    s_mov_b32 m0, s72
    s_nop 0
    buffer_load_dwordx4 v5, s[24:27], s68 offen offset:0 lds
    buffer_load_dwordx4 v5, s[24:27], s68 offen offset:1024 lds
    buffer_load_dwordx4 v5, s[24:27], s68 offen offset:2048 lds
    buffer_load_dwordx4 v5, s[24:27], s68 offen offset:3072 lds
    s_add_u32 m0, s72, 4096
    s_nop 0
    buffer_load_dwordx4 v6, s[24:27], s68 offen offset:0 lds
    buffer_load_dwordx4 v6, s[24:27], s68 offen offset:1024 lds
    buffer_load_dwordx4 v6, s[24:27], s68 offen offset:2048 lds
    buffer_load_dwordx4 v6, s[24:27], s68 offen offset:3072 lds
    s_add_u32 s68, s68, 32768
    s_add_u32 s72, s72, 32768
    s_cmp_ge_u32 s72, s74
    s_cselect_b32 s66, 98304, 0
    s_sub_u32 s72, s72, s66
    s_mov_b32 m0, s73
    s_nop 0
    buffer_load_dwordx4 v8, s[28:31], s69 offen offset:0 lds
    buffer_load_dwordx4 v8, s[28:31], s69 offen offset:1024 lds
    buffer_load_dwordx4 v8, s[28:31], s69 offen offset:2048 lds
    s_add_u32 s69, s69, 12288
    s_add_u32 s73, s73, 12288
    s_cmp_ge_u32 s73, s75
    s_cselect_b32 s66, 36864, 0
    s_sub_u32 s73, s73, s66
    s_mov_b32 m0, s72
    s_nop 0
    buffer_load_dwordx4 v5, s[24:27], s68 offen offset:0 lds
    buffer_load_dwordx4 v5, s[24:27], s68 offen offset:1024 lds
    buffer_load_dwordx4 v5, s[24:27], s68 offen offset:2048 lds
    buffer_load_dwordx4 v5, s[24:27], s68 offen offset:3072 lds
    s_add_u32 m0, s72, 4096
    s_nop 0
    buffer_load_dwordx4 v6, s[24:27], s68 offen offset:0 lds
    buffer_load_dwordx4 v6, s[24:27], s68 offen offset:1024 lds
    buffer_load_dwordx4 v6, s[24:27], s68 offen offset:2048 lds
    buffer_load_dwordx4 v6, s[24:27], s68 offen offset:3072 lds
    s_add_u32 s68, s68, 32768
    s_add_u32 s72, s72, 32768
    s_cmp_ge_u32 s72, s74
    s_cselect_b32 s66, 98304, 0
    s_sub_u32 s72, s72, s66
    s_mov_b32 m0, s73
    s_nop 0
    buffer_load_dwordx4 v8, s[28:31], s69 offen offset:0 lds
    buffer_load_dwordx4 v8, s[28:31], s69 offen offset:1024 lds
    buffer_load_dwordx4 v8, s[28:31], s69 offen offset:2048 lds
    s_add_u32 s69, s69, 12288
    s_add_u32 s73, s73, 12288
    s_cmp_ge_u32 s73, s75
    s_cselect_b32 s66, 36864, 0
    s_sub_u32 s73, s73, s66
    s_waitcnt vmcnt(11)
    s_barrier
    s_mov_b32 s77, 0
L_mm_kernel_ploop_6:
    s_mov_b32 m0, s72
    s_nop 0
    buffer_load_dwordx4 v5, s[24:27], s68 offen offset:0 lds
    buffer_load_dwordx4 v5, s[24:27], s68 offen offset:1024 lds
    buffer_load_dwordx4 v5, s[24:27], s68 offen offset:2048 lds
    buffer_load_dwordx4 v5, s[24:27], s68 offen offset:3072 lds
    s_add_u32 m0, s72, 4096
    s_nop 0
    buffer_load_dwordx4 v6, s[24:27], s68 offen offset:0 lds
    buffer_load_dwordx4 v6, s[24:27], s68 offen offset:1024 lds
    buffer_load_dwordx4 v6, s[24:27], s68 offen offset:2048 lds
    buffer_load_dwordx4 v6, s[24:27], s68 offen offset:3072 lds
    s_add_u32 s68, s68, 32768
    s_add_u32 s72, s72, 32768
    s_cmp_ge_u32 s72, s74
    s_cselect_b32 s66, 98304, 0
    s_sub_u32 s72, s72, s66
    s_mov_b32 m0, s73
    s_nop 0
    buffer_load_dwordx4 v8, s[28:31], s69 offen offset:0 lds
    buffer_load_dwordx4 v8, s[28:31], s69 offen offset:1024 lds
    buffer_load_dwordx4 v8, s[28:31], s69 offen offset:2048 lds
    s_add_u32 s69, s69, 12288
    s_add_u32 s73, s73, 12288
    s_cmp_ge_u32 s73, s75
    s_cselect_b32 s66, 36864, 0
    s_sub_u32 s73, s73, s66
    s_add_u32 s77, s77, 1
    s_cmp_lt_u32 s77, 14
    s_waitcnt vmcnt(11)
    s_barrier
    s_cbranch_scc1 L_mm_kernel_ploop_6
    s_waitcnt vmcnt(0)
    s_barrier
    s_barrier
    s_branch L_mm_kernel_help_5
L_mm_kernel_rest_2:
    s_waitcnt lgkmcnt(0)
    s_add_u32 s32, s6, 0
    s_addc_u32 s33, s7, 0
    s_mov_b32 s34, 98304
    s_mov_b32 s35, 0x20000
    s_add_u32 s36, s6, 5242880
    s_addc_u32 s37, s7, 0
    s_mov_b32 s38, 12582912
    s_mov_b32 s39, 0x20000
    s_mul_i32 s50, s3, 4096
    s_add_u32 s50, s50, 0
    v_lshl_add_u32 v4, v1, 4, s50
    v_lshlrev_b32 v5, 4, v1
    v_add_u32 v5, 98304, v5
    v_mov_b32 v80, 0
    v_mov_b32 v81, 0
    v_mov_b32 v82, 0
    v_mov_b32 v83, 0
    v_mov_b32 v84, 0
    v_mov_b32 v85, 0
    v_mov_b32 v86, 0
    v_mov_b32 v87, 0
    v_mov_b32 v88, 0
    v_mov_b32 v89, 0
    v_mov_b32 v90, 0
    v_mov_b32 v91, 0
    v_mov_b32 v92, 0
    v_mov_b32 v93, 0
    v_mov_b32 v94, 0
    v_mov_b32 v95, 0
    v_mov_b32 v96, 0
    v_mov_b32 v97, 0
    v_mov_b32 v98, 0
    v_mov_b32 v99, 0
    v_mov_b32 v100, 0
    v_mov_b32 v101, 0
    v_mov_b32 v102, 0
    v_mov_b32 v103, 0
    v_mov_b32 v104, 0
    v_mov_b32 v105, 0
    v_mov_b32 v106, 0
    v_mov_b32 v107, 0
    v_mov_b32 v108, 0
    v_mov_b32 v109, 0
    v_mov_b32 v110, 0
    v_mov_b32 v111, 0
    v_mov_b32 v112, 0
    v_mov_b32 v113, 0
    v_mov_b32 v114, 0
    v_mov_b32 v115, 0
    v_mov_b32 v116, 0
    v_mov_b32 v117, 0
    v_mov_b32 v118, 0
    v_mov_b32 v119, 0
    v_mov_b32 v120, 0
    v_mov_b32 v121, 0
    v_mov_b32 v122, 0
    v_mov_b32 v123, 0
    v_mov_b32 v124, 0
    v_mov_b32 v125, 0
    v_mov_b32 v126, 0
    v_mov_b32 v127, 0
    v_mov_b32 v128, 0
    v_mov_b32 v129, 0
    v_mov_b32 v130, 0
    v_mov_b32 v131, 0
    v_mov_b32 v132, 0
    v_mov_b32 v133, 0
    v_mov_b32 v134, 0
    v_mov_b32 v135, 0
    v_mov_b32 v136, 0
    v_mov_b32 v137, 0
    v_mov_b32 v138, 0
    v_mov_b32 v139, 0
    v_mov_b32 v140, 0
    v_mov_b32 v141, 0
    v_mov_b32 v142, 0
    v_mov_b32 v143, 0
    v_mov_b32 v144, 0
    v_mov_b32 v145, 0
    v_mov_b32 v146, 0
    v_mov_b32 v147, 0
    v_mov_b32 v148, 0
    v_mov_b32 v149, 0
    v_mov_b32 v150, 0
    v_mov_b32 v151, 0
    v_mov_b32 v152, 0
    v_mov_b32 v153, 0
    v_mov_b32 v154, 0
    v_mov_b32 v155, 0
    v_mov_b32 v156, 0
    v_mov_b32 v157, 0
    v_mov_b32 v158, 0
    v_mov_b32 v159, 0
    v_mov_b32 v160, 0
    v_mov_b32 v161, 0
    v_mov_b32 v162, 0
    v_mov_b32 v163, 0
    v_mov_b32 v164, 0
    v_mov_b32 v165, 0
    v_mov_b32 v166, 0
    v_mov_b32 v167, 0
    v_mov_b32 v168, 0
    v_mov_b32 v169, 0
    v_mov_b32 v170, 0
    v_mov_b32 v171, 0
    v_mov_b32 v172, 0
    v_mov_b32 v173, 0
    v_mov_b32 v174, 0
    v_mov_b32 v175, 0
    s_mov_b32 s52, 0
    s_mov_b32 s53, 0
    s_mov_b32 s54, 0
    v_add_u32 v6, s52, v4
    v_add_u32 v10, s53, v5
    s_barrier
    ds_read_b128 v[24:27], v6 offset:0
    ds_read_b128 v[28:31], v6 offset:1024
    ds_read_b128 v[32:35], v6 offset:2048
    ds_read_b128 v[36:39], v6 offset:3072
    ds_read_b128 v[56:59], v10 offset:0
    ds_read_b128 v[60:63], v10 offset:1024
    ds_read_b128 v[64:67], v10 offset:2048
    ds_read_b128 v[68:71], v10 offset:3072
    v_lshlrev_b32 v2, 4, v0
    v_cmp_gt_u32 vcc, 2432, v2
    v_mov_b32 v3, 0x7f000000
    s_nop 0
    v_cndmask_b32 v2, v3, v2, vcc
    v_mov_b32 v12, -1.0
    v_mov_b32 v13, -1.0
    v_mov_b32 v14, -1.0
    v_mov_b32 v15, -1.0
    s_mul_i32 s50, s2, 2432
    s_add_u32 s32, s6, 56623104
    s_addc_u32 s33, s7, 0
    s_mov_b32 s34, 1048576
    s_mov_b32 s35, 0x20000
    buffer_store_dwordx4 v[12:15], v2, s[32:35], s50 offen sc1
L_mm_kernel_cloop_7:
    s_waitcnt lgkmcnt(3)
    v_mfma_f32_16x16x32_bf16 v[80:83], v[56:59], v[24:27], v[80:83]
    ds_read_b128 v[72:75], v10 offset:4096
    v_mfma_f32_16x16x32_bf16 v[84:87], v[56:59], v[28:31], v[84:87]
    v_mfma_f32_16x16x32_bf16 v[88:91], v[56:59], v[32:35], v[88:91]
    v_mfma_f32_16x16x32_bf16 v[92:95], v[56:59], v[36:39], v[92:95]
    s_add_u32 s52, s52, 32768
    s_waitcnt lgkmcnt(3)
    v_mfma_f32_16x16x32_bf16 v[96:99], v[60:63], v[24:27], v[96:99]
    ds_read_b128 v[76:79], v10 offset:5120
    v_mfma_f32_16x16x32_bf16 v[100:103], v[60:63], v[28:31], v[100:103]
    v_mfma_f32_16x16x32_bf16 v[104:107], v[60:63], v[32:35], v[104:107]
    v_mfma_f32_16x16x32_bf16 v[108:111], v[60:63], v[36:39], v[108:111]
    s_cmp_ge_u32 s52, 98304
    s_waitcnt lgkmcnt(3)
    v_mfma_f32_16x16x32_bf16 v[112:115], v[64:67], v[24:27], v[112:115]
    ds_read_b128 v[40:43], v6 offset:16384
    ds_read_b128 v[44:47], v6 offset:17408
    v_mfma_f32_16x16x32_bf16 v[116:119], v[64:67], v[28:31], v[116:119]
    ds_read_b128 v[48:51], v6 offset:18432
    v_mfma_f32_16x16x32_bf16 v[120:123], v[64:67], v[32:35], v[120:123]
    ds_read_b128 v[52:55], v6 offset:19456
    v_mfma_f32_16x16x32_bf16 v[124:127], v[64:67], v[36:39], v[124:127]
    ds_read_b128 v[56:59], v10 offset:6144
    s_cselect_b32 s52, 0, s52
    s_waitcnt lgkmcnt(7)
    v_mfma_f32_16x16x32_bf16 v[128:131], v[68:71], v[24:27], v[128:131]
    ds_read_b128 v[60:63], v10 offset:7168
    v_mfma_f32_16x16x32_bf16 v[132:135], v[68:71], v[28:31], v[132:135]
    v_mfma_f32_16x16x32_bf16 v[136:139], v[68:71], v[32:35], v[136:139]
    v_mfma_f32_16x16x32_bf16 v[140:143], v[68:71], v[36:39], v[140:143]
    s_add_u32 s53, s53, 12288
    s_waitcnt lgkmcnt(7)
    v_mfma_f32_16x16x32_bf16 v[144:147], v[24:27], v[72:75], v[144:147]
    ds_read_b128 v[64:67], v10 offset:8192
    v_mfma_f32_16x16x32_bf16 v[148:151], v[28:31], v[72:75], v[148:151]
    v_mfma_f32_16x16x32_bf16 v[152:155], v[32:35], v[72:75], v[152:155]
    v_mfma_f32_16x16x32_bf16 v[156:159], v[36:39], v[72:75], v[156:159]
    s_cmp_ge_u32 s53, 36864
    s_waitcnt lgkmcnt(7)
    v_mfma_f32_16x16x32_bf16 v[160:163], v[24:27], v[76:79], v[160:163]
    ds_read_b128 v[68:71], v10 offset:9216
    v_mfma_f32_16x16x32_bf16 v[164:167], v[28:31], v[76:79], v[164:167]
    v_mfma_f32_16x16x32_bf16 v[168:171], v[32:35], v[76:79], v[168:171]
    v_mfma_f32_16x16x32_bf16 v[172:175], v[36:39], v[76:79], v[172:175]
    s_cselect_b32 s53, 0, s53
    s_waitcnt lgkmcnt(3)
    v_mfma_f32_16x16x32_bf16 v[80:83], v[56:59], v[40:43], v[80:83]
    ds_read_b128 v[72:75], v10 offset:10240
    v_mfma_f32_16x16x32_bf16 v[84:87], v[56:59], v[44:47], v[84:87]
    v_mfma_f32_16x16x32_bf16 v[88:91], v[56:59], v[48:51], v[88:91]
    v_mfma_f32_16x16x32_bf16 v[92:95], v[56:59], v[52:55], v[92:95]
    s_add_u32 s54, s54, 1
    s_waitcnt lgkmcnt(3)
    v_mfma_f32_16x16x32_bf16 v[96:99], v[60:63], v[40:43], v[96:99]
    ds_read_b128 v[76:79], v10 offset:11264
    v_mfma_f32_16x16x32_bf16 v[100:103], v[60:63], v[44:47], v[100:103]
    v_mfma_f32_16x16x32_bf16 v[104:107], v[60:63], v[48:51], v[104:107]
    v_mfma_f32_16x16x32_bf16 v[108:111], v[60:63], v[52:55], v[108:111]
    s_cmp_lt_u32 s54, 16
    s_waitcnt lgkmcnt(3)
    v_mfma_f32_16x16x32_bf16 v[112:115], v[64:67], v[40:43], v[112:115]
    v_mfma_f32_16x16x32_bf16 v[116:119], v[64:67], v[44:47], v[116:119]
    v_mfma_f32_16x16x32_bf16 v[120:123], v[64:67], v[48:51], v[120:123]
    v_mfma_f32_16x16x32_bf16 v[124:127], v[64:67], v[52:55], v[124:127]
    s_waitcnt lgkmcnt(2)
    v_mfma_f32_16x16x32_bf16 v[128:131], v[68:71], v[40:43], v[128:131]
    v_add_u32 v6, s52, v4
    v_add_u32 v10, s53, v5
    s_waitcnt lgkmcnt(0)
    s_barrier
    v_mfma_f32_16x16x32_bf16 v[132:135], v[68:71], v[44:47], v[132:135]
    ds_read_b128 v[24:27], v6 offset:0
    ds_read_b128 v[28:31], v6 offset:1024
    v_mfma_f32_16x16x32_bf16 v[136:139], v[68:71], v[48:51], v[136:139]
    ds_read_b128 v[32:35], v6 offset:2048
    ds_read_b128 v[36:39], v6 offset:3072
    v_mfma_f32_16x16x32_bf16 v[140:143], v[68:71], v[52:55], v[140:143]
    ds_read_b128 v[56:59], v10 offset:0
    ds_read_b128 v[60:63], v10 offset:1024
    v_mfma_f32_16x16x32_bf16 v[144:147], v[40:43], v[72:75], v[144:147]
    ds_read_b128 v[64:67], v10 offset:2048
    v_mfma_f32_16x16x32_bf16 v[148:151], v[44:47], v[72:75], v[148:151]
    v_mfma_f32_16x16x32_bf16 v[152:155], v[48:51], v[72:75], v[152:155]
    v_mfma_f32_16x16x32_bf16 v[156:159], v[52:55], v[72:75], v[156:159]
    v_mfma_f32_16x16x32_bf16 v[160:163], v[40:43], v[76:79], v[160:163]
    ds_read_b128 v[68:71], v10 offset:3072
    v_mfma_f32_16x16x32_bf16 v[164:167], v[44:47], v[76:79], v[164:167]
    v_mfma_f32_16x16x32_bf16 v[168:171], v[48:51], v[76:79], v[168:171]
    v_mfma_f32_16x16x32_bf16 v[172:175], v[52:55], v[76:79], v[172:175]
    s_cbranch_scc1 L_mm_kernel_cloop_7
    s_waitcnt lgkmcnt(0)
    v_lshlrev_b32 v2, 4, v1
    v_and_b32 v5, 0x330, v2
    v_and_b32 v6, 0x40, v2
    v_lshl_or_b32 v5, v6, 1, v5
    v_and_b32 v6, 0x80, v2
    v_lshrrev_b32 v6, 1, v6
    v_or_b32 v5, v5, v6
    s_lshl_b32 s56, s21, 17
    s_lshl_b32 s57, s20, 14
    s_add_u32 s56, s56, s57
    s_lshl_b32 s59, s3, 12
    s_add_u32 s56, s56, s59
    s_add_u32 s57, s56, 0x400000
    s_add_u32 s58, s56, 0x800000
    s_lshr_b32 s62, s3, 1
    s_lshl_b32 s62, s62, 13
    s_add_u32 s62, s62, s59
    v_add_u32 v3, s62, v2
    v_add_u32 v6, s62, v5
    s_mov_b32 s60, 0x3e8293ee
    s_mov_b32 s61, 0x3e8293ee
    s_mov_b32 s64, 0x5a800000
    s_mov_b32 s65, s64
    v_cvt_pk_bf16_f32 v24, v112, v113
    v_cvt_pk_bf16_f32 v25, v114, v115
    v_cvt_pk_bf16_f32 v26, v116, v117
    v_cvt_pk_bf16_f32 v27, v118, v119
    s_nop 0
    v_permlane16_swap_b32 v24, v26
    s_nop 0
    v_permlane16_swap_b32 v25, v27
    buffer_store_dwordx4 v[24:27], v5, s[36:39], s57 offen offset:0 sc1
    ds_write_b128 v6, v[24:27] offset:0
    v_cvt_pk_bf16_f32 v28, v128, v129
    v_cvt_pk_bf16_f32 v29, v130, v131
    v_cvt_pk_bf16_f32 v30, v132, v133
    v_cvt_pk_bf16_f32 v31, v134, v135
    s_nop 0
    v_permlane16_swap_b32 v28, v30
    s_nop 0
    v_permlane16_swap_b32 v29, v31
    buffer_store_dwordx4 v[28:31], v5, s[36:39], s57 offen offset:1024 sc1
    ds_write_b128 v6, v[28:31] offset:1024
    v_cvt_pk_bf16_f32 v32, v120, v121
    v_cvt_pk_bf16_f32 v33, v122, v123
    v_cvt_pk_bf16_f32 v34, v124, v125
    v_cvt_pk_bf16_f32 v35, v126, v127
    s_nop 0
    v_permlane16_swap_b32 v32, v34
    s_nop 0
    v_permlane16_swap_b32 v33, v35
    buffer_store_dwordx4 v[32:35], v5, s[36:39], s57 offen offset:2048 sc1
    ds_write_b128 v6, v[32:35] offset:2048
    v_cvt_pk_bf16_f32 v36, v136, v137
    v_cvt_pk_bf16_f32 v37, v138, v139
    v_cvt_pk_bf16_f32 v38, v140, v141
    v_cvt_pk_bf16_f32 v39, v142, v143
    s_nop 0
    v_permlane16_swap_b32 v36, v38
    s_nop 0
    v_permlane16_swap_b32 v37, v39
    buffer_store_dwordx4 v[36:39], v5, s[36:39], s57 offen offset:3072 sc1
    ds_write_b128 v6, v[36:39] offset:3072
    v_pk_mul_f32 v[144:145], v[144:145], s[64:65]
    v_cvt_pk_bf16_f32 v40, v144, v145
    v_pk_mul_f32 v[146:147], v[146:147], s[64:65]
    v_cvt_pk_bf16_f32 v41, v146, v147
    v_pk_mul_f32 v[160:161], v[160:161], s[64:65]
    v_cvt_pk_bf16_f32 v42, v160, v161
    v_pk_mul_f32 v[162:163], v[162:163], s[64:65]
    v_cvt_pk_bf16_f32 v43, v162, v163
    v_permlane16_swap_b32 v40, v42
    s_nop 0
    v_permlane16_swap_b32 v41, v43
    buffer_store_dwordx4 v[40:43], v2, s[36:39], s58 offen offset:0 sc1
    ds_write_b128 v3, v[40:43] offset:8192
    v_pk_mul_f32 v[148:149], v[148:149], s[64:65]
    v_cvt_pk_bf16_f32 v44, v148, v149
    v_pk_mul_f32 v[150:151], v[150:151], s[64:65]
    v_cvt_pk_bf16_f32 v45, v150, v151
    v_pk_mul_f32 v[164:165], v[164:165], s[64:65]
    v_cvt_pk_bf16_f32 v46, v164, v165
    v_pk_mul_f32 v[166:167], v[166:167], s[64:65]
    v_cvt_pk_bf16_f32 v47, v166, v167
    v_permlane16_swap_b32 v44, v46
    s_nop 0
    v_permlane16_swap_b32 v45, v47
    buffer_store_dwordx4 v[44:47], v2, s[36:39], s58 offen offset:1024 sc1
    ds_write_b128 v3, v[44:47] offset:9216
    v_pk_mul_f32 v[152:153], v[152:153], s[64:65]
    v_cvt_pk_bf16_f32 v48, v152, v153
    v_pk_mul_f32 v[154:155], v[154:155], s[64:65]
    v_cvt_pk_bf16_f32 v49, v154, v155
    v_pk_mul_f32 v[168:169], v[168:169], s[64:65]
    v_cvt_pk_bf16_f32 v50, v168, v169
    v_pk_mul_f32 v[170:171], v[170:171], s[64:65]
    v_cvt_pk_bf16_f32 v51, v170, v171
    v_permlane16_swap_b32 v48, v50
    s_nop 0
    v_permlane16_swap_b32 v49, v51
    buffer_store_dwordx4 v[48:51], v2, s[36:39], s58 offen offset:2048 sc1
    ds_write_b128 v3, v[48:51] offset:10240
    v_pk_mul_f32 v[156:157], v[156:157], s[64:65]
    v_cvt_pk_bf16_f32 v52, v156, v157
    v_pk_mul_f32 v[158:159], v[158:159], s[64:65]
    v_cvt_pk_bf16_f32 v53, v158, v159
    v_pk_mul_f32 v[172:173], v[172:173], s[64:65]
    v_cvt_pk_bf16_f32 v54, v172, v173
    v_pk_mul_f32 v[174:175], v[174:175], s[64:65]
    v_cvt_pk_bf16_f32 v55, v174, v175
    v_permlane16_swap_b32 v52, v54
    s_nop 0
    v_permlane16_swap_b32 v53, v55
    buffer_store_dwordx4 v[52:55], v2, s[36:39], s58 offen offset:3072 sc1
    ds_write_b128 v3, v[52:55] offset:11264
    v_pk_mul_f32 v[80:81], v[80:81], s[60:61]
    v_pk_mul_f32 v[82:83], v[82:83], s[60:61]
    v_pk_mul_f32 v[84:85], v[84:85], s[60:61]
    v_pk_mul_f32 v[86:87], v[86:87], s[60:61]
    v_cvt_pk_bf16_f32 v8, v80, v81
    v_cvt_pk_bf16_f32 v9, v82, v83
    v_cvt_pk_bf16_f32 v10, v84, v85
    v_cvt_pk_bf16_f32 v11, v86, v87
    s_nop 0
    v_permlane16_swap_b32 v8, v10
    s_nop 0
    v_permlane16_swap_b32 v9, v11
    v_pk_mul_f32 v[96:97], v[96:97], s[60:61]
    v_pk_mul_f32 v[98:99], v[98:99], s[60:61]
    v_pk_mul_f32 v[100:101], v[100:101], s[60:61]
    v_pk_mul_f32 v[102:103], v[102:103], s[60:61]
    v_cvt_pk_bf16_f32 v12, v96, v97
    v_cvt_pk_bf16_f32 v13, v98, v99
    v_cvt_pk_bf16_f32 v14, v100, v101
    v_cvt_pk_bf16_f32 v15, v102, v103
    s_nop 0
    v_permlane16_swap_b32 v12, v14
    s_nop 0
    v_permlane16_swap_b32 v13, v15
    v_pk_mul_f32 v[88:89], v[88:89], s[60:61]
    v_pk_mul_f32 v[90:91], v[90:91], s[60:61]
    v_pk_mul_f32 v[92:93], v[92:93], s[60:61]
    v_pk_mul_f32 v[94:95], v[94:95], s[60:61]
    v_cvt_pk_bf16_f32 v16, v88, v89
    v_cvt_pk_bf16_f32 v17, v90, v91
    v_cvt_pk_bf16_f32 v18, v92, v93
    v_cvt_pk_bf16_f32 v19, v94, v95
    s_nop 0
    v_permlane16_swap_b32 v16, v18
    s_nop 0
    v_permlane16_swap_b32 v17, v19
    v_pk_mul_f32 v[104:105], v[104:105], s[60:61]
    v_pk_mul_f32 v[106:107], v[106:107], s[60:61]
    v_pk_mul_f32 v[108:109], v[108:109], s[60:61]
    v_pk_mul_f32 v[110:111], v[110:111], s[60:61]
    v_cvt_pk_bf16_f32 v20, v104, v105
    v_cvt_pk_bf16_f32 v21, v106, v107
    v_cvt_pk_bf16_f32 v22, v108, v109
    v_cvt_pk_bf16_f32 v23, v110, v111
    s_nop 0
    v_permlane16_swap_b32 v20, v22
    s_nop 0
    v_permlane16_swap_b32 v21, v23
L_mm_kernel_comp_4:
    v_lshlrev_b32 v4, 4, v1
    s_lshl_b32 s43, s21, 17
    s_add_u32 s24, s6, 5242880
    s_addc_u32 s25, s7, 0
    s_mov_b32 s26, 12582912
    s_mov_b32 s27, 0x20000
    s_add_u32 s28, s6, 17825792
    s_addc_u32 s29, s7, 0
    s_mov_b32 s30, 4194304
    s_mov_b32 s31, 0x20000
    s_add_u32 s32, s6, 57147392
    s_addc_u32 s33, s7, 0
    s_mov_b32 s34, 327680
    s_mov_b32 s35, 0x20000
    s_lshl_b32 s46, s21, 5
    s_lshl_b32 s47, s20, 2
    s_add_u32 s23, s47, s19
    s_add_u32 s46, s46, s23
    s_lshl_b32 s46, s46, 7
    s_add_u32 s46, s46, 131072
    v_mov_b32 v156, 0
    v_mov_b32 v157, 1.0
    v_mov_b32 v158, 159744
    s_lshl_b32 s47, s19, 2
    s_add_u32 s47, s47, 159760
    v_mov_b32 v159, s47
    v_mov_b32 v160, 0
    s_mov_b32 s47, 1
    v_bfe_u32 v2, v1, 2, 1
    v_bfe_u32 v3, v1, 4, 1
    v_cmp_eq_u32 vcc, v2, v3
    v_mov_b32 v2, 0x3f803f80
    s_nop 0
    v_cndmask_b32 v152, 0, v2, vcc
    v_mov_b32 v153, v152
    v_mov_b32 v154, v152
    v_mov_b32 v155, v152
    v_mov_b32 v5, v4
    v_add_u32 v6, 16384, v4
    s_mov_b32 s45, 16384
    s_waitcnt lgkmcnt(0)
    s_barrier
    ds_read_b128 v[96:99], v4
    ds_read_b128 v[100:103], v4 offset:1024
    ds_read_b128 v[104:107], v4 offset:8192
    ds_read_b128 v[164:167], v4 offset:2048
    ds_read_b128 v[108:111], v4 offset:9216
    ds_read_b128 v[168:171], v4 offset:3072
    ds_read_b128 v[172:175], v4 offset:10240
    v_mov_b32 v112, 0
    v_mov_b32 v113, 0
    v_mov_b32 v114, 0
    v_mov_b32 v115, 0
    v_mov_b32 v116, 0
    v_mov_b32 v117, 0
    v_mov_b32 v118, 0
    v_mov_b32 v119, 0
    v_mov_b32 v120, 0
    v_mov_b32 v121, 0
    v_mov_b32 v122, 0
    v_mov_b32 v123, 0
    v_mov_b32 v124, 0
    v_mov_b32 v125, 0
    v_mov_b32 v126, 0
    v_mov_b32 v127, 0
    v_mov_b32 v144, 0
    v_mov_b32 v145, 0
    v_mov_b32 v146, 0
    v_mov_b32 v147, 0
    v_mov_b32 v128, 0
    v_mov_b32 v129, 0
    v_mov_b32 v130, 0
    v_mov_b32 v131, 0
    v_mov_b32 v132, 0
    v_mov_b32 v133, 0
    v_mov_b32 v134, 0
    v_mov_b32 v135, 0
    v_mov_b32 v136, 0
    v_mov_b32 v137, 0
    v_mov_b32 v138, 0
    v_mov_b32 v139, 0
    v_mov_b32 v140, 0
    v_mov_b32 v141, 0
    v_mov_b32 v142, 0
    v_mov_b32 v143, 0
    v_mov_b32 v148, 0
    v_mov_b32 v149, 0
    v_mov_b32 v150, 0
    v_mov_b32 v151, 0
    v_mov_b32 v176, 0
    v_mov_b32 v92, 0
    v_mov_b32 v177, 0
    v_mov_b32 v93, 0
    v_mov_b32 v178, 0
    v_mov_b32 v94, 0
    v_mov_b32 v179, 0
    v_mov_b32 v95, 0
    s_waitcnt lgkmcnt(0)
    v_mfma_f32_32x32x16_bf16 v[56:71], v[96:99], v[8:11], 0
    v_mfma_f32_32x32x16_bf16 v[56:71], v[100:103], v[12:15], v[56:71]
    v_mfma_f32_32x32x16_bf16 v[72:87], v[96:99], v[16:19], 0
    v_mfma_f32_32x32x16_bf16 v[72:87], v[100:103], v[20:23], v[72:87]
    s_mov_b32 s48, 3
    s_bitcmp0_b32 s48, 0
    s_cbranch_scc1 L_mm_kernel_notyet_9
    s_getreg_b32 s41, hwreg(HW_REG_IB_STS, 0, 4)
    s_cmp_lg_u32 s41, 0
    s_cbranch_scc1 L_mm_kernel_notyet_9
    s_waitcnt vmcnt(0)
    s_mov_b64 exec, 1
    buffer_store_dword v157, v156, s[32:35], s46 offen sc1
    s_mov_b64 exec, -1
    ds_write_b32 v158, v157 offset:8
    s_bitset0_b32 s48, 0
L_mm_kernel_notyet_9:
    s_nop 6
    v_max3_f32 v2, v56, v57, v58
    s_nop 5
    v_max_f32 v2, v2, v59
    s_nop 4
    v_max3_f32 v2, v2, v60, v61
    s_nop 3
    v_max3_f32 v2, v2, v62, v63
    s_nop 2
    v_max3_f32 v2, v2, v64, v65
    s_nop 1
    v_max3_f32 v2, v2, v66, v67
    s_nop 0
    v_max3_f32 v2, v2, v68, v69
    v_max3_f32 v2, v2, v70, v71
    v_mov_b32 v3, v2
    s_nop 1
    v_permlane32_swap_b32 v2, v3
    v_max_f32 v2, v2, v3
    v_add_f32 v2, 0x42bc0000, v2
    v_sub_f32 v24, 0, v2
    v_sub_f32 v25, 0, v2
    v_sub_f32 v26, 0, v2
    v_sub_f32 v27, 0, v2
    v_sub_f32 v28, 0, v2
    v_sub_f32 v29, 0, v2
    v_sub_f32 v30, 0, v2
    v_sub_f32 v31, 0, v2
    v_sub_f32 v32, 0, v2
    v_sub_f32 v33, 0, v2
    v_sub_f32 v34, 0, v2
    v_sub_f32 v35, 0, v2
    v_sub_f32 v36, 0, v2
    v_sub_f32 v37, 0, v2
    v_sub_f32 v38, 0, v2
    v_sub_f32 v39, 0, v2
    s_nop 1
    v_mfma_f32_32x32x16_bf16 v[56:71], v[96:99], v[8:11], v[24:39]
    v_mfma_f32_32x32x16_bf16 v[56:71], v[100:103], v[12:15], v[56:71]
    s_bitcmp0_b32 s48, 0
    s_cbranch_scc1 L_mm_kernel_notyet_10
    s_getreg_b32 s41, hwreg(HW_REG_IB_STS, 0, 4)
    s_cmp_lg_u32 s41, 0
    s_cbranch_scc1 L_mm_kernel_notyet_10
    s_waitcnt vmcnt(0)
    s_mov_b64 exec, 1
    buffer_store_dword v157, v156, s[32:35], s46 offen sc1
    s_mov_b64 exec, -1
    ds_write_b32 v158, v157 offset:8
    s_bitset0_b32 s48, 0
L_mm_kernel_notyet_10:
    v_max3_f32 v2, v72, v73, v74
    v_max_f32 v2, v2, v75
    v_max3_f32 v2, v2, v76, v77
    v_max3_f32 v2, v2, v78, v79
    v_max3_f32 v2, v2, v80, v81
    v_max3_f32 v2, v2, v82, v83
    v_max3_f32 v2, v2, v84, v85
    v_max3_f32 v2, v2, v86, v87
    v_mov_b32 v3, v2
    s_nop 1
    v_permlane32_swap_b32 v2, v3
    v_max_f32 v2, v2, v3
    v_add_f32 v2, 0x42bc0000, v2
    v_sub_f32 v40, 0, v2
    v_sub_f32 v41, 0, v2
    v_sub_f32 v42, 0, v2
    v_sub_f32 v43, 0, v2
    v_sub_f32 v44, 0, v2
    v_sub_f32 v45, 0, v2
    v_sub_f32 v46, 0, v2
    v_sub_f32 v47, 0, v2
    v_sub_f32 v48, 0, v2
    v_sub_f32 v49, 0, v2
    v_sub_f32 v50, 0, v2
    v_sub_f32 v51, 0, v2
    v_sub_f32 v52, 0, v2
    v_sub_f32 v53, 0, v2
    v_sub_f32 v54, 0, v2
    v_sub_f32 v55, 0, v2
    s_bitcmp0_b32 s48, 0
    s_cbranch_scc1 L_mm_kernel_notyet_11
    s_getreg_b32 s41, hwreg(HW_REG_IB_STS, 0, 4)
    s_cmp_lg_u32 s41, 0
    s_cbranch_scc1 L_mm_kernel_notyet_11
    s_waitcnt vmcnt(0)
    s_mov_b64 exec, 1
    buffer_store_dword v157, v156, s[32:35], s46 offen sc1
    s_mov_b64 exec, -1
    ds_write_b32 v158, v157 offset:8
    s_bitset0_b32 s48, 0
L_mm_kernel_notyet_11:
    s_mov_b32 s44, 0
L_mm_kernel_loop_12:
    v_mfma_f32_32x32x16_bf16 v[72:87], v[96:99], v[16:19], v[40:55]
    ds_read_b128 v[96:99], v5 offset:4096
    v_exp_f32 v56, v56
    v_exp_f32 v57, v57
    v_exp_f32 v58, v58
    v_exp_f32 v59, v59
    v_mfma_f32_32x32x16_bf16 v[128:143], v[176:179], v[92:95], v[128:143]
    ds_read_b128 v[176:179], v5 offset:11264
    v_cvt_pk_bf16_f32 v88, v56, v57
    v_cvt_pk_bf16_f32 v89, v58, v59
    v_exp_f32 v60, v60
    v_exp_f32 v61, v61
    v_exp_f32 v62, v62
    v_mfma_f32_16x16x32_bf16 v[148:151], v[152:155], v[92:95], v[148:151]
    v_exp_f32 v63, v63
    v_exp_f32 v64, v64
    v_mfma_f32_32x32x16_bf16 v[72:87], v[100:103], v[20:23], v[72:87]
    ds_read_b128 v[100:103], v5 offset:5120
    v_cvt_pk_bf16_f32 v90, v60, v61
    v_cvt_pk_bf16_f32 v91, v62, v63
    v_exp_f32 v65, v65
    v_exp_f32 v66, v66
    v_exp_f32 v67, v67
    v_mfma_f32_32x32x16_bf16 v[112:127], v[104:107], v[88:91], v[112:127]
    v_exp_f32 v68, v68
    v_cvt_pk_bf16_f32 v92, v64, v65
    v_cvt_pk_bf16_f32 v93, v66, v67
    v_exp_f32 v69, v69
    v_exp_f32 v70, v70
    v_mfma_f32_16x16x32_bf16 v[144:147], v[152:155], v[88:91], v[144:147]
    v_exp_f32 v71, v71
    v_cvt_pk_bf16_f32 v94, v68, v69
    v_cvt_pk_bf16_f32 v95, v70, v71
    s_add_u32 s45, s45, 16384
    s_waitcnt lgkmcnt(3)
    v_mfma_f32_32x32x16_bf16 v[56:71], v[164:167], v[8:11], v[24:39]
    ds_read_b32 v161, v158
    v_exp_f32 v72, v72
    v_exp_f32 v73, v73
    v_exp_f32 v74, v74
    v_exp_f32 v75, v75
    v_mfma_f32_32x32x16_bf16 v[112:127], v[108:111], v[92:95], v[112:127]
    v_cvt_pk_bf16_f32 v88, v72, v73
    v_cvt_pk_bf16_f32 v89, v74, v75
    v_exp_f32 v76, v76
    v_exp_f32 v77, v77
    v_exp_f32 v78, v78
    v_mfma_f32_16x16x32_bf16 v[144:147], v[152:155], v[92:95], v[144:147]
    v_exp_f32 v79, v79
    v_exp_f32 v80, v80
    v_mfma_f32_32x32x16_bf16 v[56:71], v[168:171], v[12:15], v[56:71]
    v_cvt_pk_bf16_f32 v90, v76, v77
    v_cvt_pk_bf16_f32 v91, v78, v79
    v_exp_f32 v81, v81
    v_exp_f32 v82, v82
    v_exp_f32 v83, v83
    v_mfma_f32_32x32x16_bf16 v[128:143], v[104:107], v[88:91], v[128:143]
    ds_read_b128 v[104:107], v5 offset:12288
    v_exp_f32 v84, v84
    v_cvt_pk_bf16_f32 v92, v80, v81
    v_cvt_pk_bf16_f32 v93, v82, v83
    v_exp_f32 v85, v85
    v_exp_f32 v86, v86
    v_mfma_f32_16x16x32_bf16 v[148:151], v[152:155], v[88:91], v[148:151]
    v_exp_f32 v87, v87
    v_cvt_pk_bf16_f32 v94, v84, v85
    v_cvt_pk_bf16_f32 v95, v86, v87
    s_and_b32 s45, s45, 131071
    v_mfma_f32_32x32x16_bf16 v[72:87], v[164:167], v[16:19], v[40:55]
    ds_read_b128 v[164:167], v5 offset:6144
    v_exp_f32 v56, v56
    v_exp_f32 v57, v57
    v_exp_f32 v58, v58
    v_exp_f32 v59, v59
    v_mfma_f32_32x32x16_bf16 v[128:143], v[108:111], v[92:95], v[128:143]
    ds_read_b128 v[108:111], v5 offset:13312
    v_cvt_pk_bf16_f32 v88, v56, v57
    v_cvt_pk_bf16_f32 v89, v58, v59
    v_exp_f32 v60, v60
    v_exp_f32 v61, v61
    v_exp_f32 v62, v62
    v_mfma_f32_16x16x32_bf16 v[148:151], v[152:155], v[92:95], v[148:151]
    v_exp_f32 v63, v63
    v_exp_f32 v64, v64
    v_mfma_f32_32x32x16_bf16 v[72:87], v[168:171], v[20:23], v[72:87]
    ds_read_b128 v[168:171], v5 offset:7168
    v_cvt_pk_bf16_f32 v90, v60, v61
    v_cvt_pk_bf16_f32 v91, v62, v63
    v_exp_f32 v65, v65
    v_exp_f32 v66, v66
    v_exp_f32 v67, v67
    v_mfma_f32_32x32x16_bf16 v[112:127], v[172:175], v[88:91], v[112:127]
    v_exp_f32 v68, v68
    v_cvt_pk_bf16_f32 v92, v64, v65
    v_cvt_pk_bf16_f32 v93, v66, v67
    v_exp_f32 v69, v69
    v_exp_f32 v70, v70
    v_mfma_f32_16x16x32_bf16 v[144:147], v[152:155], v[88:91], v[144:147]
    v_exp_f32 v71, v71
    v_cvt_pk_bf16_f32 v94, v68, v69
    v_cvt_pk_bf16_f32 v95, v70, v71
    s_waitcnt lgkmcnt(3)
    v_mfma_f32_32x32x16_bf16 v[56:71], v[96:99], v[8:11], v[24:39]
    v_exp_f32 v72, v72
    v_exp_f32 v73, v73
    v_exp_f32 v74, v74
    v_exp_f32 v75, v75
    v_mfma_f32_32x32x16_bf16 v[112:127], v[176:179], v[92:95], v[112:127]
    v_cvt_pk_bf16_f32 v88, v72, v73
    v_cvt_pk_bf16_f32 v89, v74, v75
    v_exp_f32 v76, v76
    v_exp_f32 v77, v77
    v_exp_f32 v78, v78
    v_mfma_f32_16x16x32_bf16 v[144:147], v[152:155], v[92:95], v[144:147]
    v_exp_f32 v79, v79
    v_exp_f32 v80, v80
    v_mfma_f32_32x32x16_bf16 v[56:71], v[100:103], v[12:15], v[56:71]
    v_readfirstlane_b32 s42, v161
    v_cvt_pk_bf16_f32 v90, v76, v77
    v_cvt_pk_bf16_f32 v91, v78, v79
    v_exp_f32 v81, v81
    v_exp_f32 v82, v82
    v_exp_f32 v83, v83
    v_mfma_f32_32x32x16_bf16 v[128:143], v[172:175], v[88:91], v[128:143]
    ds_read_b128 v[172:175], v5 offset:14336
    v_exp_f32 v84, v84
    v_cvt_pk_bf16_f32 v92, v80, v81
    v_cvt_pk_bf16_f32 v93, v82, v83
    v_exp_f32 v85, v85
    v_exp_f32 v86, v86
    v_mfma_f32_16x16x32_bf16 v[148:151], v[152:155], v[88:91], v[148:151]
    v_exp_f32 v87, v87
    v_cvt_pk_bf16_f32 v94, v84, v85
    v_cvt_pk_bf16_f32 v95, v86, v87
    s_bitcmp1_b32 s48, s44
    s_cbranch_scc1 L_mm_kernel_resc_15
L_mm_kernel_rback_16:
    s_cmp_le_u32 s42, s47
    s_cbranch_scc1 L_mm_kernel_spin_13
L_mm_kernel_back_14:
    v_mfma_f32_32x32x16_bf16 v[72:87], v[96:99], v[16:19], v[40:55]
    ds_read_b128 v[96:99], v6 offset:0
    v_exp_f32 v56, v56
    v_exp_f32 v57, v57
    v_exp_f32 v58, v58
    v_exp_f32 v59, v59
    v_mfma_f32_32x32x16_bf16 v[128:143], v[176:179], v[92:95], v[128:143]
    ds_read_b128 v[176:179], v5 offset:15360
    v_cvt_pk_bf16_f32 v88, v56, v57
    v_cvt_pk_bf16_f32 v89, v58, v59
    v_exp_f32 v60, v60
    v_exp_f32 v61, v61
    v_exp_f32 v62, v62
    v_mfma_f32_16x16x32_bf16 v[148:151], v[152:155], v[92:95], v[148:151]
    v_exp_f32 v63, v63
    v_exp_f32 v64, v64
    v_mfma_f32_32x32x16_bf16 v[72:87], v[100:103], v[20:23], v[72:87]
    ds_read_b128 v[100:103], v6 offset:1024
    v_cvt_pk_bf16_f32 v90, v60, v61
    v_cvt_pk_bf16_f32 v91, v62, v63
    v_exp_f32 v65, v65
    v_exp_f32 v66, v66
    v_exp_f32 v67, v67
    v_mfma_f32_32x32x16_bf16 v[112:127], v[104:107], v[88:91], v[112:127]
    v_exp_f32 v68, v68
    v_cvt_pk_bf16_f32 v92, v64, v65
    v_cvt_pk_bf16_f32 v93, v66, v67
    v_exp_f32 v69, v69
    v_exp_f32 v70, v70
    v_mfma_f32_16x16x32_bf16 v[144:147], v[152:155], v[88:91], v[144:147]
    v_exp_f32 v71, v71
    v_cvt_pk_bf16_f32 v94, v68, v69
    v_cvt_pk_bf16_f32 v95, v70, v71
    s_waitcnt lgkmcnt(3)
    v_mfma_f32_32x32x16_bf16 v[56:71], v[164:167], v[8:11], v[24:39]
    v_exp_f32 v72, v72
    v_exp_f32 v73, v73
    v_exp_f32 v74, v74
    v_exp_f32 v75, v75
    v_mfma_f32_32x32x16_bf16 v[112:127], v[108:111], v[92:95], v[112:127]
    v_cvt_pk_bf16_f32 v88, v72, v73
    v_cvt_pk_bf16_f32 v89, v74, v75
    v_exp_f32 v76, v76
    v_exp_f32 v77, v77
    v_exp_f32 v78, v78
    v_mfma_f32_16x16x32_bf16 v[144:147], v[152:155], v[92:95], v[144:147]
    v_exp_f32 v79, v79
    v_exp_f32 v80, v80
    v_mfma_f32_32x32x16_bf16 v[56:71], v[168:171], v[12:15], v[56:71]
    v_cvt_pk_bf16_f32 v90, v76, v77
    v_cvt_pk_bf16_f32 v91, v78, v79
    v_exp_f32 v81, v81
    v_exp_f32 v82, v82
    v_exp_f32 v83, v83
    v_mfma_f32_32x32x16_bf16 v[128:143], v[104:107], v[88:91], v[128:143]
    ds_read_b128 v[104:107], v6 offset:8192
    v_exp_f32 v84, v84
    v_cvt_pk_bf16_f32 v92, v80, v81
    v_cvt_pk_bf16_f32 v93, v82, v83
    v_exp_f32 v85, v85
    v_exp_f32 v86, v86
    v_mfma_f32_16x16x32_bf16 v[148:151], v[152:155], v[88:91], v[148:151]
    v_exp_f32 v87, v87
    v_cvt_pk_bf16_f32 v94, v84, v85
    v_cvt_pk_bf16_f32 v95, v86, v87
    v_mfma_f32_32x32x16_bf16 v[72:87], v[164:167], v[16:19], v[40:55]
    ds_read_b128 v[164:167], v6 offset:2048
    v_exp_f32 v56, v56
    v_exp_f32 v57, v57
    v_exp_f32 v58, v58
    v_exp_f32 v59, v59
    v_mfma_f32_32x32x16_bf16 v[128:143], v[108:111], v[92:95], v[128:143]
    ds_read_b128 v[108:111], v6 offset:9216
    v_cvt_pk_bf16_f32 v88, v56, v57
    v_cvt_pk_bf16_f32 v89, v58, v59
    v_exp_f32 v60, v60
    v_exp_f32 v61, v61
    v_exp_f32 v62, v62
    v_mfma_f32_16x16x32_bf16 v[148:151], v[152:155], v[92:95], v[148:151]
    v_exp_f32 v63, v63
    v_exp_f32 v64, v64
    v_mfma_f32_32x32x16_bf16 v[72:87], v[168:171], v[20:23], v[72:87]
    ds_read_b128 v[168:171], v6 offset:3072
    v_cvt_pk_bf16_f32 v90, v60, v61
    v_cvt_pk_bf16_f32 v91, v62, v63
    v_exp_f32 v65, v65
    v_exp_f32 v66, v66
    v_exp_f32 v67, v67
    v_mfma_f32_32x32x16_bf16 v[112:127], v[172:175], v[88:91], v[112:127]
    v_exp_f32 v68, v68
    v_cvt_pk_bf16_f32 v92, v64, v65
    v_cvt_pk_bf16_f32 v93, v66, v67
    v_exp_f32 v69, v69
    v_exp_f32 v70, v70
    v_mfma_f32_16x16x32_bf16 v[144:147], v[152:155], v[88:91], v[144:147]
    v_exp_f32 v71, v71
    v_cvt_pk_bf16_f32 v94, v68, v69
    v_cvt_pk_bf16_f32 v95, v70, v71
    s_waitcnt lgkmcnt(3)
    v_mfma_f32_32x32x16_bf16 v[56:71], v[96:99], v[8:11], v[24:39]
    v_exp_f32 v72, v72
    v_exp_f32 v73, v73
    v_exp_f32 v74, v74
    v_exp_f32 v75, v75
    v_mfma_f32_32x32x16_bf16 v[112:127], v[176:179], v[92:95], v[112:127]
    v_cvt_pk_bf16_f32 v88, v72, v73
    v_cvt_pk_bf16_f32 v89, v74, v75
    v_exp_f32 v76, v76
    v_exp_f32 v77, v77
    v_exp_f32 v78, v78
    v_mfma_f32_16x16x32_bf16 v[144:147], v[152:155], v[92:95], v[144:147]
    v_exp_f32 v79, v79
    v_exp_f32 v80, v80
    v_mfma_f32_32x32x16_bf16 v[56:71], v[100:103], v[12:15], v[56:71]
    v_cvt_pk_bf16_f32 v90, v76, v77
    v_cvt_pk_bf16_f32 v91, v78, v79
    v_exp_f32 v81, v81
    v_exp_f32 v82, v82
    v_exp_f32 v83, v83
    v_mfma_f32_32x32x16_bf16 v[128:143], v[172:175], v[88:91], v[128:143]
    ds_read_b128 v[172:175], v6 offset:10240
    v_exp_f32 v84, v84
    v_cvt_pk_bf16_f32 v92, v80, v81
    v_cvt_pk_bf16_f32 v93, v82, v83
    v_exp_f32 v85, v85
    v_exp_f32 v86, v86
    v_mfma_f32_16x16x32_bf16 v[148:151], v[152:155], v[88:91], v[148:151]
    v_exp_f32 v87, v87
    v_cvt_pk_bf16_f32 v94, v84, v85
    v_cvt_pk_bf16_f32 v95, v86, v87
    v_add_u32 v160, 1, v160
    v_mov_b32 v5, v6
    v_add_u32 v6, s45, v4
    ds_write_b32 v159, v160
    s_add_u32 s47, s47, 1
    s_add_u32 s44, s44, 1
    s_cmp_lt_u32 s44, 16
    s_cbranch_scc1 L_mm_kernel_loop_12
    s_waitcnt lgkmcnt(0)
    v_mfma_f32_32x32x16_bf16 v[128:143], v[176:179], v[92:95], v[128:143]
    v_mfma_f32_16x16x32_bf16 v[148:151], v[152:155], v[92:95], v[148:151]
    s_lshr_b32 s10, s23, 1
    s_lshl_b32 s10, s10, 18
    s_lshl_b32 s11, s21, 13
    s_add_u32 s10, s10, s11
    s_and_b32 s11, s23, 1
    s_lshl_b32 s11, s11, 12
    s_add_u32 s10, s10, s11
    v_bfe_u32 v2, v1, 4, 1
    v_lshlrev_b32 v5, 10, v2
    v_lshrrev_b32 v2, 5, v1
    v_lshl_add_u32 v5, v2, 8, v5
    v_and_b32 v2, 15, v1
    v_lshl_add_u32 v5, v2, 4, v5
    s_mov_b32 s14, 0x24800000
    s_mov_b32 s15, s14
    v_mov_b32 v2, v144
    v_mov_b32 v7, 0
    v_fma_f32 v2, v112, 0, v2
    v_fma_f32 v7, v113, 0, v7
    v_fma_f32 v2, v114, 0, v2
    v_fma_f32 v7, v115, 0, v7
    v_fma_f32 v2, v116, 0, v2
    v_fma_f32 v7, v117, 0, v7
    v_fma_f32 v2, v118, 0, v2
    v_fma_f32 v7, v119, 0, v7
    v_fma_f32 v2, v120, 0, v2
    v_fma_f32 v7, v121, 0, v7
    v_fma_f32 v2, v122, 0, v2
    v_fma_f32 v7, v123, 0, v7
    v_fma_f32 v2, v124, 0, v2
    v_fma_f32 v7, v125, 0, v7
    v_fma_f32 v2, v126, 0, v2
    v_fma_f32 v7, v127, 0, v7
    v_add_f32 v2, v2, v7
    v_mov_b32 v3, 0x7b800000
    v_cmp_nlt_f32 vcc, v2, v3
    s_cbranch_vccnz L_mm_kernel_slow_17
L_mm_kernel_epi_19:
    s_nop 1
    v_rcp_f32 v2, v144
    s_nop 0
    v_mov_b32 v3, v2
    s_nop 2
    v_pk_mul_f32 v[112:113], v[112:113], v[2:3]
    s_nop 1
    v_pk_mul_f32 v[114:115], v[114:115], v[2:3]
    s_nop 0
    v_pk_mul_f32 v[116:117], v[116:117], v[2:3]
    v_pk_mul_f32 v[118:119], v[118:119], v[2:3]
    v_pk_mul_f32 v[120:121], v[120:121], v[2:3]
    v_pk_mul_f32 v[122:123], v[122:123], v[2:3]
    v_pk_mul_f32 v[124:125], v[124:125], v[2:3]
    v_pk_mul_f32 v[126:127], v[126:127], v[2:3]
    v_pk_mul_f32 v[112:113], v[112:113], s[14:15]
    v_pk_mul_f32 v[114:115], v[114:115], s[14:15]
    v_pk_mul_f32 v[116:117], v[116:117], s[14:15]
    v_pk_mul_f32 v[118:119], v[118:119], s[14:15]
    v_pk_mul_f32 v[120:121], v[120:121], s[14:15]
    v_pk_mul_f32 v[122:123], v[122:123], s[14:15]
    v_pk_mul_f32 v[124:125], v[124:125], s[14:15]
    v_pk_mul_f32 v[126:127], v[126:127], s[14:15]
    v_cvt_pk_bf16_f32 v56, v112, v113
    v_cvt_pk_bf16_f32 v57, v114, v115
    v_cvt_pk_bf16_f32 v58, v116, v117
    v_cvt_pk_bf16_f32 v59, v118, v119
    v_cvt_pk_bf16_f32 v60, v120, v121
    v_cvt_pk_bf16_f32 v61, v122, v123
    v_cvt_pk_bf16_f32 v62, v124, v125
    v_cvt_pk_bf16_f32 v63, v126, v127
    v_permlane32_swap_b32 v56, v58
    v_permlane32_swap_b32 v57, v59
    v_permlane32_swap_b32 v60, v62
    v_permlane32_swap_b32 v61, v63
    buffer_store_dwordx4 v[56:59], v5, s[28:31], s10 offen offset:0 sc1
    buffer_store_dwordx4 v[60:63], v5, s[28:31], s10 offen offset:512 sc1
    v_mov_b32 v2, v148
    v_mov_b32 v7, 0
    v_fma_f32 v2, v128, 0, v2
    v_fma_f32 v7, v129, 0, v7
    v_fma_f32 v2, v130, 0, v2
    v_fma_f32 v7, v131, 0, v7
    v_fma_f32 v2, v132, 0, v2
    v_fma_f32 v7, v133, 0, v7
    v_fma_f32 v2, v134, 0, v2
    v_fma_f32 v7, v135, 0, v7
    v_fma_f32 v2, v136, 0, v2
    v_fma_f32 v7, v137, 0, v7
    v_fma_f32 v2, v138, 0, v2
    v_fma_f32 v7, v139, 0, v7
    v_fma_f32 v2, v140, 0, v2
    v_fma_f32 v7, v141, 0, v7
    v_fma_f32 v2, v142, 0, v2
    v_fma_f32 v7, v143, 0, v7
    v_add_f32 v2, v2, v7
    v_mov_b32 v3, 0x7b800000
    v_cmp_nlt_f32 vcc, v2, v3
    s_cbranch_vccnz L_mm_kernel_slow_18
L_mm_kernel_epi_20:
    s_nop 1
    v_rcp_f32 v2, v148
    s_nop 0
    v_mov_b32 v3, v2
    s_nop 2
    v_pk_mul_f32 v[128:129], v[128:129], v[2:3]
    s_nop 1
    v_pk_mul_f32 v[130:131], v[130:131], v[2:3]
    s_nop 0
    v_pk_mul_f32 v[132:133], v[132:133], v[2:3]
    v_pk_mul_f32 v[134:135], v[134:135], v[2:3]
    v_pk_mul_f32 v[136:137], v[136:137], v[2:3]
    v_pk_mul_f32 v[138:139], v[138:139], v[2:3]
    v_pk_mul_f32 v[140:141], v[140:141], v[2:3]
    v_pk_mul_f32 v[142:143], v[142:143], v[2:3]
    v_pk_mul_f32 v[128:129], v[128:129], s[14:15]
    v_pk_mul_f32 v[130:131], v[130:131], s[14:15]
    v_pk_mul_f32 v[132:133], v[132:133], s[14:15]
    v_pk_mul_f32 v[134:135], v[134:135], s[14:15]
    v_pk_mul_f32 v[136:137], v[136:137], s[14:15]
    v_pk_mul_f32 v[138:139], v[138:139], s[14:15]
    v_pk_mul_f32 v[140:141], v[140:141], s[14:15]
    v_pk_mul_f32 v[142:143], v[142:143], s[14:15]
    v_cvt_pk_bf16_f32 v64, v128, v129
    v_cvt_pk_bf16_f32 v65, v130, v131
    v_cvt_pk_bf16_f32 v66, v132, v133
    v_cvt_pk_bf16_f32 v67, v134, v135
    v_cvt_pk_bf16_f32 v68, v136, v137
    v_cvt_pk_bf16_f32 v69, v138, v139
    v_cvt_pk_bf16_f32 v70, v140, v141
    v_cvt_pk_bf16_f32 v71, v142, v143
    v_permlane32_swap_b32 v64, v66
    v_permlane32_swap_b32 v65, v67
    v_permlane32_swap_b32 v68, v70
    v_permlane32_swap_b32 v69, v71
    buffer_store_dwordx4 v[64:67], v5, s[28:31], s10 offen offset:2048 sc1
    buffer_store_dwordx4 v[68:71], v5, s[28:31], s10 offen offset:2560 sc1
    s_add_u32 s32, s6, 57147392
    s_addc_u32 s33, s7, 0
    s_mov_b32 s34, 327680
    s_mov_b32 s35, 0x20000
    s_lshl_b32 s56, s20, 12
    s_lshl_b32 s57, s21, 7
    s_add_u32 s56, s56, s57
    s_add_u32 s56, s56, 98304
    v_mov_b32 v2, 0
    v_mov_b32 v3, 1.0
    s_waitcnt vmcnt(0)
    s_barrier
    s_cmp_lg_u32 s3, 0
    s_cbranch_scc1 L_mm_kernel_nosig_21
    s_mov_b64 exec, 1
    buffer_store_dword v3, v2, s[32:35], s56 offen sc1
    s_mov_b64 exec, -1
L_mm_kernel_nosig_21:
    s_branch L_mm_second
L_mm_kernel_resc_15:
    s_cmp_lg_u32 s44, 0
    s_cbranch_scc1 L_mm_kernel_resc_22
    s_waitcnt vmcnt(0)
    s_mov_b64 exec, 1
    buffer_store_dword v157, v156, s[32:35], s46 offen sc1
    s_mov_b64 exec, -1
    ds_write_b32 v158, v157 offset:8
    s_branch L_mm_kernel_rback_16
L_mm_kernel_resc_22:
    v_mfma_f32_32x32x16_bf16 v[128:143], v[176:179], v[92:95], v[128:143]
    v_mfma_f32_16x16x32_bf16 v[148:151], v[152:155], v[92:95], v[148:151]
    v_frexp_exp_i32_f32 v2, v144
    v_sub_u32 v2, 4294967203, v2
    v_cvt_f32_i32 v3, v2
    v_mov_b32 v92, 0
    v_mov_b32 v93, 0
    v_mov_b32 v94, 0
    v_mov_b32 v95, 0
    v_add_f32 v56, v3, v56
    v_add_f32 v57, v3, v57
    v_add_f32 v58, v3, v58
    v_add_f32 v59, v3, v59
    v_add_f32 v60, v3, v60
    v_add_f32 v61, v3, v61
    v_add_f32 v62, v3, v62
    v_add_f32 v63, v3, v63
    v_add_f32 v64, v3, v64
    v_add_f32 v65, v3, v65
    v_add_f32 v66, v3, v66
    v_add_f32 v67, v3, v67
    v_add_f32 v68, v3, v68
    v_add_f32 v69, v3, v69
    v_add_f32 v70, v3, v70
    v_add_f32 v71, v3, v71
    v_add_f32 v24, v3, v24
    v_add_f32 v25, v3, v25
    v_add_f32 v26, v3, v26
    v_add_f32 v27, v3, v27
    v_add_f32 v28, v3, v28
    v_add_f32 v29, v3, v29
    v_add_f32 v30, v3, v30
    v_add_f32 v31, v3, v31
    v_add_f32 v32, v3, v32
    v_add_f32 v33, v3, v33
    v_add_f32 v34, v3, v34
    v_add_f32 v35, v3, v35
    v_add_f32 v36, v3, v36
    v_add_f32 v37, v3, v37
    v_add_f32 v38, v3, v38
    v_add_f32 v39, v3, v39
    v_ldexp_f32 v112, v112, v2
    v_ldexp_f32 v113, v113, v2
    v_ldexp_f32 v114, v114, v2
    v_ldexp_f32 v115, v115, v2
    v_ldexp_f32 v116, v116, v2
    v_ldexp_f32 v117, v117, v2
    v_ldexp_f32 v118, v118, v2
    v_ldexp_f32 v119, v119, v2
    v_ldexp_f32 v120, v120, v2
    v_ldexp_f32 v121, v121, v2
    v_ldexp_f32 v122, v122, v2
    v_ldexp_f32 v123, v123, v2
    v_ldexp_f32 v124, v124, v2
    v_ldexp_f32 v125, v125, v2
    v_ldexp_f32 v126, v126, v2
    v_ldexp_f32 v127, v127, v2
    v_ldexp_f32 v144, v144, v2
    v_ldexp_f32 v145, v145, v2
    v_ldexp_f32 v146, v146, v2
    v_ldexp_f32 v147, v147, v2
    v_frexp_exp_i32_f32 v2, v148
    v_sub_u32 v2, 4294967203, v2
    v_cvt_f32_i32 v3, v2
    v_add_f32 v40, v3, v40
    v_add_f32 v41, v3, v41
    v_add_f32 v42, v3, v42
    v_add_f32 v43, v3, v43
    v_add_f32 v44, v3, v44
    v_add_f32 v45, v3, v45
    v_add_f32 v46, v3, v46
    v_add_f32 v47, v3, v47
    v_add_f32 v48, v3, v48
    v_add_f32 v49, v3, v49
    v_add_f32 v50, v3, v50
    v_add_f32 v51, v3, v51
    v_add_f32 v52, v3, v52
    v_add_f32 v53, v3, v53
    v_add_f32 v54, v3, v54
    v_add_f32 v55, v3, v55
    v_ldexp_f32 v128, v128, v2
    v_ldexp_f32 v129, v129, v2
    v_ldexp_f32 v130, v130, v2
    v_ldexp_f32 v131, v131, v2
    v_ldexp_f32 v132, v132, v2
    v_ldexp_f32 v133, v133, v2
    v_ldexp_f32 v134, v134, v2
    v_ldexp_f32 v135, v135, v2
    v_ldexp_f32 v136, v136, v2
    v_ldexp_f32 v137, v137, v2
    v_ldexp_f32 v138, v138, v2
    v_ldexp_f32 v139, v139, v2
    v_ldexp_f32 v140, v140, v2
    v_ldexp_f32 v141, v141, v2
    v_ldexp_f32 v142, v142, v2
    v_ldexp_f32 v143, v143, v2
    v_ldexp_f32 v148, v148, v2
    v_ldexp_f32 v149, v149, v2
    v_ldexp_f32 v150, v150, v2
    v_ldexp_f32 v151, v151, v2
    s_branch L_mm_kernel_rback_16
L_mm_kernel_spin_13:
    s_mov_b32 s41, 0
L_mm_kernel_spin_23:
    ds_read_b32 v161, v158
    s_add_u32 s41, s41, 1
    s_waitcnt lgkmcnt(0)
    v_readfirstlane_b32 s42, v161
    s_nop 0
    s_cmp_gt_u32 s42, s47
    s_cbranch_scc1 L_mm_kernel_back_14
    s_sleep 1
    s_cmp_lt_u32 s41, 0x1000000
    s_cbranch_scc1 L_mm_kernel_spin_23
    s_branch L_mm_kernel_back_14
L_mm_kernel_slow_17:
    s_waitcnt vmcnt(0)
    s_add_u32 s16, s43, 0x400000
    s_mov_b32 s44, 0
    v_mov_b32 v2, 0xff800000
L_mm_kernel_slowa_24:
    buffer_load_dwordx4 v[96:99], v4, s[24:27], s16 offen sc1
    buffer_load_dwordx4 v[100:103], v4, s[24:27], s16 offen offset:1024 sc1
    s_waitcnt vmcnt(0)
    v_mfma_f32_32x32x16_bf16 v[72:87], v[96:99], v[8:11], 0
    v_mfma_f32_32x32x16_bf16 v[72:87], v[100:103], v[12:15], v[72:87]
    s_nop 11
    v_max3_f32 v2, v2, v72, v73
    s_nop 10
    v_max3_f32 v2, v2, v74, v75
    s_nop 9
    v_max3_f32 v2, v2, v76, v77
    s_nop 8
    v_max3_f32 v2, v2, v78, v79
    s_nop 7
    v_max3_f32 v2, v2, v80, v81
    s_nop 6
    v_max3_f32 v2, v2, v82, v83
    s_nop 5
    v_max3_f32 v2, v2, v84, v85
    s_nop 4
    v_max3_f32 v2, v2, v86, v87
    s_add_u32 s16, s16, 2048
    s_add_u32 s44, s44, 1
    s_cmp_lt_u32 s44, 64
    s_cbranch_scc1 L_mm_kernel_slowa_24
    v_mov_b32 v3, v2
    s_nop 1
    v_permlane32_swap_b32 v2, v3
    v_max_f32 v2, v2, v3
    v_sub_f32 v24, 0, v2
    v_sub_f32 v25, 0, v2
    v_sub_f32 v26, 0, v2
    v_sub_f32 v27, 0, v2
    v_sub_f32 v28, 0, v2
    v_sub_f32 v29, 0, v2
    v_sub_f32 v30, 0, v2
    v_sub_f32 v31, 0, v2
    v_sub_f32 v32, 0, v2
    v_sub_f32 v33, 0, v2
    v_sub_f32 v34, 0, v2
    v_sub_f32 v35, 0, v2
    v_sub_f32 v36, 0, v2
    v_sub_f32 v37, 0, v2
    v_sub_f32 v38, 0, v2
    v_sub_f32 v39, 0, v2
    v_mov_b32 v112, 0
    v_mov_b32 v113, 0
    v_mov_b32 v114, 0
    v_mov_b32 v115, 0
    v_mov_b32 v116, 0
    v_mov_b32 v117, 0
    v_mov_b32 v118, 0
    v_mov_b32 v119, 0
    v_mov_b32 v120, 0
    v_mov_b32 v121, 0
    v_mov_b32 v122, 0
    v_mov_b32 v123, 0
    v_mov_b32 v124, 0
    v_mov_b32 v125, 0
    v_mov_b32 v126, 0
    v_mov_b32 v127, 0
    v_mov_b32 v144, 0
    v_mov_b32 v145, 0
    v_mov_b32 v146, 0
    v_mov_b32 v147, 0
    s_add_u32 s16, s43, 0x400000
    s_add_u32 s17, s43, 0x800000
    s_mov_b32 s44, 0
L_mm_kernel_slowb_25:
    buffer_load_dwordx4 v[96:99], v4, s[24:27], s16 offen sc1
    buffer_load_dwordx4 v[100:103], v4, s[24:27], s16 offen offset:1024 sc1
    buffer_load_dwordx4 v[104:107], v4, s[24:27], s17 offen sc1
    buffer_load_dwordx4 v[108:111], v4, s[24:27], s17 offen offset:1024 sc1
    s_waitcnt vmcnt(0)
    v_mfma_f32_32x32x16_bf16 v[72:87], v[96:99], v[8:11], v[24:39]
    v_mfma_f32_32x32x16_bf16 v[72:87], v[100:103], v[12:15], v[72:87]
    s_nop 11
    v_exp_f32 v72, v72
    s_nop 10
    v_exp_f32 v73, v73
    s_nop 9
    v_exp_f32 v74, v74
    s_nop 8
    v_exp_f32 v75, v75
    s_nop 7
    v_cvt_pk_bf16_f32 v88, v72, v73
    s_nop 6
    v_cvt_pk_bf16_f32 v89, v74, v75
    s_nop 5
    v_exp_f32 v76, v76
    s_nop 4
    v_exp_f32 v77, v77
    s_nop 3
    v_exp_f32 v78, v78
    s_nop 2
    v_exp_f32 v79, v79
    s_nop 1
    v_cvt_pk_bf16_f32 v90, v76, v77
    s_nop 0
    v_cvt_pk_bf16_f32 v91, v78, v79
    v_exp_f32 v80, v80
    v_exp_f32 v81, v81
    v_exp_f32 v82, v82
    v_exp_f32 v83, v83
    v_cvt_pk_bf16_f32 v92, v80, v81
    v_cvt_pk_bf16_f32 v93, v82, v83
    v_exp_f32 v84, v84
    v_exp_f32 v85, v85
    v_exp_f32 v86, v86
    v_exp_f32 v87, v87
    v_cvt_pk_bf16_f32 v94, v84, v85
    v_cvt_pk_bf16_f32 v95, v86, v87
    v_mfma_f32_32x32x16_bf16 v[112:127], v[104:107], v[88:91], v[112:127]
    v_mfma_f32_16x16x32_bf16 v[144:147], v[152:155], v[88:91], v[144:147]
    v_mfma_f32_32x32x16_bf16 v[112:127], v[108:111], v[92:95], v[112:127]
    v_mfma_f32_16x16x32_bf16 v[144:147], v[152:155], v[92:95], v[144:147]
    s_add_u32 s16, s16, 2048
    s_add_u32 s17, s17, 2048
    s_add_u32 s44, s44, 1
    s_cmp_lt_u32 s44, 64
    s_cbranch_scc1 L_mm_kernel_slowb_25
    s_branch L_mm_kernel_epi_19
L_mm_kernel_slow_18:
    s_waitcnt vmcnt(0)
    s_add_u32 s16, s43, 0x400000
    s_mov_b32 s44, 0
    v_mov_b32 v2, 0xff800000
L_mm_kernel_slowa_26:
    buffer_load_dwordx4 v[96:99], v4, s[24:27], s16 offen sc1
    buffer_load_dwordx4 v[100:103], v4, s[24:27], s16 offen offset:1024 sc1
    s_waitcnt vmcnt(0)
    v_mfma_f32_32x32x16_bf16 v[72:87], v[96:99], v[16:19], 0
    v_mfma_f32_32x32x16_bf16 v[72:87], v[100:103], v[20:23], v[72:87]
    s_nop 11
    v_max3_f32 v2, v2, v72, v73
    s_nop 10
    v_max3_f32 v2, v2, v74, v75
    s_nop 9
    v_max3_f32 v2, v2, v76, v77
    s_nop 8
    v_max3_f32 v2, v2, v78, v79
    s_nop 7
    v_max3_f32 v2, v2, v80, v81
    s_nop 6
    v_max3_f32 v2, v2, v82, v83
    s_nop 5
    v_max3_f32 v2, v2, v84, v85
    s_nop 4
    v_max3_f32 v2, v2, v86, v87
    s_add_u32 s16, s16, 2048
    s_add_u32 s44, s44, 1
    s_cmp_lt_u32 s44, 64
    s_cbranch_scc1 L_mm_kernel_slowa_26
    v_mov_b32 v3, v2
    s_nop 1
    v_permlane32_swap_b32 v2, v3
    v_max_f32 v2, v2, v3
    v_sub_f32 v40, 0, v2
    v_sub_f32 v41, 0, v2
    v_sub_f32 v42, 0, v2
    v_sub_f32 v43, 0, v2
    v_sub_f32 v44, 0, v2
    v_sub_f32 v45, 0, v2
    v_sub_f32 v46, 0, v2
    v_sub_f32 v47, 0, v2
    v_sub_f32 v48, 0, v2
    v_sub_f32 v49, 0, v2
    v_sub_f32 v50, 0, v2
    v_sub_f32 v51, 0, v2
    v_sub_f32 v52, 0, v2
    v_sub_f32 v53, 0, v2
    v_sub_f32 v54, 0, v2
    v_sub_f32 v55, 0, v2
    v_mov_b32 v128, 0
    v_mov_b32 v129, 0
    v_mov_b32 v130, 0
    v_mov_b32 v131, 0
    v_mov_b32 v132, 0
    v_mov_b32 v133, 0
    v_mov_b32 v134, 0
    v_mov_b32 v135, 0
    v_mov_b32 v136, 0
    v_mov_b32 v137, 0
    v_mov_b32 v138, 0
    v_mov_b32 v139, 0
    v_mov_b32 v140, 0
    v_mov_b32 v141, 0
    v_mov_b32 v142, 0
    v_mov_b32 v143, 0
    v_mov_b32 v148, 0
    v_mov_b32 v149, 0
    v_mov_b32 v150, 0
    v_mov_b32 v151, 0
    s_add_u32 s16, s43, 0x400000
    s_add_u32 s17, s43, 0x800000
    s_mov_b32 s44, 0
L_mm_kernel_slowb_27:
    buffer_load_dwordx4 v[96:99], v4, s[24:27], s16 offen sc1
    buffer_load_dwordx4 v[100:103], v4, s[24:27], s16 offen offset:1024 sc1
    buffer_load_dwordx4 v[104:107], v4, s[24:27], s17 offen sc1
    buffer_load_dwordx4 v[108:111], v4, s[24:27], s17 offen offset:1024 sc1
    s_waitcnt vmcnt(0)
    v_mfma_f32_32x32x16_bf16 v[72:87], v[96:99], v[16:19], v[40:55]
    v_mfma_f32_32x32x16_bf16 v[72:87], v[100:103], v[20:23], v[72:87]
    s_nop 11
    v_exp_f32 v72, v72
    s_nop 10
    v_exp_f32 v73, v73
    s_nop 9
    v_exp_f32 v74, v74
    s_nop 8
    v_exp_f32 v75, v75
    s_nop 7
    v_cvt_pk_bf16_f32 v88, v72, v73
    s_nop 6
    v_cvt_pk_bf16_f32 v89, v74, v75
    s_nop 5
    v_exp_f32 v76, v76
    s_nop 4
    v_exp_f32 v77, v77
    s_nop 3
    v_exp_f32 v78, v78
    s_nop 2
    v_exp_f32 v79, v79
    s_nop 1
    v_cvt_pk_bf16_f32 v90, v76, v77
    s_nop 0
    v_cvt_pk_bf16_f32 v91, v78, v79
    v_exp_f32 v80, v80
    v_exp_f32 v81, v81
    v_exp_f32 v82, v82
    v_exp_f32 v83, v83
    v_cvt_pk_bf16_f32 v92, v80, v81
    v_cvt_pk_bf16_f32 v93, v82, v83
    v_exp_f32 v84, v84
    v_exp_f32 v85, v85
    v_exp_f32 v86, v86
    v_exp_f32 v87, v87
    v_cvt_pk_bf16_f32 v94, v84, v85
    v_cvt_pk_bf16_f32 v95, v86, v87
    v_mfma_f32_32x32x16_bf16 v[128:143], v[104:107], v[88:91], v[128:143]
    v_mfma_f32_16x16x32_bf16 v[148:151], v[152:155], v[88:91], v[148:151]
    v_mfma_f32_32x32x16_bf16 v[128:143], v[108:111], v[92:95], v[128:143]
    v_mfma_f32_16x16x32_bf16 v[148:151], v[152:155], v[92:95], v[148:151]
    s_add_u32 s16, s16, 2048
    s_add_u32 s17, s17, 2048
    s_add_u32 s44, s44, 1
    s_cmp_lt_u32 s44, 64
    s_cbranch_scc1 L_mm_kernel_slowb_27
    s_branch L_mm_kernel_epi_20
L_mm_kernel_help_5:
    v_lshlrev_b32 v4, 4, v1
    s_lshl_b32 s43, s21, 17
    s_add_u32 s24, s6, 5242880
    s_addc_u32 s25, s7, 0
    s_mov_b32 s26, 12582912
    s_mov_b32 s27, 0x20000
    s_sub_u32 s3, s19, 4
    v_mov_b32 v7, 159744
    s_cmp_lg_u32 s3, 0
    s_cbranch_scc1 L_mm_kernel_side_28
    s_add_u32 s11, s20, 1
    s_and_b32 s11, s11, 7
    s_lshl_b32 s18, s11, 2
    s_lshl_b32 s11, s11, 14
    s_mov_b32 s11, 0
    s_mov_b32 s18, 0
    s_lshl_b32 s17, s20, 14
    s_add_u32 s13, s43, 0x400000
    v_mov_b32 v100, 2
    v_mov_b32 v101, 0
    v_mov_b32 v102, 0
    v_mov_b32 v103, 0
    ds_write_b128 v7, v[100:103]
    v_mov_b32 v100, 0
    ds_write_b128 v7, v[100:103] offset:16
    ds_write_b128 v7, v[100:103] offset:32
    s_add_u32 s96, s6, 57147392
    s_addc_u32 s97, s7, 0
    s_mov_b32 s98, 327680
    s_mov_b32 s99, 0x20000
    s_lshl_b32 s94, s21, 12
    s_add_u32 s94, s94, 131072
    v_min_u32 v96, 31, v1
    v_add_u32 v96, s18, v96
    v_and_b32 v96, 31, v96
    v_lshlrev_b32 v96, 7, v96
    s_mov_b32 s95, 0
    s_mov_b32 s100, 1024
    v_mov_b32 v98, 159748
    v_mov_b32 v97, 0
    ds_write_b32 v98, v97
    s_waitcnt lgkmcnt(0)
    s_barrier
    s_mov_b32 s14, 0
    s_mov_b32 s4, 0
L_mm_kernel_w_33:
    ds_read_b32 v100, v7 offset:8
    s_add_u32 s4, s4, 1
    s_waitcnt lgkmcnt(0)
    v_readfirstlane_b32 s5, v100
    s_nop 0
    s_cmp_gt_u32 s5, s14
    s_cbranch_scc1 L_mm_kernel_g_34
    s_sleep 2
    s_cmp_lt_u32 s4, 0x1000000
    s_cbranch_scc1 L_mm_kernel_w_33
L_mm_kernel_g_34:
    v_mov_b32 v105, 2
    s_mov_b32 s12, 2
    s_mov_b32 s15, 32768
    s_mov_b32 s16, 0
L_mm_kernel_kv_35:
    s_add_u32 s14, s16, 8
    s_cmp_lt_u32 s12, s14
    s_cbranch_scc1 L_mm_kernel_free_36
    s_sub_u32 s14, s12, 8
    s_mov_b32 s4, 0
L_mm_kernel_w_37:
    ds_read_b128 v[100:103], v7 offset:16
    s_add_u32 s4, s4, 1
    s_waitcnt lgkmcnt(0)
    v_min_u32 v100, v100, v101
    v_min3_u32 v100, v100, v102, v103
    s_nop 0
    v_readfirstlane_b32 s5, v100
    s_nop 0
    s_cmp_gt_u32 s5, s14
    s_cbranch_scc1 L_mm_kernel_g_38
    s_sleep 6
    s_cmp_lt_u32 s4, 0x1000000
    s_cbranch_scc1 L_mm_kernel_w_37
L_mm_kernel_g_38:
    s_mov_b32 s16, s5
L_mm_kernel_free_36:
    s_cmp_eq_u32 s11, s17
    s_cselect_b32 s10, 16384, 0
    s_add_u32 s11, s11, s10
    s_lshr_b32 s10, s10, 2
    s_add_u32 s100, s100, s10
    s_lshr_b32 s101, s100, 10
    s_add_u32 s100, s100, 2048
    s_cmp_gt_u32 s95, s101
    s_cbranch_scc1 L_mm_kernel_go_40
    s_waitcnt vmcnt(0)
    v_mov_b32 v104, s12
    v_max_u32 v105, v105, v104
    ds_write_b32 v7, v105
    s_mov_b32 s4, 0
    s_cmp_lg_u32 s3, 0
    s_cbranch_scc1 L_mm_kernel_follow_41
L_mm_kernel_wait_39:
    s_sleep 6
    buffer_load_dword v97, v96, s[96:99], s94 offen sc1
    s_waitcnt vmcnt(0)
    v_cmp_gt_f32 vcc, 0, v97
    s_add_u32 s4, s4, 1
    s_nop 3
    s_ff1_i32_b64 s95, vcc
    v_mov_b32 v97, s95
    ds_write_b32 v98, v97
    s_cmp_gt_u32 s95, s101
    s_cbranch_scc1 L_mm_kernel_go_40
    s_cmp_lt_u32 s4, 0x100000
    s_cbranch_scc1 L_mm_kernel_wait_39
    s_branch L_mm_kernel_go_40
L_mm_kernel_follow_41:
    ds_read_b32 v97, v98
    s_add_u32 s4, s4, 1
    s_waitcnt lgkmcnt(0)
    v_readfirstlane_b32 s95, v97
    s_nop 3
    s_cmp_gt_u32 s95, s101
    s_cbranch_scc1 L_mm_kernel_go_40
    s_sleep 1
    s_cmp_lt_u32 s4, 0x1000000
    s_cbranch_scc1 L_mm_kernel_follow_41
L_mm_kernel_go_40:
    s_add_u32 s10, s13, s11
    s_add_u32 m0, s15, 0
    s_nop 0
    buffer_load_dwordx4 v4, s[24:27], s10 offen offset:0 sc1 lds
    buffer_load_dwordx4 v4, s[24:27], s10 offen offset:1024 sc1 lds
    buffer_load_dwordx4 v4, s[24:27], s10 offen offset:2048 sc1 lds
    buffer_load_dwordx4 v4, s[24:27], s10 offen offset:3072 sc1 lds
    s_add_u32 m0, s15, 4096
    s_add_u32 s10, s10, 4096
    buffer_load_dwordx4 v4, s[24:27], s10 offen offset:0 sc1 lds
    buffer_load_dwordx4 v4, s[24:27], s10 offen offset:1024 sc1 lds
    buffer_load_dwordx4 v4, s[24:27], s10 offen offset:2048 sc1 lds
    buffer_load_dwordx4 v4, s[24:27], s10 offen offset:3072 sc1 lds
    s_add_u32 m0, s15, 8192
    s_add_u32 s10, s10, 4190208
    buffer_load_dwordx4 v4, s[24:27], s10 offen offset:0 sc1 lds
    buffer_load_dwordx4 v4, s[24:27], s10 offen offset:1024 sc1 lds
    buffer_load_dwordx4 v4, s[24:27], s10 offen offset:2048 sc1 lds
    buffer_load_dwordx4 v4, s[24:27], s10 offen offset:3072 sc1 lds
    s_add_u32 m0, s15, 12288
    s_add_u32 s10, s10, 4096
    buffer_load_dwordx4 v4, s[24:27], s10 offen offset:0 sc1 lds
    buffer_load_dwordx4 v4, s[24:27], s10 offen offset:1024 sc1 lds
    buffer_load_dwordx4 v4, s[24:27], s10 offen offset:2048 sc1 lds
    buffer_load_dwordx4 v4, s[24:27], s10 offen offset:3072 sc1 lds
    s_waitcnt vmcnt(32)
    v_mov_b32 v104, s12
    v_subrev_u32 v104, 1, v104
    v_max_u32 v105, v105, v104
    ds_write_b32 v7, v105
    s_add_u32 s11, s11, 8192
    s_and_b32 s11, s11, 0x1ffff
    s_add_u32 s15, s15, 16384
    s_and_b32 s15, s15, 0x1ffff
    s_add_u32 s12, s12, 1
    s_cmp_lt_u32 s12, 16
    s_cbranch_scc1 L_mm_kernel_kv_35
    s_mov_b32 s12, 15
    s_waitcnt vmcnt(16)
    v_mov_b32 v104, s12
    v_max_u32 v105, v105, v104
    ds_write_b32 v7, v105
    s_mov_b32 s12, 99
    s_waitcnt vmcnt(0)
    v_mov_b32 v104, s12
    v_max_u32 v105, v105, v104
    ds_write_b32 v7, v105
    v_add_u32 v18, 0, v1
    s_getpc_b64 s[16:17]
L_mm_kernel_pc_42:
    s_add_u32 s16, s16, L_mm_second-L_mm_kernel_pc_42
    s_addc_u32 s17, s17, 0
    v_lshlrev_b32 v100, 7, v18
    v_min_u32 v100, L_mm_kernel_codeend-L_mm_second-4, v100
    v_mov_b32 v101, s17
    v_add_co_u32 v100, vcc, s16, v100
    s_nop 1
    v_addc_co_u32 v101, vcc, 0, v101, vcc
    global_load_dword v102, v[100:101], off
    v_add_u32 v18, 64, v1
    s_getpc_b64 s[16:17]
L_mm_kernel_pc_43:
    s_add_u32 s16, s16, L_mm_second-L_mm_kernel_pc_43
    s_addc_u32 s17, s17, 0
    v_lshlrev_b32 v100, 7, v18
    v_min_u32 v100, L_mm_kernel_codeend-L_mm_second-4, v100
    v_mov_b32 v101, s17
    v_add_co_u32 v100, vcc, s16, v100
    s_nop 1
    v_addc_co_u32 v101, vcc, 0, v101, vcc
    global_load_dword v102, v[100:101], off
    v_add_u32 v18, 128, v1
    s_getpc_b64 s[16:17]
L_mm_kernel_pc_44:
    s_add_u32 s16, s16, L_mm_second-L_mm_kernel_pc_44
    s_addc_u32 s17, s17, 0
    v_lshlrev_b32 v100, 7, v18
    v_min_u32 v100, L_mm_kernel_codeend-L_mm_second-4, v100
    v_mov_b32 v101, s17
    v_add_co_u32 v100, vcc, s16, v100
    s_nop 1
    v_addc_co_u32 v101, vcc, 0, v101, vcc
    global_load_dword v102, v[100:101], off
    s_branch L_mm_kernel_done_30
L_mm_kernel_side_28:
    s_load_dwordx2 s[8:9], s[0:1], 16
    s_load_dwordx4 s[32:35], s[0:1], 32
    s_load_dwordx2 s[36:37], s[0:1], 56
    s_load_dwordx2 s[82:83], s[0:1], 72
    s_lshl_b32 s46, s2, 1
    s_add_u32 s46, s46, s3
    s_sub_u32 s46, s46, 2
    s_lshl_b32 s47, s3, 13
    s_add_u32 s47, s47, 126976
    v_lshrrev_b32 v9, 3, v1
    v_and_b32 v10, 7, v1
    v_lshlrev_b32 v10, 4, v10
    v_bfe_u32 v2, v1, 2, 2
    v_and_b32 v3, 3, v1
    v_lshlrev_b32 v3, 3, v3
    v_lshl_add_u32 v3, v2, 7, v3
    v_add_u32 v3, s47, v3
    v_lshrrev_b32 v2, 5, v1
    v_lshl_add_u32 v11, v2, 10, v3
    v_bfe_u32 v2, v1, 4, 1
    v_lshl_add_u32 v11, v2, 5, v11
    v_lshrrev_b32 v2, 4, v1
    v_lshl_add_u32 v12, v2, 10, v3
    v_lshlrev_b32 v13, 4, v2
    v_and_b32 v2, 15, v1
    v_lshl_add_u32 v13, v2, 7, v13
    v_add_u32 v13, s47, v13
    s_waitcnt lgkmcnt(0)
    s_barrier
    s_mov_b32 s14, 3
    s_mov_b32 s4, 0
L_mm_kernel_w_45:
    ds_read_b32 v100, v7 offset:0
    s_add_u32 s4, s4, 1
    s_waitcnt lgkmcnt(0)
    v_readfirstlane_b32 s5, v100
    s_nop 0
    s_cmp_gt_u32 s5, s14
    s_cbranch_scc1 L_mm_kernel_g_46
    s_sleep 24
    s_cmp_lt_u32 s4, 0x1000000
    s_cbranch_scc1 L_mm_kernel_w_45
L_mm_kernel_g_46:
    s_cmp_eq_u32 s3, 1
    s_cbranch_scc1 L_mm_kernel_gemv_29
    s_add_u32 s41, s46, 0
    s_lshr_b32 s38, s41, 4
    s_and_b32 s39, s41, 15
    s_cmp_ge_u32 s41, 512
    s_cselect_b32 s40, 2130706432, 0
    s_mov_b32 s72, s8
    s_mov_b32 s73, s9
    s_mov_b32 s74, 2097152
    s_mov_b32 s75, 0x20000
    s_mov_b32 s42, 2048
    v_mul_lo_u32 v14, v9, s42
    v_add_u32 v14, v14, v10
    s_mul_i32 s42, s38, 65536
    s_lshl_b32 s41, s39, 7
    s_add_u32 s42, s42, s41
    s_or_b32 s42, s42, s40
    s_add_u32 m0, s47, 0
    s_add_u32 s41, s42, 0
    buffer_load_dwordx4 v14, s[72:75], s41 offen lds
    s_add_u32 m0, s47, 1024
    s_add_u32 s41, s42, 16384
    buffer_load_dwordx4 v14, s[72:75], s41 offen lds
    s_add_u32 m0, s47, 2048
    s_add_u32 s41, s42, 32768
    buffer_load_dwordx4 v14, s[72:75], s41 offen lds
    s_add_u32 m0, s47, 3072
    s_add_u32 s41, s42, 49152
    buffer_load_dwordx4 v14, s[72:75], s41 offen lds
    s_add_u32 s41, s46, 0
    s_mul_i32 s38, s41, 9363
    s_lshr_b32 s38, s38, 19
    s_mul_i32 s39, s38, 56
    s_sub_u32 s39, s41, s39
    s_cmp_ge_u32 s41, 1792
    s_cselect_b32 s40, 2130706432, 0
    s_mov_b32 s72, s32
    s_mov_b32 s73, s33
    s_mov_b32 s74, 7340032
    s_mov_b32 s75, 0x20000
    s_mov_b32 s42, 7168
    v_mul_lo_u32 v14, v9, s42
    v_add_u32 v14, v14, v10
    s_mul_i32 s42, s38, 229376
    s_lshl_b32 s41, s39, 7
    s_add_u32 s42, s42, s41
    s_or_b32 s42, s42, s40
    s_add_u32 m0, s47, 4096
    s_add_u32 s41, s42, 0
    buffer_load_dwordx4 v14, s[72:75], s41 offen lds
    s_add_u32 m0, s47, 5120
    s_add_u32 s41, s42, 57344
    buffer_load_dwordx4 v14, s[72:75], s41 offen lds
    s_add_u32 m0, s47, 6144
    s_add_u32 s41, s42, 114688
    buffer_load_dwordx4 v14, s[72:75], s41 offen lds
    s_add_u32 m0, s47, 7168
    s_add_u32 s41, s42, 172032
    buffer_load_dwordx4 v14, s[72:75], s41 offen lds
    s_waitcnt vmcnt(4)
    ds_read_b64_tr_b16 v[80:81], v12 offset:0
    ds_read_b64_tr_b16 v[82:83], v12 offset:512
    ds_read_b64_tr_b16 v[84:85], v12 offset:32
    ds_read_b64_tr_b16 v[86:87], v12 offset:544
    ds_read_b64_tr_b16 v[88:89], v12 offset:64
    ds_read_b64_tr_b16 v[90:91], v12 offset:576
    ds_read_b64_tr_b16 v[92:93], v12 offset:96
    ds_read_b64_tr_b16 v[94:95], v12 offset:608
    s_add_u32 s41, s46, 0
    s_lshr_b32 s38, s41, 4
    s_and_b32 s39, s41, 15
    s_cmp_ge_u32 s41, 512
    s_cselect_b32 s40, 2130706432, 0
    s_add_u32 s76, s6, 58720256
    s_addc_u32 s77, s7, 0
    s_mov_b32 s78, 2097152
    s_mov_b32 s79, 0x20000
    s_mul_i32 s42, s39, 131072
    s_lshl_b32 s41, s38, 12
    s_add_u32 s42, s42, s41
    s_or_b32 s42, s42, s40
    s_waitcnt lgkmcnt(0)
    buffer_store_dwordx4 v[80:83], v4, s[76:79], s42 offen offset:0 sc1
    buffer_store_dwordx4 v[84:87], v4, s[76:79], s42 offen offset:1024 sc1
    buffer_store_dwordx4 v[88:91], v4, s[76:79], s42 offen offset:2048 sc1
    buffer_store_dwordx4 v[92:95], v4, s[76:79], s42 offen offset:3072 sc1
    s_add_u32 s41, s46, 512
    s_mul_i32 s38, s41, 9363
    s_lshr_b32 s38, s38, 19
    s_mul_i32 s39, s38, 56
    s_sub_u32 s39, s41, s39
    s_cmp_ge_u32 s41, 1792
    s_cselect_b32 s40, 2130706432, 0
    s_mov_b32 s72, s32
    s_mov_b32 s73, s33
    s_mov_b32 s74, 7340032
    s_mov_b32 s75, 0x20000
    s_mov_b32 s42, 7168
    v_mul_lo_u32 v14, v9, s42
    v_add_u32 v14, v14, v10
    s_mul_i32 s42, s38, 229376
    s_lshl_b32 s41, s39, 7
    s_add_u32 s42, s42, s41
    s_or_b32 s42, s42, s40
    s_add_u32 m0, s47, 0
    s_add_u32 s41, s42, 0
    buffer_load_dwordx4 v14, s[72:75], s41 offen lds
    s_add_u32 m0, s47, 1024
    s_add_u32 s41, s42, 57344
    buffer_load_dwordx4 v14, s[72:75], s41 offen lds
    s_add_u32 m0, s47, 2048
    s_add_u32 s41, s42, 114688
    buffer_load_dwordx4 v14, s[72:75], s41 offen lds
    s_add_u32 m0, s47, 3072
    s_add_u32 s41, s42, 172032
    buffer_load_dwordx4 v14, s[72:75], s41 offen lds
    s_waitcnt vmcnt(8)
    ds_read_b64_tr_b16 v[80:81], v12 offset:4096
    ds_read_b64_tr_b16 v[82:83], v12 offset:4608
    ds_read_b64_tr_b16 v[84:85], v12 offset:4128
    ds_read_b64_tr_b16 v[86:87], v12 offset:4640
    ds_read_b64_tr_b16 v[88:89], v12 offset:4160
    ds_read_b64_tr_b16 v[90:91], v12 offset:4672
    ds_read_b64_tr_b16 v[92:93], v12 offset:4192
    ds_read_b64_tr_b16 v[94:95], v12 offset:4704
    s_add_u32 s41, s46, 0
    s_mul_i32 s38, s41, 9363
    s_lshr_b32 s38, s38, 19
    s_mul_i32 s39, s38, 56
    s_sub_u32 s39, s41, s39
    s_cmp_ge_u32 s41, 1792
    s_cselect_b32 s40, 2130706432, 0
    s_add_u32 s76, s6, 65011712
    s_addc_u32 s77, s7, 0
    s_mov_b32 s78, 7340032
    s_mov_b32 s79, 0x20000
    s_cmp_ge_u32 s39, 28
    s_cselect_b32 s16, 28, 0
    s_cselect_b32 s17, 7168, 0
    s_sub_u32 s16, s39, s16
    s_lshl_b32 s16, s16, 2
    s_mul_i32 s41, s38, 14336
    s_add_u32 s17, s17, s41
    s_or_b32 s17, s17, s40
    s_add_u32 s41, s16, 0
    s_mul_i32 s42, s41, 147
    s_lshr_b32 s42, s42, 10
    s_mul_i32 s42, s42, 451584
    s_lshl_b32 s41, s41, 10
    s_add_u32 s41, s41, s42
    s_add_u32 s28, s41, s17
    s_add_u32 s41, s16, 1
    s_mul_i32 s42, s41, 147
    s_lshr_b32 s42, s42, 10
    s_mul_i32 s42, s42, 451584
    s_lshl_b32 s41, s41, 10
    s_add_u32 s41, s41, s42
    s_add_u32 s29, s41, s17
    s_add_u32 s41, s16, 2
    s_mul_i32 s42, s41, 147
    s_lshr_b32 s42, s42, 10
    s_mul_i32 s42, s42, 451584
    s_lshl_b32 s41, s41, 10
    s_add_u32 s41, s41, s42
    s_add_u32 s30, s41, s17
    s_add_u32 s41, s16, 3
    s_mul_i32 s42, s41, 147
    s_lshr_b32 s42, s42, 10
    s_mul_i32 s42, s42, 451584
    s_lshl_b32 s41, s41, 10
    s_add_u32 s41, s41, s42
    s_add_u32 s31, s41, s17
    s_waitcnt lgkmcnt(0)
    buffer_store_dwordx4 v[80:83], v4, s[76:79], s28 offen offset:0 sc1
    buffer_store_dwordx4 v[84:87], v4, s[76:79], s29 offen offset:0 sc1
    buffer_store_dwordx4 v[88:91], v4, s[76:79], s30 offen offset:0 sc1
    buffer_store_dwordx4 v[92:95], v4, s[76:79], s31 offen offset:0 sc1
    s_add_u32 s41, s46, 1024
    s_mul_i32 s38, s41, 9363
    s_lshr_b32 s38, s38, 19
    s_mul_i32 s39, s38, 56
    s_sub_u32 s39, s41, s39
    s_cmp_ge_u32 s41, 1792
    s_cselect_b32 s40, 2130706432, 0
    s_mov_b32 s72, s32
    s_mov_b32 s73, s33
    s_mov_b32 s74, 7340032
    s_mov_b32 s75, 0x20000
    s_mov_b32 s42, 7168
    v_mul_lo_u32 v14, v9, s42
    v_add_u32 v14, v14, v10
    s_mul_i32 s42, s38, 229376
    s_lshl_b32 s41, s39, 7
    s_add_u32 s42, s42, s41
    s_or_b32 s42, s42, s40
    s_add_u32 m0, s47, 4096
    s_add_u32 s41, s42, 0
    buffer_load_dwordx4 v14, s[72:75], s41 offen lds
    s_add_u32 m0, s47, 5120
    s_add_u32 s41, s42, 57344
    buffer_load_dwordx4 v14, s[72:75], s41 offen lds
    s_add_u32 m0, s47, 6144
    s_add_u32 s41, s42, 114688
    buffer_load_dwordx4 v14, s[72:75], s41 offen lds
    s_add_u32 m0, s47, 7168
    s_add_u32 s41, s42, 172032
    buffer_load_dwordx4 v14, s[72:75], s41 offen lds
    s_waitcnt vmcnt(8)
    ds_read_b64_tr_b16 v[80:81], v12 offset:0
    ds_read_b64_tr_b16 v[82:83], v12 offset:512
    ds_read_b64_tr_b16 v[84:85], v12 offset:32
    ds_read_b64_tr_b16 v[86:87], v12 offset:544
    ds_read_b64_tr_b16 v[88:89], v12 offset:64
    ds_read_b64_tr_b16 v[90:91], v12 offset:576
    ds_read_b64_tr_b16 v[92:93], v12 offset:96
    ds_read_b64_tr_b16 v[94:95], v12 offset:608
    s_add_u32 s41, s46, 512
    s_mul_i32 s38, s41, 9363
    s_lshr_b32 s38, s38, 19
    s_mul_i32 s39, s38, 56
    s_sub_u32 s39, s41, s39
    s_cmp_ge_u32 s41, 1792
    s_cselect_b32 s40, 2130706432, 0
    s_add_u32 s76, s6, 65011712
    s_addc_u32 s77, s7, 0
    s_mov_b32 s78, 7340032
    s_mov_b32 s79, 0x20000
    s_cmp_ge_u32 s39, 28
    s_cselect_b32 s16, 28, 0
    s_cselect_b32 s17, 7168, 0
    s_sub_u32 s16, s39, s16
    s_lshl_b32 s16, s16, 2
    s_mul_i32 s41, s38, 14336
    s_add_u32 s17, s17, s41
    s_or_b32 s17, s17, s40
    s_add_u32 s41, s16, 0
    s_mul_i32 s42, s41, 147
    s_lshr_b32 s42, s42, 10
    s_mul_i32 s42, s42, 451584
    s_lshl_b32 s41, s41, 10
    s_add_u32 s41, s41, s42
    s_add_u32 s28, s41, s17
    s_add_u32 s41, s16, 1
    s_mul_i32 s42, s41, 147
    s_lshr_b32 s42, s42, 10
    s_mul_i32 s42, s42, 451584
    s_lshl_b32 s41, s41, 10
    s_add_u32 s41, s41, s42
    s_add_u32 s29, s41, s17
    s_add_u32 s41, s16, 2
    s_mul_i32 s42, s41, 147
    s_lshr_b32 s42, s42, 10
    s_mul_i32 s42, s42, 451584
    s_lshl_b32 s41, s41, 10
    s_add_u32 s41, s41, s42
    s_add_u32 s30, s41, s17
    s_add_u32 s41, s16, 3
    s_mul_i32 s42, s41, 147
    s_lshr_b32 s42, s42, 10
    s_mul_i32 s42, s42, 451584
    s_lshl_b32 s41, s41, 10
    s_add_u32 s41, s41, s42
    s_add_u32 s31, s41, s17
    s_waitcnt lgkmcnt(0)
    buffer_store_dwordx4 v[80:83], v4, s[76:79], s28 offen offset:0 sc1
    buffer_store_dwordx4 v[84:87], v4, s[76:79], s29 offen offset:0 sc1
    buffer_store_dwordx4 v[88:91], v4, s[76:79], s30 offen offset:0 sc1
    buffer_store_dwordx4 v[92:95], v4, s[76:79], s31 offen offset:0 sc1
    s_add_u32 s41, s46, 1536
    s_mul_i32 s38, s41, 9363
    s_lshr_b32 s38, s38, 19
    s_mul_i32 s39, s38, 56
    s_sub_u32 s39, s41, s39
    s_cmp_ge_u32 s41, 1792
    s_cselect_b32 s40, 2130706432, 0
    s_mov_b32 s72, s32
    s_mov_b32 s73, s33
    s_mov_b32 s74, 7340032
    s_mov_b32 s75, 0x20000
    s_mov_b32 s42, 7168
    v_mul_lo_u32 v14, v9, s42
    v_add_u32 v14, v14, v10
    s_mul_i32 s42, s38, 229376
    s_lshl_b32 s41, s39, 7
    s_add_u32 s42, s42, s41
    s_or_b32 s42, s42, s40
    s_add_u32 m0, s47, 0
    s_add_u32 s41, s42, 0
    buffer_load_dwordx4 v14, s[72:75], s41 offen lds
    s_add_u32 m0, s47, 1024
    s_add_u32 s41, s42, 57344
    buffer_load_dwordx4 v14, s[72:75], s41 offen lds
    s_add_u32 m0, s47, 2048
    s_add_u32 s41, s42, 114688
    buffer_load_dwordx4 v14, s[72:75], s41 offen lds
    s_add_u32 m0, s47, 3072
    s_add_u32 s41, s42, 172032
    buffer_load_dwordx4 v14, s[72:75], s41 offen lds
    s_waitcnt vmcnt(8)
    ds_read_b64_tr_b16 v[80:81], v12 offset:4096
    ds_read_b64_tr_b16 v[82:83], v12 offset:4608
    ds_read_b64_tr_b16 v[84:85], v12 offset:4128
    ds_read_b64_tr_b16 v[86:87], v12 offset:4640
    ds_read_b64_tr_b16 v[88:89], v12 offset:4160
    ds_read_b64_tr_b16 v[90:91], v12 offset:4672
    ds_read_b64_tr_b16 v[92:93], v12 offset:4192
    ds_read_b64_tr_b16 v[94:95], v12 offset:4704
    s_add_u32 s41, s46, 1024
    s_mul_i32 s38, s41, 9363
    s_lshr_b32 s38, s38, 19
    s_mul_i32 s39, s38, 56
    s_sub_u32 s39, s41, s39
    s_cmp_ge_u32 s41, 1792
    s_cselect_b32 s40, 2130706432, 0
    s_add_u32 s76, s6, 65011712
    s_addc_u32 s77, s7, 0
    s_mov_b32 s78, 7340032
    s_mov_b32 s79, 0x20000
    s_cmp_ge_u32 s39, 28
    s_cselect_b32 s16, 28, 0
    s_cselect_b32 s17, 7168, 0
    s_sub_u32 s16, s39, s16
    s_lshl_b32 s16, s16, 2
    s_mul_i32 s41, s38, 14336
    s_add_u32 s17, s17, s41
    s_or_b32 s17, s17, s40
    s_add_u32 s41, s16, 0
    s_mul_i32 s42, s41, 147
    s_lshr_b32 s42, s42, 10
    s_mul_i32 s42, s42, 451584
    s_lshl_b32 s41, s41, 10
    s_add_u32 s41, s41, s42
    s_add_u32 s28, s41, s17
    s_add_u32 s41, s16, 1
    s_mul_i32 s42, s41, 147
    s_lshr_b32 s42, s42, 10
    s_mul_i32 s42, s42, 451584
    s_lshl_b32 s41, s41, 10
    s_add_u32 s41, s41, s42
    s_add_u32 s29, s41, s17
    s_add_u32 s41, s16, 2
    s_mul_i32 s42, s41, 147
    s_lshr_b32 s42, s42, 10
    s_mul_i32 s42, s42, 451584
    s_lshl_b32 s41, s41, 10
    s_add_u32 s41, s41, s42
    s_add_u32 s30, s41, s17
    s_add_u32 s41, s16, 3
    s_mul_i32 s42, s41, 147
    s_lshr_b32 s42, s42, 10
    s_mul_i32 s42, s42, 451584
    s_lshl_b32 s41, s41, 10
    s_add_u32 s41, s41, s42
    s_add_u32 s31, s41, s17
    s_waitcnt lgkmcnt(0)
    buffer_store_dwordx4 v[80:83], v4, s[76:79], s28 offen offset:0 sc1
    buffer_store_dwordx4 v[84:87], v4, s[76:79], s29 offen offset:0 sc1
    buffer_store_dwordx4 v[88:91], v4, s[76:79], s30 offen offset:0 sc1
    buffer_store_dwordx4 v[92:95], v4, s[76:79], s31 offen offset:0 sc1
    s_waitcnt vmcnt(4)
    ds_read_b64_tr_b16 v[80:81], v12 offset:0
    ds_read_b64_tr_b16 v[82:83], v12 offset:512
    ds_read_b64_tr_b16 v[84:85], v12 offset:32
    ds_read_b64_tr_b16 v[86:87], v12 offset:544
    ds_read_b64_tr_b16 v[88:89], v12 offset:64
    ds_read_b64_tr_b16 v[90:91], v12 offset:576
    ds_read_b64_tr_b16 v[92:93], v12 offset:96
    ds_read_b64_tr_b16 v[94:95], v12 offset:608
    s_add_u32 s41, s46, 1536
    s_mul_i32 s38, s41, 9363
    s_lshr_b32 s38, s38, 19
    s_mul_i32 s39, s38, 56
    s_sub_u32 s39, s41, s39
    s_cmp_ge_u32 s41, 1792
    s_cselect_b32 s40, 2130706432, 0
    s_add_u32 s76, s6, 65011712
    s_addc_u32 s77, s7, 0
    s_mov_b32 s78, 7340032
    s_mov_b32 s79, 0x20000
    s_cmp_ge_u32 s39, 28
    s_cselect_b32 s16, 28, 0
    s_cselect_b32 s17, 7168, 0
    s_sub_u32 s16, s39, s16
    s_lshl_b32 s16, s16, 2
    s_mul_i32 s41, s38, 14336
    s_add_u32 s17, s17, s41
    s_or_b32 s17, s17, s40
    s_add_u32 s41, s16, 0
    s_mul_i32 s42, s41, 147
    s_lshr_b32 s42, s42, 10
    s_mul_i32 s42, s42, 451584
    s_lshl_b32 s41, s41, 10
    s_add_u32 s41, s41, s42
    s_add_u32 s28, s41, s17
    s_add_u32 s41, s16, 1
    s_mul_i32 s42, s41, 147
    s_lshr_b32 s42, s42, 10
    s_mul_i32 s42, s42, 451584
    s_lshl_b32 s41, s41, 10
    s_add_u32 s41, s41, s42
    s_add_u32 s29, s41, s17
    s_add_u32 s41, s16, 2
    s_mul_i32 s42, s41, 147
    s_lshr_b32 s42, s42, 10
    s_mul_i32 s42, s42, 451584
    s_lshl_b32 s41, s41, 10
    s_add_u32 s41, s41, s42
    s_add_u32 s30, s41, s17
    s_add_u32 s41, s16, 3
    s_mul_i32 s42, s41, 147
    s_lshr_b32 s42, s42, 10
    s_mul_i32 s42, s42, 451584
    s_lshl_b32 s41, s41, 10
    s_add_u32 s41, s41, s42
    s_add_u32 s31, s41, s17
    s_waitcnt lgkmcnt(0)
    buffer_store_dwordx4 v[80:83], v4, s[76:79], s28 offen offset:0 sc1
    buffer_store_dwordx4 v[84:87], v4, s[76:79], s29 offen offset:0 sc1
    buffer_store_dwordx4 v[88:91], v4, s[76:79], s30 offen offset:0 sc1
    buffer_store_dwordx4 v[92:95], v4, s[76:79], s31 offen offset:0 sc1
    s_branch L_mm_kernel_sdone_31
L_mm_kernel_gemv_29:
    s_lshr_b32 s14, s2, 2
    s_add_u32 s14, s14, 32
    s_and_b32 s15, s2, 3
    s_mov_b32 s72, s82
    s_mov_b32 s73, s83
    s_mov_b32 s74, 12582912
    s_mov_b32 s75, 0x20000
    s_add_u32 s76, s6, 135168
    s_addc_u32 s77, s7, 0
    s_mov_b32 s78, 2048
    s_mov_b32 s79, 0x20000
    s_mul_i32 s42, s15, 3145728
    s_lshl_b32 s41, s14, 7
    s_add_u32 s42, s42, s41
    s_mov_b32 s41, 12288
    v_mul_lo_u32 v14, v9, s41
    v_add_u32 v14, v14, v10
    v_mul_lo_u32 v16, v1, s41
    v_lshrrev_b32 v17, 4, v1
    v_lshlrev_b32 v17, 4, v17
    s_lshl_b32 s40, s15, 9
    buffer_load_dwordx4 v[24:27], v17, s[76:79], s40 offen offset:0
    buffer_load_dwordx4 v[28:31], v17, s[76:79], s40 offen offset:64
    buffer_load_dwordx4 v[32:35], v17, s[76:79], s40 offen offset:128
    buffer_load_dwordx4 v[36:39], v17, s[76:79], s40 offen offset:192
    buffer_load_dwordx4 v[40:43], v17, s[76:79], s40 offen offset:256
    buffer_load_dwordx4 v[44:47], v17, s[76:79], s40 offen offset:320
    buffer_load_dwordx4 v[48:51], v17, s[76:79], s40 offen offset:384
    buffer_load_dwordx4 v[52:55], v17, s[76:79], s40 offen offset:448
    v_mov_b32 v56, 0
    v_mov_b32 v57, 0
    v_mov_b32 v58, 0
    v_mov_b32 v59, 0
    v_mov_b32 v60, 0
    v_mov_b32 v61, 0
    v_mov_b32 v62, 0
    v_mov_b32 v63, 0
    v_mov_b32 v64, 0
    v_mov_b32 v65, 0
    v_mov_b32 v66, 0
    v_mov_b32 v67, 0
    v_mov_b32 v68, 0
    v_mov_b32 v69, 0
    v_mov_b32 v70, 0
    v_mov_b32 v71, 0
    s_add_u32 m0, s47, 0
    s_add_u32 s41, s42, 0
    buffer_load_dwordx4 v14, s[72:75], s41 offen lds
    s_add_u32 m0, s47, 1024
    s_add_u32 s41, s42, 98304
    buffer_load_dwordx4 v14, s[72:75], s41 offen lds
    s_add_u32 m0, s47, 2048
    s_add_u32 s41, s42, 196608
    buffer_load_dwordx4 v14, s[72:75], s41 offen lds
    s_add_u32 m0, s47, 3072
    s_add_u32 s41, s42, 294912
    buffer_load_dwordx4 v14, s[72:75], s41 offen lds
    s_add_u32 m0, s47, 4096
    s_add_u32 s41, s42, 393216
    buffer_load_dwordx4 v14, s[72:75], s41 offen lds
    s_add_u32 m0, s47, 5120
    s_add_u32 s41, s42, 491520
    buffer_load_dwordx4 v14, s[72:75], s41 offen lds
    s_add_u32 m0, s47, 6144
    s_add_u32 s41, s42, 589824
    buffer_load_dwordx4 v14, s[72:75], s41 offen lds
    s_add_u32 m0, s47, 7168
    s_add_u32 s41, s42, 688128
    buffer_load_dwordx4 v14, s[72:75], s41 offen lds
    s_waitcnt vmcnt(4)
    ds_read_b64_tr_b16 v[80:81], v12 offset:0
    ds_read_b64_tr_b16 v[82:83], v12 offset:512
    ds_read_b64_tr_b16 v[84:85], v12 offset:32
    ds_read_b64_tr_b16 v[86:87], v12 offset:544
    ds_read_b64_tr_b16 v[88:89], v12 offset:64
    ds_read_b64_tr_b16 v[90:91], v12 offset:576
    ds_read_b64_tr_b16 v[92:93], v12 offset:96
    ds_read_b64_tr_b16 v[94:95], v12 offset:608
    s_waitcnt lgkmcnt(0)
    s_add_u32 m0, s47, 0
    s_add_u32 s41, s42, 786432
    buffer_load_dwordx4 v14, s[72:75], s41 offen lds
    s_add_u32 m0, s47, 1024
    s_add_u32 s41, s42, 884736
    buffer_load_dwordx4 v14, s[72:75], s41 offen lds
    s_add_u32 m0, s47, 2048
    s_add_u32 s41, s42, 983040
    buffer_load_dwordx4 v14, s[72:75], s41 offen lds
    s_add_u32 m0, s47, 3072
    s_add_u32 s41, s42, 1081344
    buffer_load_dwordx4 v14, s[72:75], s41 offen lds
    v_mfma_f32_16x16x32_bf16 v[56:59], v[80:83], v[24:27], v[56:59]
    v_mfma_f32_16x16x32_bf16 v[60:63], v[84:87], v[24:27], v[60:63]
    v_mfma_f32_16x16x32_bf16 v[64:67], v[88:91], v[24:27], v[64:67]
    v_mfma_f32_16x16x32_bf16 v[68:71], v[92:95], v[24:27], v[68:71]
    s_waitcnt vmcnt(4)
    ds_read_b64_tr_b16 v[80:81], v12 offset:4096
    ds_read_b64_tr_b16 v[82:83], v12 offset:4608
    ds_read_b64_tr_b16 v[84:85], v12 offset:4128
    ds_read_b64_tr_b16 v[86:87], v12 offset:4640
    ds_read_b64_tr_b16 v[88:89], v12 offset:4160
    ds_read_b64_tr_b16 v[90:91], v12 offset:4672
    ds_read_b64_tr_b16 v[92:93], v12 offset:4192
    ds_read_b64_tr_b16 v[94:95], v12 offset:4704
    s_waitcnt lgkmcnt(0)
    s_add_u32 m0, s47, 4096
    s_add_u32 s41, s42, 1179648
    buffer_load_dwordx4 v14, s[72:75], s41 offen lds
    s_add_u32 m0, s47, 5120
    s_add_u32 s41, s42, 1277952
    buffer_load_dwordx4 v14, s[72:75], s41 offen lds
    s_add_u32 m0, s47, 6144
    s_add_u32 s41, s42, 1376256
    buffer_load_dwordx4 v14, s[72:75], s41 offen lds
    s_add_u32 m0, s47, 7168
    s_add_u32 s41, s42, 1474560
    buffer_load_dwordx4 v14, s[72:75], s41 offen lds
    v_mfma_f32_16x16x32_bf16 v[56:59], v[80:83], v[28:31], v[56:59]
    v_mfma_f32_16x16x32_bf16 v[60:63], v[84:87], v[28:31], v[60:63]
    v_mfma_f32_16x16x32_bf16 v[64:67], v[88:91], v[28:31], v[64:67]
    v_mfma_f32_16x16x32_bf16 v[68:71], v[92:95], v[28:31], v[68:71]
    s_waitcnt vmcnt(4)
    ds_read_b64_tr_b16 v[80:81], v12 offset:0
    ds_read_b64_tr_b16 v[82:83], v12 offset:512
    ds_read_b64_tr_b16 v[84:85], v12 offset:32
    ds_read_b64_tr_b16 v[86:87], v12 offset:544
    ds_read_b64_tr_b16 v[88:89], v12 offset:64
    ds_read_b64_tr_b16 v[90:91], v12 offset:576
    ds_read_b64_tr_b16 v[92:93], v12 offset:96
    ds_read_b64_tr_b16 v[94:95], v12 offset:608
    s_waitcnt lgkmcnt(0)
    s_add_u32 m0, s47, 0
    s_add_u32 s41, s42, 1572864
    buffer_load_dwordx4 v14, s[72:75], s41 offen lds
    s_add_u32 m0, s47, 1024
    s_add_u32 s41, s42, 1671168
    buffer_load_dwordx4 v14, s[72:75], s41 offen lds
    s_add_u32 m0, s47, 2048
    s_add_u32 s41, s42, 1769472
    buffer_load_dwordx4 v14, s[72:75], s41 offen lds
    s_add_u32 m0, s47, 3072
    s_add_u32 s41, s42, 1867776
    buffer_load_dwordx4 v14, s[72:75], s41 offen lds
    v_mfma_f32_16x16x32_bf16 v[56:59], v[80:83], v[32:35], v[56:59]
    v_mfma_f32_16x16x32_bf16 v[60:63], v[84:87], v[32:35], v[60:63]
    v_mfma_f32_16x16x32_bf16 v[64:67], v[88:91], v[32:35], v[64:67]
    v_mfma_f32_16x16x32_bf16 v[68:71], v[92:95], v[32:35], v[68:71]
    s_waitcnt vmcnt(4)
    ds_read_b64_tr_b16 v[80:81], v12 offset:4096
    ds_read_b64_tr_b16 v[82:83], v12 offset:4608
    ds_read_b64_tr_b16 v[84:85], v12 offset:4128
    ds_read_b64_tr_b16 v[86:87], v12 offset:4640
    ds_read_b64_tr_b16 v[88:89], v12 offset:4160
    ds_read_b64_tr_b16 v[90:91], v12 offset:4672
    ds_read_b64_tr_b16 v[92:93], v12 offset:4192
    ds_read_b64_tr_b16 v[94:95], v12 offset:4704
    s_waitcnt lgkmcnt(0)
    s_add_u32 m0, s47, 4096
    s_add_u32 s41, s42, 1966080
    buffer_load_dwordx4 v14, s[72:75], s41 offen lds
    s_add_u32 m0, s47, 5120
    s_add_u32 s41, s42, 2064384
    buffer_load_dwordx4 v14, s[72:75], s41 offen lds
    s_add_u32 m0, s47, 6144
    s_add_u32 s41, s42, 2162688
    buffer_load_dwordx4 v14, s[72:75], s41 offen lds
    s_add_u32 m0, s47, 7168
    s_add_u32 s41, s42, 2260992
    buffer_load_dwordx4 v14, s[72:75], s41 offen lds
    v_mfma_f32_16x16x32_bf16 v[56:59], v[80:83], v[36:39], v[56:59]
    v_mfma_f32_16x16x32_bf16 v[60:63], v[84:87], v[36:39], v[60:63]
    v_mfma_f32_16x16x32_bf16 v[64:67], v[88:91], v[36:39], v[64:67]
    v_mfma_f32_16x16x32_bf16 v[68:71], v[92:95], v[36:39], v[68:71]
    s_waitcnt vmcnt(4)
    ds_read_b64_tr_b16 v[80:81], v12 offset:0
    ds_read_b64_tr_b16 v[82:83], v12 offset:512
    ds_read_b64_tr_b16 v[84:85], v12 offset:32
    ds_read_b64_tr_b16 v[86:87], v12 offset:544
    ds_read_b64_tr_b16 v[88:89], v12 offset:64
    ds_read_b64_tr_b16 v[90:91], v12 offset:576
    ds_read_b64_tr_b16 v[92:93], v12 offset:96
    ds_read_b64_tr_b16 v[94:95], v12 offset:608
    s_waitcnt lgkmcnt(0)
    s_add_u32 m0, s47, 0
    s_add_u32 s41, s42, 2359296
    buffer_load_dwordx4 v14, s[72:75], s41 offen lds
    s_add_u32 m0, s47, 1024
    s_add_u32 s41, s42, 2457600
    buffer_load_dwordx4 v14, s[72:75], s41 offen lds
    s_add_u32 m0, s47, 2048
    s_add_u32 s41, s42, 2555904
    buffer_load_dwordx4 v14, s[72:75], s41 offen lds
    s_add_u32 m0, s47, 3072
    s_add_u32 s41, s42, 2654208
    buffer_load_dwordx4 v14, s[72:75], s41 offen lds
    v_mfma_f32_16x16x32_bf16 v[56:59], v[80:83], v[40:43], v[56:59]
    v_mfma_f32_16x16x32_bf16 v[60:63], v[84:87], v[40:43], v[60:63]
    v_mfma_f32_16x16x32_bf16 v[64:67], v[88:91], v[40:43], v[64:67]
    v_mfma_f32_16x16x32_bf16 v[68:71], v[92:95], v[40:43], v[68:71]
    s_waitcnt vmcnt(4)
    ds_read_b64_tr_b16 v[80:81], v12 offset:4096
    ds_read_b64_tr_b16 v[82:83], v12 offset:4608
    ds_read_b64_tr_b16 v[84:85], v12 offset:4128
    ds_read_b64_tr_b16 v[86:87], v12 offset:4640
    ds_read_b64_tr_b16 v[88:89], v12 offset:4160
    ds_read_b64_tr_b16 v[90:91], v12 offset:4672
    ds_read_b64_tr_b16 v[92:93], v12 offset:4192
    ds_read_b64_tr_b16 v[94:95], v12 offset:4704
    s_waitcnt lgkmcnt(0)
    s_add_u32 m0, s47, 4096
    s_add_u32 s41, s42, 2752512
    buffer_load_dwordx4 v14, s[72:75], s41 offen lds
    s_add_u32 m0, s47, 5120
    s_add_u32 s41, s42, 2850816
    buffer_load_dwordx4 v14, s[72:75], s41 offen lds
    s_add_u32 m0, s47, 6144
    s_add_u32 s41, s42, 2949120
    buffer_load_dwordx4 v14, s[72:75], s41 offen lds
    s_add_u32 m0, s47, 7168
    s_add_u32 s41, s42, 3047424
    buffer_load_dwordx4 v14, s[72:75], s41 offen lds
    v_mfma_f32_16x16x32_bf16 v[56:59], v[80:83], v[44:47], v[56:59]
    v_mfma_f32_16x16x32_bf16 v[60:63], v[84:87], v[44:47], v[60:63]
    v_mfma_f32_16x16x32_bf16 v[64:67], v[88:91], v[44:47], v[64:67]
    v_mfma_f32_16x16x32_bf16 v[68:71], v[92:95], v[44:47], v[68:71]
    s_waitcnt vmcnt(4)
    ds_read_b64_tr_b16 v[80:81], v12 offset:0
    ds_read_b64_tr_b16 v[82:83], v12 offset:512
    ds_read_b64_tr_b16 v[84:85], v12 offset:32
    ds_read_b64_tr_b16 v[86:87], v12 offset:544
    ds_read_b64_tr_b16 v[88:89], v12 offset:64
    ds_read_b64_tr_b16 v[90:91], v12 offset:576
    ds_read_b64_tr_b16 v[92:93], v12 offset:96
    ds_read_b64_tr_b16 v[94:95], v12 offset:608
    s_waitcnt lgkmcnt(0)
    v_mfma_f32_16x16x32_bf16 v[56:59], v[80:83], v[48:51], v[56:59]
    v_mfma_f32_16x16x32_bf16 v[60:63], v[84:87], v[48:51], v[60:63]
    v_mfma_f32_16x16x32_bf16 v[64:67], v[88:91], v[48:51], v[64:67]
    v_mfma_f32_16x16x32_bf16 v[68:71], v[92:95], v[48:51], v[68:71]
    s_waitcnt vmcnt(0)
    ds_read_b64_tr_b16 v[80:81], v12 offset:4096
    ds_read_b64_tr_b16 v[82:83], v12 offset:4608
    ds_read_b64_tr_b16 v[84:85], v12 offset:4128
    ds_read_b64_tr_b16 v[86:87], v12 offset:4640
    ds_read_b64_tr_b16 v[88:89], v12 offset:4160
    ds_read_b64_tr_b16 v[90:91], v12 offset:4672
    ds_read_b64_tr_b16 v[92:93], v12 offset:4192
    ds_read_b64_tr_b16 v[94:95], v12 offset:4704
    s_waitcnt lgkmcnt(0)
    v_mfma_f32_16x16x32_bf16 v[56:59], v[80:83], v[52:55], v[56:59]
    v_mfma_f32_16x16x32_bf16 v[60:63], v[84:87], v[52:55], v[60:63]
    v_mfma_f32_16x16x32_bf16 v[64:67], v[88:91], v[52:55], v[64:67]
    v_mfma_f32_16x16x32_bf16 v[68:71], v[92:95], v[52:55], v[68:71]
    s_add_u32 s76, s6, 0
    s_addc_u32 s77, s7, 0
    s_mov_b32 s78, 98304
    s_mov_b32 s79, 0x20000
    v_and_b32 v2, 15, v1
    v_cmp_eq_u32 vcc, 0, v2
    v_mov_b32 v2, 0x7f000000
    s_nop 0
    v_cndmask_b32 v17, v2, v17, vcc
    s_mul_i32 s41, s15, 24576
    s_lshl_b32 s42, s14, 8
    s_add_u32 s41, s41, s42
    buffer_store_dwordx4 v[56:59], v17, s[76:79], s41 offen offset:0 sc1
    buffer_store_dwordx4 v[60:63], v17, s[76:79], s41 offen offset:64 sc1
    buffer_store_dwordx4 v[64:67], v17, s[76:79], s41 offen offset:128 sc1
    buffer_store_dwordx4 v[68:71], v17, s[76:79], s41 offen offset:192 sc1
L_mm_kernel_sdone_31:
    s_add_u32 s76, s6, 57409536
    s_addc_u32 s77, s7, 0
    s_mov_b32 s78, 1024
    s_mov_b32 s79, 0x20000
    v_mov_b32 v2, 1
    v_mov_b32 v16, 0
    v_mov_b32 v17, 1.0
    s_lshl_b32 s41, s2, 2
    s_waitcnt vmcnt(0)
    s_mov_b64 exec, 1
    ds_add_rtn_u32 v3, v7, v2 offset:12
    s_waitcnt lgkmcnt(0)
    v_cmp_eq_u32 vcc, 2, v3
    s_cbranch_vccz L_mm_kernel_sd2_32
    buffer_store_dword v17, v16, s[76:79], s41 offen sc1
L_mm_kernel_sd2_32:
    s_mov_b64 exec, -1
L_mm_kernel_done_30:
    s_load_dwordx2 s[34:35], s[0:1], 40
    s_load_dwordx2 s[12:13], s[0:1], 56
    ds_read_b32 v100, v7 offset:16
    s_mov_b32 s83, 0
    s_waitcnt lgkmcnt(0)
    v_readfirstlane_b32 s5, v100
    s_nop 0
    s_cmp_gt_u32 s5, 11
    s_cbranch_scc1 L_mm_kernel_late_47
    s_mov_b32 s83, 64
    s_lshl_b32 s48, s2, 2
    s_add_u32 s48, s48, s3
    s_lshr_b32 s49, s48, 4
    s_and_b32 s50, s48, 15
    s_cmp_ge_u32 s48, 896
    s_cselect_b32 s51, 0x7f000000, 0
    s_lshl_b32 s52, s3, 13
    s_add_u32 s52, s52, 131072
    s_mov_b32 s36, s12
    s_mov_b32 s37, s13
    s_mov_b32 s38, 3670016
    s_mov_b32 s39, 0x20000
    v_lshrrev_b32 v20, 3, v1
    v_lshlrev_b32 v20, 11, v20
    v_and_b32 v21, 7, v1
    v_lshl_add_u32 v20, v21, 4, v20
    s_lshl_b32 s53, s49, 16
    s_lshl_b32 s54, s50, 7
    s_add_u32 s53, s53, s54
    s_or_b32 s53, s53, s51
    s_add_u32 m0, s52, 0
    s_add_u32 s54, s53, 0
    buffer_load_dwordx4 v20, s[36:39], s54 offen lds
    s_add_u32 m0, s52, 1024
    s_add_u32 s54, s53, 16384
    buffer_load_dwordx4 v20, s[36:39], s54 offen lds
    s_add_u32 m0, s52, 2048
    s_add_u32 s54, s53, 32768
    buffer_load_dwordx4 v20, s[36:39], s54 offen lds
    s_add_u32 m0, s52, 3072
    s_add_u32 s54, s53, 49152
    buffer_load_dwordx4 v20, s[36:39], s54 offen lds
    s_lshl_b32 s41, s2, 2
    s_add_u32 s41, s41, s3
    s_mov_b32 s72, s34
    s_mov_b32 s73, s35
    s_mov_b32 s74, 8388608
    s_mov_b32 s75, 0x20000
    v_lshlrev_b32 v16, 7, v1
    s_lshl_b32 s42, s41, 13
    buffer_load_dword v104, v16, s[72:75], s42 offen
    s_waitcnt vmcnt(1)
    s_lshl_b32 s48, s2, 2
    s_add_u32 s48, s48, s3
    s_lshr_b32 s49, s48, 4
    s_and_b32 s50, s48, 15
    s_cmp_ge_u32 s48, 896
    s_cselect_b32 s51, 0x7f000000, 0
    s_lshl_b32 s52, s3, 13
    s_add_u32 s52, s52, 131072
    v_bfe_u32 v20, v1, 2, 2
    v_and_b32 v21, 3, v1
    v_lshlrev_b32 v21, 3, v21
    v_lshl_add_u32 v21, v20, 7, v21
    v_lshrrev_b32 v20, 4, v1
    v_lshl_add_u32 v21, v20, 10, v21
    v_add_u32 v21, s52, v21
    ds_read_b64_tr_b16 v[24:25], v21 offset:0
    ds_read_b64_tr_b16 v[26:27], v21 offset:512
    ds_read_b64_tr_b16 v[28:29], v21 offset:32
    ds_read_b64_tr_b16 v[30:31], v21 offset:544
    ds_read_b64_tr_b16 v[32:33], v21 offset:64
    ds_read_b64_tr_b16 v[34:35], v21 offset:576
    ds_read_b64_tr_b16 v[36:37], v21 offset:96
    ds_read_b64_tr_b16 v[38:39], v21 offset:608
    s_add_u32 s36, s6, 60817408
    s_addc_u32 s37, s7, 0
    s_mov_b32 s38, 3670016
    s_mov_b32 s39, 0x20000
    s_mul_i32 s53, s50, 229376
    s_lshl_b32 s54, s49, 12
    s_add_u32 s53, s53, s54
    s_or_b32 s53, s53, s51
    v_lshlrev_b32 v20, 4, v1
    s_waitcnt lgkmcnt(0)
    buffer_store_dwordx4 v[24:27], v20, s[36:39], s53 offen offset:0 sc1
    buffer_store_dwordx4 v[28:31], v20, s[36:39], s53 offen offset:1024 sc1
    buffer_store_dwordx4 v[32:35], v20, s[36:39], s53 offen offset:2048 sc1
    buffer_store_dwordx4 v[36:39], v20, s[36:39], s53 offen offset:3072 sc1
L_mm_kernel_late_47:
    s_branch L_mm_kernel_p2_8
L_mm_second:
    s_load_dwordx2 s[4:5], s[0:1], 0
    s_load_dwordx4 s[8:11], s[0:1], 40
    s_load_dwordx2 s[12:13], s[0:1], 56
    s_load_dwordx2 s[16:17], s[0:1], 80
    s_and_b32 s48, s2, 7
    s_lshr_b32 s49, s2, 3
    s_and_b32 s50, s49, 3
    s_lshr_b32 s51, s49, 2
    s_and_b32 s52, s48, 3
    s_lshl_b32 s52, s52, 2
    s_add_u32 s20, s52, s50
    s_lshr_b32 s52, s48, 2
    s_mul_i32 s52, s52, 8
    s_add_u32 s21, s52, s51
    s_lshr_b32 s22, s20, 1
    s_lshl_b32 s23, s20, 1
    s_add_u32 s14, s21, 1
    s_add_u32 s15, s20, 1
    s_waitcnt lgkmcnt(0)
    s_mov_b32 s36, s4
    s_mov_b32 s37, s5
    s_mov_b32 s38, 4194304
    s_mov_b32 s39, 0x20000
    s_add_u32 s40, s6, 52428800
    s_addc_u32 s41, s7, 0
    s_mov_b32 s42, 4194304
    s_mov_b32 s43, 0x20000
    s_add_u32 s44, s6, 56623104
    s_addc_u32 s45, s7, 0
    s_mov_b32 s46, 262144
    s_mov_b32 s47, 0x20000
    v_lshrrev_b32 v3, 5, v1
    v_and_b32 v13, 48, v1
    v_add_u32 v13, 162688, v13
    v_and_b32 v2, 31, v1
    v_lshlrev_b32 v11, 11, v2
    v_lshl_add_u32 v11, v3, 4, v11
    s_lshl_b32 s60, s20, 18
    s_lshl_b32 s58, s3, 16
    s_add_u32 s60, s60, s58
    s_lshl_b32 s58, s21, 7
    s_add_u32 s60, s60, s58
    s_lshl_b32 s59, s20, 4
    s_add_u32 s59, s59, s21
    s_lshl_b32 s59, s59, 14
    s_lshl_b32 s58, s3, 11
    s_add_u32 s57, s59, s58
    s_add_u32 s55, s57, 8192
    v_bfe_u32 v2, v1, 4, 1
    v_lshlrev_b32 v12, 10, v2
    v_lshl_add_u32 v12, v3, 8, v12
    v_and_b32 v2, 15, v1
    v_lshl_add_u32 v12, v2, 4, v12
    v_add_u32 v15, s58, v12
    v_lshlrev_b32 v14, 3, v1
    s_lshl_b32 s56, s20, 2
    s_add_u32 s56, s56, s3
    s_lshl_b32 s56, s56, 12
    s_lshl_b32 s58, s21, 8
    s_add_u32 s58, s58, s56
    s_mul_i32 s50, s3, 2048
    s_add_u32 s50, s50, 0
    v_lshl_add_u32 v4, v1, 4, s50
    v_lshlrev_b32 v5, 4, v1
    v_add_u32 v5, 65536, v5
    v_mov_b32 v80, 0
    v_mov_b32 v81, 0
    v_mov_b32 v82, 0
    v_mov_b32 v83, 0
    v_mov_b32 v84, 0
    v_mov_b32 v85, 0
    v_mov_b32 v86, 0
    v_mov_b32 v87, 0
    v_mov_b32 v88, 0
    v_mov_b32 v89, 0
    v_mov_b32 v90, 0
    v_mov_b32 v91, 0
    v_mov_b32 v92, 0
    v_mov_b32 v93, 0
    v_mov_b32 v94, 0
    v_mov_b32 v95, 0
    v_mov_b32 v96, 0
    v_mov_b32 v97, 0
    v_mov_b32 v98, 0
    v_mov_b32 v99, 0
    v_mov_b32 v100, 0
    v_mov_b32 v101, 0
    v_mov_b32 v102, 0
    v_mov_b32 v103, 0
    v_mov_b32 v104, 0
    v_mov_b32 v105, 0
    v_mov_b32 v106, 0
    v_mov_b32 v107, 0
    v_mov_b32 v108, 0
    v_mov_b32 v109, 0
    v_mov_b32 v110, 0
    v_mov_b32 v111, 0
    s_mov_b32 s52, 0
    s_mov_b32 s53, 0
    s_mov_b32 s54, 0
    v_add_u32 v6, s52, v4
    v_add_u32 v10, s53, v5
    s_barrier
    ds_read_b128 v[32:35], v6 offset:0
    ds_read_b128 v[36:39], v6 offset:1024
    ds_read_b128 v[48:51], v10 offset:0
    ds_read_b128 v[52:55], v10 offset:1024
    ds_read_b128 v[56:59], v10 offset:2048
    ds_read_b128 v[60:63], v10 offset:3072
    buffer_load_dwordx4 v[196:199], v11, s[36:39], s60 offen offset:0
    buffer_load_dwordx4 v[200:203], v11, s[36:39], s60 offen offset:32
    buffer_load_dwordx4 v[204:207], v11, s[36:39], s60 offen offset:64
    buffer_load_dwordx4 v[208:211], v11, s[36:39], s60 offen offset:96
    s_mov_b32 s32, s10
    s_mov_b32 s33, s11
    s_mov_b32 s34, 4096
    s_mov_b32 s35, 0x20000
    v_and_b32 v2, 15, v1
    v_lshlrev_b32 v2, 1, v2
    s_lshr_b32 s61, s56, 6
    buffer_load_ushort v192, v2, s[32:35], s61 offen offset:0
    buffer_load_ushort v193, v2, s[32:35], s61 offen offset:32
L_mm_kernel_cloop_48:
    s_waitcnt lgkmcnt(3)
    v_mfma_f32_16x16x32_bf16 v[80:83], v[48:51], v[32:35], v[80:83]
    ds_read_b128 v[40:43], v6 offset:8192
    ds_read_b128 v[44:47], v6 offset:9216
    v_mfma_f32_16x16x32_bf16 v[84:87], v[48:51], v[36:39], v[84:87]
    ds_read_b128 v[64:67], v10 offset:4096
    s_add_u32 s52, s52, 16384
    s_cmp_ge_u32 s52, 65536
    s_waitcnt lgkmcnt(5)
    v_mfma_f32_16x16x32_bf16 v[88:91], v[52:55], v[32:35], v[88:91]
    ds_read_b128 v[68:71], v10 offset:5120
    v_mfma_f32_16x16x32_bf16 v[92:95], v[52:55], v[36:39], v[92:95]
    s_cselect_b32 s52, 0, s52
    s_add_u32 s53, s53, 8192
    s_waitcnt lgkmcnt(5)
    v_mfma_f32_16x16x32_bf16 v[96:99], v[56:59], v[32:35], v[96:99]
    ds_read_b128 v[72:75], v10 offset:6144
    v_mfma_f32_16x16x32_bf16 v[100:103], v[56:59], v[36:39], v[100:103]
    s_cmp_ge_u32 s53, 32768
    s_cselect_b32 s53, 0, s53
    s_waitcnt lgkmcnt(5)
    v_mfma_f32_16x16x32_bf16 v[104:107], v[60:63], v[32:35], v[104:107]
    ds_read_b128 v[76:79], v10 offset:7168
    v_mfma_f32_16x16x32_bf16 v[108:111], v[60:63], v[36:39], v[108:111]
    s_add_u32 s54, s54, 1
    s_cmp_lt_u32 s54, 16
    s_waitcnt lgkmcnt(3)
    v_mfma_f32_16x16x32_bf16 v[80:83], v[64:67], v[40:43], v[80:83]
    v_mfma_f32_16x16x32_bf16 v[84:87], v[64:67], v[44:47], v[84:87]
    s_waitcnt lgkmcnt(2)
    v_mfma_f32_16x16x32_bf16 v[88:91], v[68:71], v[40:43], v[88:91]
    v_add_u32 v6, s52, v4
    v_add_u32 v10, s53, v5
    s_waitcnt lgkmcnt(0)
    s_barrier
    v_mfma_f32_16x16x32_bf16 v[92:95], v[68:71], v[44:47], v[92:95]
    ds_read_b128 v[32:35], v6 offset:0
    ds_read_b128 v[36:39], v6 offset:1024
    ds_read_b128 v[48:51], v10 offset:0
    ds_read_b128 v[52:55], v10 offset:1024
    v_mfma_f32_16x16x32_bf16 v[96:99], v[72:75], v[40:43], v[96:99]
    ds_read_b128 v[56:59], v10 offset:2048
    v_mfma_f32_16x16x32_bf16 v[100:103], v[72:75], v[44:47], v[100:103]
    v_mfma_f32_16x16x32_bf16 v[104:107], v[76:79], v[40:43], v[104:107]
    ds_read_b128 v[60:63], v10 offset:3072
    v_mfma_f32_16x16x32_bf16 v[108:111], v[76:79], v[44:47], v[108:111]
    s_cmp_lg_u32 s54, 8
    s_cbranch_scc1 L_mm_kernel_nomid_49
    ds_read_b128 v[112:115], v13 offset:0
    ds_read_b128 v[116:119], v13 offset:64
    ds_read_b128 v[120:123], v13 offset:128
    ds_read_b128 v[124:127], v13 offset:192
    ds_read_b128 v[128:131], v13 offset:512
    ds_read_b128 v[132:135], v13 offset:576
    ds_read_b128 v[136:139], v13 offset:640
    ds_read_b128 v[140:143], v13 offset:704
    ds_read_b128 v[212:215], v13 offset:256
    ds_read_b128 v[216:219], v13 offset:320
    ds_read_b128 v[220:223], v13 offset:384
    ds_read_b128 v[224:227], v13 offset:448
    s_waitcnt vmcnt(0)
    v_permlane16_swap_b32 v196, v198
    v_permlane16_swap_b32 v197, v199
    v_permlane16_swap_b32 v200, v202
    v_permlane16_swap_b32 v201, v203
    v_permlane16_swap_b32 v204, v206
    v_permlane16_swap_b32 v205, v207
    v_permlane16_swap_b32 v208, v210
    v_permlane16_swap_b32 v209, v211
    v_lshlrev_b32 v192, 16, v192
    v_lshlrev_b32 v193, 16, v193
    v_lshlrev_b32 v144, 16, v196
    v_and_b32 v145, 0xffff0000, v196
    v_lshlrev_b32 v146, 16, v197
    v_and_b32 v147, 0xffff0000, v197
    v_lshlrev_b32 v148, 16, v198
    v_and_b32 v149, 0xffff0000, v198
    v_lshlrev_b32 v150, 16, v199
    v_and_b32 v151, 0xffff0000, v199
    v_lshlrev_b32 v152, 16, v200
    v_and_b32 v153, 0xffff0000, v200
    v_lshlrev_b32 v154, 16, v201
    v_and_b32 v155, 0xffff0000, v201
    v_lshlrev_b32 v156, 16, v202
    v_and_b32 v157, 0xffff0000, v202
    v_lshlrev_b32 v158, 16, v203
    v_and_b32 v159, 0xffff0000, v203
    v_lshlrev_b32 v160, 16, v204
    v_and_b32 v161, 0xffff0000, v204
    v_lshlrev_b32 v162, 16, v205
    v_and_b32 v163, 0xffff0000, v205
    v_lshlrev_b32 v164, 16, v206
    v_and_b32 v165, 0xffff0000, v206
    v_lshlrev_b32 v166, 16, v207
    v_and_b32 v167, 0xffff0000, v207
    v_lshlrev_b32 v168, 16, v208
    v_and_b32 v169, 0xffff0000, v208
    v_lshlrev_b32 v170, 16, v209
    v_and_b32 v171, 0xffff0000, v209
    v_lshlrev_b32 v172, 16, v210
    v_and_b32 v173, 0xffff0000, v210
    v_lshlrev_b32 v174, 16, v211
    v_and_b32 v175, 0xffff0000, v211
    s_waitcnt lgkmcnt(0)
L_mm_kernel_nomid_49:
    s_cmp_lt_u32 s54, 16
    s_cbranch_scc1 L_mm_kernel_cloop_48
    s_waitcnt lgkmcnt(0)
    v_mov_b32 v4, 0
    v_mov_b32 v5, 0
    v_mov_b32 v6, 0
    v_mov_b32 v7, 0
    v_mov_b32 v8, 0
    v_mov_b32 v9, 0
    v_mov_b32 v10, 0
    v_mov_b32 v11, 0
    v_pk_fma_f32 v[80:81], v[80:81], v[112:113], v[144:145]
    v_pk_fma_f32 v[82:83], v[82:83], v[114:115], v[146:147]
    v_pk_fma_f32 v[84:85], v[84:85], v[112:113], v[148:149]
    v_pk_fma_f32 v[86:87], v[86:87], v[114:115], v[150:151]
    v_pk_fma_f32 v[88:89], v[88:89], v[116:117], v[152:153]
    v_pk_fma_f32 v[90:91], v[90:91], v[118:119], v[154:155]
    v_pk_fma_f32 v[92:93], v[92:93], v[116:117], v[156:157]
    v_pk_fma_f32 v[94:95], v[94:95], v[118:119], v[158:159]
    v_pk_fma_f32 v[96:97], v[96:97], v[120:121], v[160:161]
    v_pk_fma_f32 v[98:99], v[98:99], v[122:123], v[162:163]
    v_pk_fma_f32 v[100:101], v[100:101], v[120:121], v[164:165]
    v_pk_fma_f32 v[102:103], v[102:103], v[122:123], v[166:167]
    v_pk_fma_f32 v[104:105], v[104:105], v[124:125], v[168:169]
    v_pk_fma_f32 v[106:107], v[106:107], v[126:127], v[170:171]
    v_pk_fma_f32 v[108:109], v[108:109], v[124:125], v[172:173]
    v_pk_fma_f32 v[110:111], v[110:111], v[126:127], v[174:175]
    v_pk_add_f32 v[4:5], v[4:5], v[80:81]
    v_pk_fma_f32 v[6:7], v[80:81], v[80:81], v[6:7]
    v_pk_add_f32 v[4:5], v[4:5], v[82:83]
    v_pk_fma_f32 v[6:7], v[82:83], v[82:83], v[6:7]
    v_pk_add_f32 v[8:9], v[8:9], v[84:85]
    v_pk_fma_f32 v[10:11], v[84:85], v[84:85], v[10:11]
    v_pk_add_f32 v[8:9], v[8:9], v[86:87]
    v_pk_fma_f32 v[10:11], v[86:87], v[86:87], v[10:11]
    v_pk_add_f32 v[4:5], v[4:5], v[88:89]
    v_pk_fma_f32 v[6:7], v[88:89], v[88:89], v[6:7]
    v_pk_add_f32 v[4:5], v[4:5], v[90:91]
    v_pk_fma_f32 v[6:7], v[90:91], v[90:91], v[6:7]
    v_pk_add_f32 v[8:9], v[8:9], v[92:93]
    v_pk_fma_f32 v[10:11], v[92:93], v[92:93], v[10:11]
    v_pk_add_f32 v[8:9], v[8:9], v[94:95]
    v_pk_fma_f32 v[10:11], v[94:95], v[94:95], v[10:11]
    v_pk_add_f32 v[4:5], v[4:5], v[96:97]
    v_pk_fma_f32 v[6:7], v[96:97], v[96:97], v[6:7]
    v_pk_add_f32 v[4:5], v[4:5], v[98:99]
    v_pk_fma_f32 v[6:7], v[98:99], v[98:99], v[6:7]
    v_pk_add_f32 v[8:9], v[8:9], v[100:101]
    v_pk_fma_f32 v[10:11], v[100:101], v[100:101], v[10:11]
    v_pk_add_f32 v[8:9], v[8:9], v[102:103]
    v_pk_fma_f32 v[10:11], v[102:103], v[102:103], v[10:11]
    v_pk_add_f32 v[4:5], v[4:5], v[104:105]
    v_pk_fma_f32 v[6:7], v[104:105], v[104:105], v[6:7]
    v_pk_add_f32 v[4:5], v[4:5], v[106:107]
    v_pk_fma_f32 v[6:7], v[106:107], v[106:107], v[6:7]
    v_pk_add_f32 v[8:9], v[8:9], v[108:109]
    v_pk_fma_f32 v[10:11], v[108:109], v[108:109], v[10:11]
    v_pk_add_f32 v[8:9], v[8:9], v[110:111]
    v_pk_fma_f32 v[10:11], v[110:111], v[110:111], v[10:11]
    v_add_f32 v4, v4, v5
    v_add_f32 v6, v6, v7
    v_add_f32 v8, v8, v9
    v_add_f32 v10, v10, v11
    s_nop 0
    v_permlane16_swap_b32 v4, v8
    s_nop 0
    v_permlane16_swap_b32 v6, v10
    v_mov_b32 v5, v8
    v_mov_b32 v7, v10
    v_add_f32 v4, v4, v5
    v_add_f32 v5, v6, v7
    v_mov_b32 v6, v4
    s_nop 1
    v_permlane32_swap_b32 v4, v6
    v_add_f32 v4, v4, v6
    v_mov_b32 v7, v5
    s_nop 1
    v_permlane32_swap_b32 v5, v7
    v_add_f32 v5, v5, v7
    s_mov_b32 exec_hi, 0
    buffer_store_dwordx2 v[4:5], v14, s[44:47], s58 offen sc1
    s_mov_b32 exec_hi, -1
    v_cvt_pk_bf16_f32 v16, v80, v81
    v_cvt_pk_bf16_f32 v17, v82, v83
    v_cvt_pk_bf16_f32 v18, v84, v85
    v_cvt_pk_bf16_f32 v19, v86, v87
    v_cvt_pk_bf16_f32 v20, v88, v89
    v_cvt_pk_bf16_f32 v21, v90, v91
    v_cvt_pk_bf16_f32 v22, v92, v93
    v_cvt_pk_bf16_f32 v23, v94, v95
    v_cvt_pk_bf16_f32 v24, v96, v97
    v_cvt_pk_bf16_f32 v25, v98, v99
    v_cvt_pk_bf16_f32 v26, v100, v101
    v_cvt_pk_bf16_f32 v27, v102, v103
    v_cvt_pk_bf16_f32 v28, v104, v105
    v_cvt_pk_bf16_f32 v29, v106, v107
    v_cvt_pk_bf16_f32 v30, v108, v109
    v_cvt_pk_bf16_f32 v31, v110, v111
    s_mov_b32 s64, 0
L_mm_kernel_poll_50:
    s_sleep 6
    buffer_load_dwordx2 v[48:49], v14, s[44:47], s56 offen offset:0 sc1
    buffer_load_dwordx2 v[50:51], v14, s[44:47], s56 offen offset:512 sc1
    buffer_load_dwordx2 v[52:53], v14, s[44:47], s56 offen offset:1024 sc1
    buffer_load_dwordx2 v[54:55], v14, s[44:47], s56 offen offset:1536 sc1
    buffer_load_dwordx2 v[56:57], v14, s[44:47], s56 offen offset:2048 sc1
    buffer_load_dwordx2 v[58:59], v14, s[44:47], s56 offen offset:2560 sc1
    buffer_load_dwordx2 v[60:61], v14, s[44:47], s56 offen offset:3072 sc1
    buffer_load_dwordx2 v[62:63], v14, s[44:47], s56 offen offset:3584 sc1
    s_waitcnt vmcnt(0)
    v_mov_b32 v2, 0
    v_min3_f32 v2, v2, v49, v51
    v_min3_f32 v2, v2, v53, v55
    v_min3_f32 v2, v2, v57, v59
    v_min3_f32 v2, v2, v61, v63
    v_cmp_gt_f32 vcc, 0, v2
    s_cbranch_vccz L_mm_kernel_got_51
    s_add_u32 s64, s64, 1
    s_cmp_lt_u32 s64, 0x100000
    s_cbranch_scc1 L_mm_kernel_poll_50
L_mm_kernel_got_51:
    v_pk_add_f32 v[48:49], v[48:49], v[56:57]
    v_pk_add_f32 v[50:51], v[50:51], v[58:59]
    v_pk_add_f32 v[52:53], v[52:53], v[60:61]
    v_pk_add_f32 v[54:55], v[54:55], v[62:63]
    v_pk_add_f32 v[48:49], v[48:49], v[52:53]
    v_pk_add_f32 v[50:51], v[50:51], v[54:55]
    v_pk_add_f32 v[48:49], v[48:49], v[50:51]
    v_mov_b32 v50, v48
    s_nop 1
    v_permlane32_swap_b32 v48, v50
    v_add_f32 v48, v48, v50
    v_mov_b32 v51, v49
    s_nop 1
    v_permlane32_swap_b32 v49, v51
    v_add_f32 v49, v49, v51
    v_mul_f32 v2, 0x3a800000, v48
    v_mul_f32 v3, v2, v2
    v_mul_f32 v49, 0x3a800000, v49
    v_sub_f32 v3, v49, v3
    v_max_f32 v3, 0, v3
    v_add_f32 v3, 0x3727c5ac, v3
    v_rsq_f32 v48, v3
    s_nop 0
    v_mul_f32 v49, v2, v48
    v_sub_f32 v49, 0, v49
    v_mov_b32 v4, v48
    v_mov_b32 v5, v49
    v_mov_b32 v6, v4
    v_mov_b32 v7, v5
    s_nop 0
    v_permlane16_swap_b32 v4, v6
    s_nop 0
    v_permlane16_swap_b32 v5, v7
    v_pk_fma_f32 v[80:81], v[80:81], v[4:5], v[4:5] op_sel:[0,0,1] op_sel_hi:[1,0,1]
    v_pk_fma_f32 v[82:83], v[82:83], v[4:5], v[4:5] op_sel:[0,0,1] op_sel_hi:[1,0,1]
    v_pk_fma_f32 v[84:85], v[84:85], v[6:7], v[6:7] op_sel:[0,0,1] op_sel_hi:[1,0,1]
    v_pk_fma_f32 v[86:87], v[86:87], v[6:7], v[6:7] op_sel:[0,0,1] op_sel_hi:[1,0,1]
    v_pk_fma_f32 v[80:81], v[80:81], v[128:129], v[212:213]
    v_pk_fma_f32 v[82:83], v[82:83], v[130:131], v[214:215]
    v_pk_fma_f32 v[84:85], v[84:85], v[128:129], v[212:213]
    v_pk_fma_f32 v[86:87], v[86:87], v[130:131], v[214:215]
    v_cvt_pk_bf16_f32 v32, v80, v81
    v_cvt_pk_bf16_f32 v33, v82, v83
    v_cvt_pk_bf16_f32 v34, v84, v85
    v_cvt_pk_bf16_f32 v35, v86, v87
    s_nop 0
    v_permlane16_swap_b32 v32, v34
    s_nop 0
    v_permlane16_swap_b32 v33, v35
    buffer_store_dwordx4 v[32:35], v12, s[40:43], s57 offen offset:0 sc1
    ds_write_b128 v15, v[32:35] offset:0
    v_pk_fma_f32 v[88:89], v[88:89], v[4:5], v[4:5] op_sel:[0,0,1] op_sel_hi:[1,0,1]
    v_pk_fma_f32 v[90:91], v[90:91], v[4:5], v[4:5] op_sel:[0,0,1] op_sel_hi:[1,0,1]
    v_pk_fma_f32 v[92:93], v[92:93], v[6:7], v[6:7] op_sel:[0,0,1] op_sel_hi:[1,0,1]
    v_pk_fma_f32 v[94:95], v[94:95], v[6:7], v[6:7] op_sel:[0,0,1] op_sel_hi:[1,0,1]
    v_pk_fma_f32 v[88:89], v[88:89], v[132:133], v[216:217]
    v_pk_fma_f32 v[90:91], v[90:91], v[134:135], v[218:219]
    v_pk_fma_f32 v[92:93], v[92:93], v[132:133], v[216:217]
    v_pk_fma_f32 v[94:95], v[94:95], v[134:135], v[218:219]
    v_cvt_pk_bf16_f32 v36, v88, v89
    v_cvt_pk_bf16_f32 v37, v90, v91
    v_cvt_pk_bf16_f32 v38, v92, v93
    v_cvt_pk_bf16_f32 v39, v94, v95
    s_nop 0
    v_permlane16_swap_b32 v36, v38
    s_nop 0
    v_permlane16_swap_b32 v37, v39
    buffer_store_dwordx4 v[36:39], v12, s[40:43], s57 offen offset:512 sc1
    ds_write_b128 v15, v[36:39] offset:512
    v_pk_fma_f32 v[96:97], v[96:97], v[4:5], v[4:5] op_sel:[0,0,1] op_sel_hi:[1,0,1]
    v_pk_fma_f32 v[98:99], v[98:99], v[4:5], v[4:5] op_sel:[0,0,1] op_sel_hi:[1,0,1]
    v_pk_fma_f32 v[100:101], v[100:101], v[6:7], v[6:7] op_sel:[0,0,1] op_sel_hi:[1,0,1]
    v_pk_fma_f32 v[102:103], v[102:103], v[6:7], v[6:7] op_sel:[0,0,1] op_sel_hi:[1,0,1]
    v_pk_fma_f32 v[96:97], v[96:97], v[136:137], v[220:221]
    v_pk_fma_f32 v[98:99], v[98:99], v[138:139], v[222:223]
    v_pk_fma_f32 v[100:101], v[100:101], v[136:137], v[220:221]
    v_pk_fma_f32 v[102:103], v[102:103], v[138:139], v[222:223]
    v_cvt_pk_bf16_f32 v40, v96, v97
    v_cvt_pk_bf16_f32 v41, v98, v99
    v_cvt_pk_bf16_f32 v42, v100, v101
    v_cvt_pk_bf16_f32 v43, v102, v103
    s_nop 0
    v_permlane16_swap_b32 v40, v42
    s_nop 0
    v_permlane16_swap_b32 v41, v43
    buffer_store_dwordx4 v[40:43], v12, s[40:43], s55 offen offset:0 sc1
    ds_write_b128 v15, v[40:43] offset:8192
    v_pk_fma_f32 v[104:105], v[104:105], v[4:5], v[4:5] op_sel:[0,0,1] op_sel_hi:[1,0,1]
    v_pk_fma_f32 v[106:107], v[106:107], v[4:5], v[4:5] op_sel:[0,0,1] op_sel_hi:[1,0,1]
    v_pk_fma_f32 v[108:109], v[108:109], v[6:7], v[6:7] op_sel:[0,0,1] op_sel_hi:[1,0,1]
    v_pk_fma_f32 v[110:111], v[110:111], v[6:7], v[6:7] op_sel:[0,0,1] op_sel_hi:[1,0,1]
    v_pk_fma_f32 v[104:105], v[104:105], v[140:141], v[224:225]
    v_pk_fma_f32 v[106:107], v[106:107], v[142:143], v[226:227]
    v_pk_fma_f32 v[108:109], v[108:109], v[140:141], v[224:225]
    v_pk_fma_f32 v[110:111], v[110:111], v[142:143], v[226:227]
    v_cvt_pk_bf16_f32 v44, v104, v105
    v_cvt_pk_bf16_f32 v45, v106, v107
    v_cvt_pk_bf16_f32 v46, v108, v109
    v_cvt_pk_bf16_f32 v47, v110, v111
    s_nop 0
    v_permlane16_swap_b32 v44, v46
    s_nop 0
    v_permlane16_swap_b32 v45, v47
    buffer_store_dwordx4 v[44:47], v12, s[40:43], s55 offen offset:512 sc1
    ds_write_b128 v15, v[44:47] offset:8704
    s_add_u32 s40, s6, 33554432
    s_addc_u32 s41, s7, 0
    s_mov_b32 s42, 7340032
    s_mov_b32 s43, 0x20000
    s_add_u32 s44, s6, 56885248
    s_addc_u32 s45, s7, 0
    s_mov_b32 s46, 262144
    s_mov_b32 s47, 0x20000
    s_mul_i32 s50, s3, 2048
    s_add_u32 s50, s50, 0
    v_lshl_add_u32 v4, v1, 4, s50
    v_lshlrev_b32 v5, 4, v1
    v_add_u32 v5, 69632, v5
    v_mov_b32 v80, 0
    v_mov_b32 v81, 0
    v_mov_b32 v82, 0
    v_mov_b32 v83, 0
    v_mov_b32 v84, 0
    v_mov_b32 v85, 0
    v_mov_b32 v86, 0
    v_mov_b32 v87, 0
    v_mov_b32 v88, 0
    v_mov_b32 v89, 0
    v_mov_b32 v90, 0
    v_mov_b32 v91, 0
    v_mov_b32 v92, 0
    v_mov_b32 v93, 0
    v_mov_b32 v94, 0
    v_mov_b32 v95, 0
    v_mov_b32 v96, 0
    v_mov_b32 v97, 0
    v_mov_b32 v98, 0
    v_mov_b32 v99, 0
    v_mov_b32 v100, 0
    v_mov_b32 v101, 0
    v_mov_b32 v102, 0
    v_mov_b32 v103, 0
    v_mov_b32 v104, 0
    v_mov_b32 v105, 0
    v_mov_b32 v106, 0
    v_mov_b32 v107, 0
    v_mov_b32 v108, 0
    v_mov_b32 v109, 0
    v_mov_b32 v110, 0
    v_mov_b32 v111, 0
    v_mov_b32 v112, 0
    v_mov_b32 v113, 0
    v_mov_b32 v114, 0
    v_mov_b32 v115, 0
    v_mov_b32 v116, 0
    v_mov_b32 v117, 0
    v_mov_b32 v118, 0
    v_mov_b32 v119, 0
    v_mov_b32 v120, 0
    v_mov_b32 v121, 0
    v_mov_b32 v122, 0
    v_mov_b32 v123, 0
    v_mov_b32 v124, 0
    v_mov_b32 v125, 0
    v_mov_b32 v126, 0
    v_mov_b32 v127, 0
    v_mov_b32 v128, 0
    v_mov_b32 v129, 0
    v_mov_b32 v130, 0
    v_mov_b32 v131, 0
    v_mov_b32 v132, 0
    v_mov_b32 v133, 0
    v_mov_b32 v134, 0
    v_mov_b32 v135, 0
    v_mov_b32 v136, 0
    v_mov_b32 v137, 0
    v_mov_b32 v138, 0
    v_mov_b32 v139, 0
    v_mov_b32 v140, 0
    v_mov_b32 v141, 0
    v_mov_b32 v142, 0
    v_mov_b32 v143, 0
    v_mov_b32 v144, 0
    v_mov_b32 v145, 0
    v_mov_b32 v146, 0
    v_mov_b32 v147, 0
    v_mov_b32 v148, 0
    v_mov_b32 v149, 0
    v_mov_b32 v150, 0
    v_mov_b32 v151, 0
    v_mov_b32 v152, 0
    v_mov_b32 v153, 0
    v_mov_b32 v154, 0
    v_mov_b32 v155, 0
    v_mov_b32 v156, 0
    v_mov_b32 v157, 0
    v_mov_b32 v158, 0
    v_mov_b32 v159, 0
    v_mov_b32 v160, 0
    v_mov_b32 v161, 0
    v_mov_b32 v162, 0
    v_mov_b32 v163, 0
    v_mov_b32 v164, 0
    v_mov_b32 v165, 0
    v_mov_b32 v166, 0
    v_mov_b32 v167, 0
    v_mov_b32 v168, 0
    v_mov_b32 v169, 0
    v_mov_b32 v170, 0
    v_mov_b32 v171, 0
    v_mov_b32 v172, 0
    v_mov_b32 v173, 0
    v_mov_b32 v174, 0
    v_mov_b32 v175, 0
    v_mov_b32 v176, 0
    v_mov_b32 v177, 0
    v_mov_b32 v178, 0
    v_mov_b32 v179, 0
    v_mov_b32 v180, 0
    v_mov_b32 v181, 0
    v_mov_b32 v182, 0
    v_mov_b32 v183, 0
    v_mov_b32 v184, 0
    v_mov_b32 v185, 0
    v_mov_b32 v186, 0
    v_mov_b32 v187, 0
    v_mov_b32 v188, 0
    v_mov_b32 v189, 0
    v_mov_b32 v190, 0
    v_mov_b32 v191, 0
    s_mov_b32 s52, 0
    s_mov_b32 s53, 28672
    s_mov_b32 s54, 0
    v_add_u32 v6, s52, v4
    v_add_u32 v10, s53, v5
    s_waitcnt lgkmcnt(0)
    s_add_u32 s32, s6, 57147392
    s_addc_u32 s33, s7, 0
    s_mov_b32 s34, 327680
    s_mov_b32 s35, 0x20000
    s_lshl_b32 s56, s20, 11
    s_lshl_b32 s57, s21, 7
    s_add_u32 s56, s56, s57
    s_add_u32 s56, s56, 0
    v_mov_b32 v2, 0
    v_mov_b32 v3, 1.0
    s_waitcnt vmcnt(0)
    s_barrier
    s_cmp_lg_u32 s3, 0
    s_cbranch_scc1 L_mm_kernel_nosig_52
    s_mov_b64 exec, 1
    buffer_store_dword v3, v2, s[32:35], s56 offen sc1
    s_mov_b64 exec, -1
L_mm_kernel_nosig_52:
    ds_read_b128 v[32:35], v6 offset:0
    ds_read_b128 v[36:39], v6 offset:1024
    ds_read_b128 v[48:51], v10 offset:0
    ds_read_b128 v[52:55], v10 offset:1024
    ds_read_b128 v[56:59], v10 offset:2048
    ds_read_b128 v[60:63], v10 offset:3072
    ds_read_b128 v[64:67], v10 offset:4096
    ds_read_b128 v[68:71], v10 offset:5120
L_mm_kernel_cloop_53:
    s_waitcnt lgkmcnt(4)
    v_mfma_f32_16x16x32_bf16 v[80:83], v[48:51], v[32:35], v[80:83]
    ds_read_b128 v[72:75], v10 offset:6144
    v_mfma_f32_16x16x32_bf16 v[84:87], v[48:51], v[36:39], v[84:87]
    s_add_u32 s52, s52, 16384
    v_mfma_f32_16x16x32_bf16 v[88:91], v[52:55], v[32:35], v[88:91]
    ds_read_b128 v[48:51], v10 offset:7168
    v_mfma_f32_16x16x32_bf16 v[92:95], v[52:55], v[36:39], v[92:95]
    s_cmp_ge_u32 s52, 49152
    s_waitcnt lgkmcnt(4)
    v_mfma_f32_16x16x32_bf16 v[96:99], v[56:59], v[32:35], v[96:99]
    ds_read_b128 v[52:55], v10 offset:8192
    v_mfma_f32_16x16x32_bf16 v[100:103], v[56:59], v[36:39], v[100:103]
    s_cselect_b32 s52, 0, s52
    v_mfma_f32_16x16x32_bf16 v[104:107], v[60:63], v[32:35], v[104:107]
    ds_read_b128 v[56:59], v10 offset:9216
    v_mfma_f32_16x16x32_bf16 v[108:111], v[60:63], v[36:39], v[108:111]
    s_add_u32 s53, s53, 28672
    s_waitcnt lgkmcnt(4)
    v_mfma_f32_16x16x32_bf16 v[112:115], v[64:67], v[32:35], v[112:115]
    ds_read_b128 v[60:63], v10 offset:10240
    v_mfma_f32_16x16x32_bf16 v[116:119], v[64:67], v[36:39], v[116:119]
    s_cmp_ge_u32 s53, 86016
    v_mfma_f32_16x16x32_bf16 v[120:123], v[68:71], v[32:35], v[120:123]
    ds_read_b128 v[64:67], v10 offset:11264
    v_mfma_f32_16x16x32_bf16 v[124:127], v[68:71], v[36:39], v[124:127]
    s_cselect_b32 s53, 0, s53
    s_waitcnt lgkmcnt(4)
    v_mfma_f32_16x16x32_bf16 v[128:131], v[72:75], v[32:35], v[128:131]
    ds_read_b128 v[68:71], v10 offset:12288
    v_mfma_f32_16x16x32_bf16 v[132:135], v[72:75], v[36:39], v[132:135]
    s_add_u32 s54, s54, 1
    v_mfma_f32_16x16x32_bf16 v[136:139], v[48:51], v[32:35], v[136:139]
    ds_read_b128 v[72:75], v10 offset:13312
    v_mfma_f32_16x16x32_bf16 v[140:143], v[48:51], v[36:39], v[140:143]
    s_cmp_lt_u32 s54, 16
    s_waitcnt lgkmcnt(4)
    v_mfma_f32_16x16x32_bf16 v[144:147], v[52:55], v[32:35], v[144:147]
    ds_read_b128 v[40:43], v6 offset:8192
    ds_read_b128 v[44:47], v6 offset:9216
    v_mfma_f32_16x16x32_bf16 v[148:151], v[52:55], v[36:39], v[148:151]
    ds_read_b128 v[48:51], v10 offset:14336
    v_mfma_f32_16x16x32_bf16 v[152:155], v[56:59], v[32:35], v[152:155]
    ds_read_b128 v[52:55], v10 offset:15360
    v_mfma_f32_16x16x32_bf16 v[156:159], v[56:59], v[36:39], v[156:159]
    s_waitcnt lgkmcnt(6)
    v_mfma_f32_16x16x32_bf16 v[160:163], v[60:63], v[32:35], v[160:163]
    ds_read_b128 v[56:59], v10 offset:16384
    v_mfma_f32_16x16x32_bf16 v[164:167], v[60:63], v[36:39], v[164:167]
    v_mfma_f32_16x16x32_bf16 v[168:171], v[64:67], v[32:35], v[168:171]
    ds_read_b128 v[60:63], v10 offset:17408
    v_mfma_f32_16x16x32_bf16 v[172:175], v[64:67], v[36:39], v[172:175]
    s_waitcnt lgkmcnt(6)
    v_mfma_f32_16x16x32_bf16 v[176:179], v[68:71], v[32:35], v[176:179]
    ds_read_b128 v[64:67], v10 offset:18432
    v_mfma_f32_16x16x32_bf16 v[180:183], v[68:71], v[36:39], v[180:183]
    v_mfma_f32_16x16x32_bf16 v[184:187], v[72:75], v[32:35], v[184:187]
    ds_read_b128 v[68:71], v10 offset:19456
    v_mfma_f32_16x16x32_bf16 v[188:191], v[72:75], v[36:39], v[188:191]
    s_waitcnt lgkmcnt(4)
    v_mfma_f32_16x16x32_bf16 v[80:83], v[48:51], v[40:43], v[80:83]
    ds_read_b128 v[72:75], v10 offset:20480
    v_mfma_f32_16x16x32_bf16 v[84:87], v[48:51], v[44:47], v[84:87]
    v_mfma_f32_16x16x32_bf16 v[88:91], v[52:55], v[40:43], v[88:91]
    ds_read_b128 v[48:51], v10 offset:21504
    v_mfma_f32_16x16x32_bf16 v[92:95], v[52:55], v[44:47], v[92:95]
    s_waitcnt lgkmcnt(4)
    v_mfma_f32_16x16x32_bf16 v[96:99], v[56:59], v[40:43], v[96:99]
    ds_read_b128 v[52:55], v10 offset:22528
    v_mfma_f32_16x16x32_bf16 v[100:103], v[56:59], v[44:47], v[100:103]
    v_mfma_f32_16x16x32_bf16 v[104:107], v[60:63], v[40:43], v[104:107]
    ds_read_b128 v[56:59], v10 offset:23552
    v_mfma_f32_16x16x32_bf16 v[108:111], v[60:63], v[44:47], v[108:111]
    s_waitcnt lgkmcnt(4)
    v_mfma_f32_16x16x32_bf16 v[112:115], v[64:67], v[40:43], v[112:115]
    ds_read_b128 v[60:63], v10 offset:24576
    v_mfma_f32_16x16x32_bf16 v[116:119], v[64:67], v[44:47], v[116:119]
    v_mfma_f32_16x16x32_bf16 v[120:123], v[68:71], v[40:43], v[120:123]
    ds_read_b128 v[64:67], v10 offset:25600
    v_mfma_f32_16x16x32_bf16 v[124:127], v[68:71], v[44:47], v[124:127]
    s_waitcnt lgkmcnt(4)
    v_mfma_f32_16x16x32_bf16 v[128:131], v[72:75], v[40:43], v[128:131]
    ds_read_b128 v[68:71], v10 offset:26624
    v_mfma_f32_16x16x32_bf16 v[132:135], v[72:75], v[44:47], v[132:135]
    v_mfma_f32_16x16x32_bf16 v[136:139], v[48:51], v[40:43], v[136:139]
    ds_read_b128 v[72:75], v10 offset:27648
    v_mfma_f32_16x16x32_bf16 v[140:143], v[48:51], v[44:47], v[140:143]
    s_waitcnt lgkmcnt(4)
    v_mfma_f32_16x16x32_bf16 v[144:147], v[52:55], v[40:43], v[144:147]
    v_mfma_f32_16x16x32_bf16 v[148:151], v[52:55], v[44:47], v[148:151]
    v_mfma_f32_16x16x32_bf16 v[152:155], v[56:59], v[40:43], v[152:155]
    v_mfma_f32_16x16x32_bf16 v[156:159], v[56:59], v[44:47], v[156:159]
    s_waitcnt lgkmcnt(3)
    v_mfma_f32_16x16x32_bf16 v[160:163], v[60:63], v[40:43], v[160:163]
    v_add_u32 v6, s52, v4
    v_add_u32 v10, s53, v5
    s_waitcnt lgkmcnt(0)
    s_barrier
    v_mfma_f32_16x16x32_bf16 v[164:167], v[60:63], v[44:47], v[164:167]
    ds_read_b128 v[32:35], v6 offset:0
    ds_read_b128 v[36:39], v6 offset:1024
    ds_read_b128 v[48:51], v10 offset:0
    ds_read_b128 v[52:55], v10 offset:1024
    v_mfma_f32_16x16x32_bf16 v[168:171], v[64:67], v[40:43], v[168:171]
    ds_read_b128 v[56:59], v10 offset:2048
    v_mfma_f32_16x16x32_bf16 v[172:175], v[64:67], v[44:47], v[172:175]
    ds_read_b128 v[60:63], v10 offset:3072
    v_mfma_f32_16x16x32_bf16 v[176:179], v[68:71], v[40:43], v[176:179]
    ds_read_b128 v[64:67], v10 offset:4096
    v_mfma_f32_16x16x32_bf16 v[180:183], v[68:71], v[44:47], v[180:183]
    v_mfma_f32_16x16x32_bf16 v[184:187], v[72:75], v[40:43], v[184:187]
    ds_read_b128 v[68:71], v10 offset:5120
    v_mfma_f32_16x16x32_bf16 v[188:191], v[72:75], v[44:47], v[188:191]
    s_cbranch_scc1 L_mm_kernel_cloop_53
    s_waitcnt lgkmcnt(0)
    s_mov_b32 s60, 0xbdd2d3e8
    s_mov_b32 s61, 0xbdd2d3e8
    v_mov_b32 v12, 0xc0135761
    v_mov_b32 v13, 0xc0135761
    s_lshl_b32 s57, s20, 2
    s_add_u32 s57, s57, s3
    s_lshl_b32 s62, s57, 12
    s_lshl_b32 s63, s21, 8
    s_add_u32 s63, s63, s62
    v_lshlrev_b32 v14, 3, v1
    v_mov_b32 v4, 0
    v_mov_b32 v5, 0
    v_mov_b32 v6, 0
    v_mov_b32 v7, 0
    v_mov_b32 v8, 0
    v_mov_b32 v9, 0
    v_mov_b32 v10, 0
    v_mov_b32 v11, 0
    v_pk_mul_f32 v[32:33], v[136:137], v[136:137]
    v_pk_mul_f32 v[34:35], v[138:139], v[138:139]
    v_pk_mul_f32 v[36:37], v[140:141], v[140:141]
    v_pk_mul_f32 v[38:39], v[142:143], v[142:143]
    v_pk_mul_f32 v[40:41], v[144:145], v[144:145]
    v_pk_mul_f32 v[42:43], v[146:147], v[146:147]
    v_pk_mul_f32 v[44:45], v[148:149], v[148:149]
    v_pk_mul_f32 v[46:47], v[150:151], v[150:151]
    v_pk_mul_f32 v[48:49], v[152:153], v[152:153]
    v_pk_mul_f32 v[50:51], v[154:155], v[154:155]
    v_pk_mul_f32 v[52:53], v[156:157], v[156:157]
    v_pk_mul_f32 v[54:55], v[158:159], v[158:159]
    v_pk_fma_f32 v[32:33], v[32:33], s[60:61], v[12:13]
    v_pk_fma_f32 v[34:35], v[34:35], s[60:61], v[12:13]
    v_pk_fma_f32 v[36:37], v[36:37], s[60:61], v[12:13]
    v_pk_fma_f32 v[38:39], v[38:39], s[60:61], v[12:13]
    v_pk_fma_f32 v[40:41], v[40:41], s[60:61], v[12:13]
    v_pk_fma_f32 v[42:43], v[42:43], s[60:61], v[12:13]
    v_pk_fma_f32 v[44:45], v[44:45], s[60:61], v[12:13]
    v_pk_fma_f32 v[46:47], v[46:47], s[60:61], v[12:13]
    v_pk_fma_f32 v[48:49], v[48:49], s[60:61], v[12:13]
    v_pk_fma_f32 v[50:51], v[50:51], s[60:61], v[12:13]
    v_pk_fma_f32 v[52:53], v[52:53], s[60:61], v[12:13]
    v_pk_fma_f32 v[54:55], v[54:55], s[60:61], v[12:13]
    v_pk_mul_f32 v[32:33], v[32:33], v[136:137]
    v_pk_mul_f32 v[34:35], v[34:35], v[138:139]
    v_pk_mul_f32 v[36:37], v[36:37], v[140:141]
    v_pk_mul_f32 v[38:39], v[38:39], v[142:143]
    v_pk_mul_f32 v[40:41], v[40:41], v[144:145]
    v_pk_mul_f32 v[42:43], v[42:43], v[146:147]
    v_pk_mul_f32 v[44:45], v[44:45], v[148:149]
    v_pk_mul_f32 v[46:47], v[46:47], v[150:151]
    v_pk_mul_f32 v[48:49], v[48:49], v[152:153]
    v_pk_mul_f32 v[50:51], v[50:51], v[154:155]
    v_pk_mul_f32 v[52:53], v[52:53], v[156:157]
    v_pk_mul_f32 v[54:55], v[54:55], v[158:159]
    v_exp_f32 v32, v32
    v_exp_f32 v33, v33
    v_exp_f32 v34, v34
    v_exp_f32 v35, v35
    v_exp_f32 v36, v36
    v_exp_f32 v37, v37
    v_exp_f32 v38, v38
    v_exp_f32 v39, v39
    v_exp_f32 v40, v40
    v_exp_f32 v41, v41
    v_exp_f32 v42, v42
    v_exp_f32 v43, v43
    v_exp_f32 v44, v44
    v_exp_f32 v45, v45
    v_exp_f32 v46, v46
    v_exp_f32 v47, v47
    v_exp_f32 v48, v48
    v_exp_f32 v49, v49
    v_exp_f32 v50, v50
    v_exp_f32 v51, v51
    v_exp_f32 v52, v52
    v_exp_f32 v53, v53
    v_exp_f32 v54, v54
    v_exp_f32 v55, v55
    v_pk_add_f32 v[32:33], v[32:33], 1.0 op_sel_hi:[1,0]
    v_pk_add_f32 v[34:35], v[34:35], 1.0 op_sel_hi:[1,0]
    v_pk_add_f32 v[36:37], v[36:37], 1.0 op_sel_hi:[1,0]
    v_pk_add_f32 v[38:39], v[38:39], 1.0 op_sel_hi:[1,0]
    v_pk_add_f32 v[40:41], v[40:41], 1.0 op_sel_hi:[1,0]
    v_pk_add_f32 v[42:43], v[42:43], 1.0 op_sel_hi:[1,0]
    v_pk_add_f32 v[44:45], v[44:45], 1.0 op_sel_hi:[1,0]
    v_pk_add_f32 v[46:47], v[46:47], 1.0 op_sel_hi:[1,0]
    v_pk_add_f32 v[48:49], v[48:49], 1.0 op_sel_hi:[1,0]
    v_pk_add_f32 v[50:51], v[50:51], 1.0 op_sel_hi:[1,0]
    v_pk_add_f32 v[52:53], v[52:53], 1.0 op_sel_hi:[1,0]
    v_pk_add_f32 v[54:55], v[54:55], 1.0 op_sel_hi:[1,0]
    v_rcp_f32 v32, v32
    v_rcp_f32 v33, v33
    v_rcp_f32 v34, v34
    v_rcp_f32 v35, v35
    v_rcp_f32 v36, v36
    v_rcp_f32 v37, v37
    v_rcp_f32 v38, v38
    v_rcp_f32 v39, v39
    v_rcp_f32 v40, v40
    v_rcp_f32 v41, v41
    v_rcp_f32 v42, v42
    v_rcp_f32 v43, v43
    v_rcp_f32 v44, v44
    v_rcp_f32 v45, v45
    v_rcp_f32 v46, v46
    v_rcp_f32 v47, v47
    v_rcp_f32 v48, v48
    v_rcp_f32 v49, v49
    v_rcp_f32 v50, v50
    v_rcp_f32 v51, v51
    v_rcp_f32 v52, v52
    v_rcp_f32 v53, v53
    v_rcp_f32 v54, v54
    v_rcp_f32 v55, v55
    v_pk_mul_f32 v[136:137], v[136:137], v[32:33]
    v_pk_mul_f32 v[138:139], v[138:139], v[34:35]
    v_pk_mul_f32 v[140:141], v[140:141], v[36:37]
    v_pk_mul_f32 v[142:143], v[142:143], v[38:39]
    v_pk_mul_f32 v[144:145], v[144:145], v[40:41]
    v_pk_mul_f32 v[146:147], v[146:147], v[42:43]
    v_pk_mul_f32 v[148:149], v[148:149], v[44:45]
    v_pk_mul_f32 v[150:151], v[150:151], v[46:47]
    v_pk_mul_f32 v[152:153], v[152:153], v[48:49]
    v_pk_mul_f32 v[154:155], v[154:155], v[50:51]
    v_pk_mul_f32 v[156:157], v[156:157], v[52:53]
    v_pk_mul_f32 v[158:159], v[158:159], v[54:55]
    v_pk_add_f32 v[4:5], v[4:5], v[136:137]
    v_pk_fma_f32 v[6:7], v[136:137], v[136:137], v[6:7]
    v_pk_add_f32 v[4:5], v[4:5], v[138:139]
    v_pk_fma_f32 v[6:7], v[138:139], v[138:139], v[6:7]
    v_pk_add_f32 v[8:9], v[8:9], v[140:141]
    v_pk_fma_f32 v[10:11], v[140:141], v[140:141], v[10:11]
    v_pk_add_f32 v[8:9], v[8:9], v[142:143]
    v_pk_fma_f32 v[10:11], v[142:143], v[142:143], v[10:11]
    v_pk_add_f32 v[4:5], v[4:5], v[144:145]
    v_pk_fma_f32 v[6:7], v[144:145], v[144:145], v[6:7]
    v_pk_add_f32 v[4:5], v[4:5], v[146:147]
    v_pk_fma_f32 v[6:7], v[146:147], v[146:147], v[6:7]
    v_pk_add_f32 v[8:9], v[8:9], v[148:149]
    v_pk_fma_f32 v[10:11], v[148:149], v[148:149], v[10:11]
    v_pk_add_f32 v[8:9], v[8:9], v[150:151]
    v_pk_fma_f32 v[10:11], v[150:151], v[150:151], v[10:11]
    v_pk_add_f32 v[4:5], v[4:5], v[152:153]
    v_pk_fma_f32 v[6:7], v[152:153], v[152:153], v[6:7]
    v_pk_add_f32 v[4:5], v[4:5], v[154:155]
    v_pk_fma_f32 v[6:7], v[154:155], v[154:155], v[6:7]
    v_pk_add_f32 v[8:9], v[8:9], v[156:157]
    v_pk_fma_f32 v[10:11], v[156:157], v[156:157], v[10:11]
    v_pk_add_f32 v[8:9], v[8:9], v[158:159]
    v_pk_fma_f32 v[10:11], v[158:159], v[158:159], v[10:11]
    v_pk_mul_f32 v[32:33], v[160:161], v[160:161]
    v_pk_mul_f32 v[34:35], v[162:163], v[162:163]
    v_pk_mul_f32 v[36:37], v[164:165], v[164:165]
    v_pk_mul_f32 v[38:39], v[166:167], v[166:167]
    v_pk_mul_f32 v[40:41], v[168:169], v[168:169]
    v_pk_mul_f32 v[42:43], v[170:171], v[170:171]
    v_pk_mul_f32 v[44:45], v[172:173], v[172:173]
    v_pk_mul_f32 v[46:47], v[174:175], v[174:175]
    v_pk_mul_f32 v[48:49], v[176:177], v[176:177]
    v_pk_mul_f32 v[50:51], v[178:179], v[178:179]
    v_pk_mul_f32 v[52:53], v[180:181], v[180:181]
    v_pk_mul_f32 v[54:55], v[182:183], v[182:183]
    v_pk_mul_f32 v[56:57], v[184:185], v[184:185]
    v_pk_mul_f32 v[58:59], v[186:187], v[186:187]
    v_pk_mul_f32 v[60:61], v[188:189], v[188:189]
    v_pk_mul_f32 v[62:63], v[190:191], v[190:191]
    v_pk_fma_f32 v[32:33], v[32:33], s[60:61], v[12:13]
    v_pk_fma_f32 v[34:35], v[34:35], s[60:61], v[12:13]
    v_pk_fma_f32 v[36:37], v[36:37], s[60:61], v[12:13]
    v_pk_fma_f32 v[38:39], v[38:39], s[60:61], v[12:13]
    v_pk_fma_f32 v[40:41], v[40:41], s[60:61], v[12:13]
    v_pk_fma_f32 v[42:43], v[42:43], s[60:61], v[12:13]
    v_pk_fma_f32 v[44:45], v[44:45], s[60:61], v[12:13]
    v_pk_fma_f32 v[46:47], v[46:47], s[60:61], v[12:13]
    v_pk_fma_f32 v[48:49], v[48:49], s[60:61], v[12:13]
    v_pk_fma_f32 v[50:51], v[50:51], s[60:61], v[12:13]
    v_pk_fma_f32 v[52:53], v[52:53], s[60:61], v[12:13]
    v_pk_fma_f32 v[54:55], v[54:55], s[60:61], v[12:13]
    v_pk_fma_f32 v[56:57], v[56:57], s[60:61], v[12:13]
    v_pk_fma_f32 v[58:59], v[58:59], s[60:61], v[12:13]
    v_pk_fma_f32 v[60:61], v[60:61], s[60:61], v[12:13]
    v_pk_fma_f32 v[62:63], v[62:63], s[60:61], v[12:13]
    v_pk_mul_f32 v[32:33], v[32:33], v[160:161]
    v_pk_mul_f32 v[34:35], v[34:35], v[162:163]
    v_pk_mul_f32 v[36:37], v[36:37], v[164:165]
    v_pk_mul_f32 v[38:39], v[38:39], v[166:167]
    v_pk_mul_f32 v[40:41], v[40:41], v[168:169]
    v_pk_mul_f32 v[42:43], v[42:43], v[170:171]
    v_pk_mul_f32 v[44:45], v[44:45], v[172:173]
    v_pk_mul_f32 v[46:47], v[46:47], v[174:175]
    v_pk_mul_f32 v[48:49], v[48:49], v[176:177]
    v_pk_mul_f32 v[50:51], v[50:51], v[178:179]
    v_pk_mul_f32 v[52:53], v[52:53], v[180:181]
    v_pk_mul_f32 v[54:55], v[54:55], v[182:183]
    v_pk_mul_f32 v[56:57], v[56:57], v[184:185]
    v_pk_mul_f32 v[58:59], v[58:59], v[186:187]
    v_pk_mul_f32 v[60:61], v[60:61], v[188:189]
    v_pk_mul_f32 v[62:63], v[62:63], v[190:191]
    v_exp_f32 v32, v32
    v_exp_f32 v33, v33
    v_exp_f32 v34, v34
    v_exp_f32 v35, v35
    v_exp_f32 v36, v36
    v_exp_f32 v37, v37
    v_exp_f32 v38, v38
    v_exp_f32 v39, v39
    v_exp_f32 v40, v40
    v_exp_f32 v41, v41
    v_exp_f32 v42, v42
    v_exp_f32 v43, v43
    v_exp_f32 v44, v44
    v_exp_f32 v45, v45
    v_exp_f32 v46, v46
    v_exp_f32 v47, v47
    v_exp_f32 v48, v48
    v_exp_f32 v49, v49
    v_exp_f32 v50, v50
    v_exp_f32 v51, v51
    v_exp_f32 v52, v52
    v_exp_f32 v53, v53
    v_exp_f32 v54, v54
    v_exp_f32 v55, v55
    v_exp_f32 v56, v56
    v_exp_f32 v57, v57
    v_exp_f32 v58, v58
    v_exp_f32 v59, v59
    v_exp_f32 v60, v60
    v_exp_f32 v61, v61
    v_exp_f32 v62, v62
    v_exp_f32 v63, v63
    v_pk_add_f32 v[32:33], v[32:33], 1.0 op_sel_hi:[1,0]
    v_pk_add_f32 v[34:35], v[34:35], 1.0 op_sel_hi:[1,0]
    v_pk_add_f32 v[36:37], v[36:37], 1.0 op_sel_hi:[1,0]
    v_pk_add_f32 v[38:39], v[38:39], 1.0 op_sel_hi:[1,0]
    v_pk_add_f32 v[40:41], v[40:41], 1.0 op_sel_hi:[1,0]
    v_pk_add_f32 v[42:43], v[42:43], 1.0 op_sel_hi:[1,0]
    v_pk_add_f32 v[44:45], v[44:45], 1.0 op_sel_hi:[1,0]
    v_pk_add_f32 v[46:47], v[46:47], 1.0 op_sel_hi:[1,0]
    v_pk_add_f32 v[48:49], v[48:49], 1.0 op_sel_hi:[1,0]
    v_pk_add_f32 v[50:51], v[50:51], 1.0 op_sel_hi:[1,0]
    v_pk_add_f32 v[52:53], v[52:53], 1.0 op_sel_hi:[1,0]
    v_pk_add_f32 v[54:55], v[54:55], 1.0 op_sel_hi:[1,0]
    v_pk_add_f32 v[56:57], v[56:57], 1.0 op_sel_hi:[1,0]
    v_pk_add_f32 v[58:59], v[58:59], 1.0 op_sel_hi:[1,0]
    v_pk_add_f32 v[60:61], v[60:61], 1.0 op_sel_hi:[1,0]
    v_pk_add_f32 v[62:63], v[62:63], 1.0 op_sel_hi:[1,0]
    v_rcp_f32 v32, v32
    v_rcp_f32 v33, v33
    v_rcp_f32 v34, v34
    v_rcp_f32 v35, v35
    v_rcp_f32 v36, v36
    v_rcp_f32 v37, v37
    v_rcp_f32 v38, v38
    v_rcp_f32 v39, v39
    v_rcp_f32 v40, v40
    v_rcp_f32 v41, v41
    v_rcp_f32 v42, v42
    v_rcp_f32 v43, v43
    v_rcp_f32 v44, v44
    v_rcp_f32 v45, v45
    v_rcp_f32 v46, v46
    v_rcp_f32 v47, v47
    v_rcp_f32 v48, v48
    v_rcp_f32 v49, v49
    v_rcp_f32 v50, v50
    v_rcp_f32 v51, v51
    v_rcp_f32 v52, v52
    v_rcp_f32 v53, v53
    v_rcp_f32 v54, v54
    v_rcp_f32 v55, v55
    v_rcp_f32 v56, v56
    v_rcp_f32 v57, v57
    v_rcp_f32 v58, v58
    v_rcp_f32 v59, v59
    v_rcp_f32 v60, v60
    v_rcp_f32 v61, v61
    v_rcp_f32 v62, v62
    v_rcp_f32 v63, v63
    v_pk_mul_f32 v[160:161], v[160:161], v[32:33]
    v_pk_mul_f32 v[162:163], v[162:163], v[34:35]
    v_pk_mul_f32 v[164:165], v[164:165], v[36:37]
    v_pk_mul_f32 v[166:167], v[166:167], v[38:39]
    v_pk_mul_f32 v[168:169], v[168:169], v[40:41]
    v_pk_mul_f32 v[170:171], v[170:171], v[42:43]
    v_pk_mul_f32 v[172:173], v[172:173], v[44:45]
    v_pk_mul_f32 v[174:175], v[174:175], v[46:47]
    v_pk_mul_f32 v[176:177], v[176:177], v[48:49]
    v_pk_mul_f32 v[178:179], v[178:179], v[50:51]
    v_pk_mul_f32 v[180:181], v[180:181], v[52:53]
    v_pk_mul_f32 v[182:183], v[182:183], v[54:55]
    v_pk_mul_f32 v[184:185], v[184:185], v[56:57]
    v_pk_mul_f32 v[186:187], v[186:187], v[58:59]
    v_pk_mul_f32 v[188:189], v[188:189], v[60:61]
    v_pk_mul_f32 v[190:191], v[190:191], v[62:63]
    v_pk_add_f32 v[4:5], v[4:5], v[160:161]
    v_pk_fma_f32 v[6:7], v[160:161], v[160:161], v[6:7]
    v_pk_add_f32 v[4:5], v[4:5], v[162:163]
    v_pk_fma_f32 v[6:7], v[162:163], v[162:163], v[6:7]
    v_pk_add_f32 v[8:9], v[8:9], v[164:165]
    v_pk_fma_f32 v[10:11], v[164:165], v[164:165], v[10:11]
    v_pk_add_f32 v[8:9], v[8:9], v[166:167]
    v_pk_fma_f32 v[10:11], v[166:167], v[166:167], v[10:11]
    v_pk_add_f32 v[4:5], v[4:5], v[168:169]
    v_pk_fma_f32 v[6:7], v[168:169], v[168:169], v[6:7]
    v_pk_add_f32 v[4:5], v[4:5], v[170:171]
    v_pk_fma_f32 v[6:7], v[170:171], v[170:171], v[6:7]
    v_pk_add_f32 v[8:9], v[8:9], v[172:173]
    v_pk_fma_f32 v[10:11], v[172:173], v[172:173], v[10:11]
    v_pk_add_f32 v[8:9], v[8:9], v[174:175]
    v_pk_fma_f32 v[10:11], v[174:175], v[174:175], v[10:11]
    v_pk_add_f32 v[4:5], v[4:5], v[176:177]
    v_pk_fma_f32 v[6:7], v[176:177], v[176:177], v[6:7]
    v_pk_add_f32 v[4:5], v[4:5], v[178:179]
    v_pk_fma_f32 v[6:7], v[178:179], v[178:179], v[6:7]
    v_pk_add_f32 v[8:9], v[8:9], v[180:181]
    v_pk_fma_f32 v[10:11], v[180:181], v[180:181], v[10:11]
    v_pk_add_f32 v[8:9], v[8:9], v[182:183]
    v_pk_fma_f32 v[10:11], v[182:183], v[182:183], v[10:11]
    v_pk_add_f32 v[4:5], v[4:5], v[184:185]
    v_pk_fma_f32 v[6:7], v[184:185], v[184:185], v[6:7]
    v_pk_add_f32 v[4:5], v[4:5], v[186:187]
    v_pk_fma_f32 v[6:7], v[186:187], v[186:187], v[6:7]
    v_pk_add_f32 v[8:9], v[8:9], v[188:189]
    v_pk_fma_f32 v[10:11], v[188:189], v[188:189], v[10:11]
    v_pk_add_f32 v[8:9], v[8:9], v[190:191]
    v_pk_fma_f32 v[10:11], v[190:191], v[190:191], v[10:11]
    v_add_f32 v4, v4, v5
    v_add_f32 v6, v6, v7
    v_add_f32 v8, v8, v9
    v_add_f32 v10, v10, v11
    s_nop 0
    v_permlane16_swap_b32 v4, v8
    s_nop 0
    v_permlane16_swap_b32 v6, v10
    v_mov_b32 v5, v8
    v_mov_b32 v7, v10
    v_add_f32 v4, v4, v5
    v_add_f32 v5, v6, v7
    v_mov_b32 v6, v4
    s_nop 1
    v_permlane32_swap_b32 v4, v6
    v_add_f32 v4, v4, v6
    v_mov_b32 v7, v5
    s_nop 1
    v_permlane32_swap_b32 v5, v7
    v_add_f32 v5, v5, v7
    s_mov_b32 exec_hi, 0
    buffer_store_dwordx2 v[4:5], v14, s[44:47], s63 offen sc1
    s_mov_b32 exec_hi, -1
    v_pk_mul_f32 v[32:33], v[80:81], v[80:81]
    v_pk_mul_f32 v[34:35], v[82:83], v[82:83]
    v_pk_mul_f32 v[36:37], v[84:85], v[84:85]
    v_pk_mul_f32 v[38:39], v[86:87], v[86:87]
    v_pk_mul_f32 v[40:41], v[88:89], v[88:89]
    v_pk_mul_f32 v[42:43], v[90:91], v[90:91]
    v_pk_mul_f32 v[44:45], v[92:93], v[92:93]
    v_pk_mul_f32 v[46:47], v[94:95], v[94:95]
    v_pk_mul_f32 v[48:49], v[96:97], v[96:97]
    v_pk_mul_f32 v[50:51], v[98:99], v[98:99]
    v_pk_mul_f32 v[52:53], v[100:101], v[100:101]
    v_pk_mul_f32 v[54:55], v[102:103], v[102:103]
    v_pk_mul_f32 v[56:57], v[104:105], v[104:105]
    v_pk_mul_f32 v[58:59], v[106:107], v[106:107]
    v_pk_mul_f32 v[60:61], v[108:109], v[108:109]
    v_pk_mul_f32 v[62:63], v[110:111], v[110:111]
    v_pk_fma_f32 v[32:33], v[32:33], s[60:61], v[12:13]
    v_pk_fma_f32 v[34:35], v[34:35], s[60:61], v[12:13]
    v_pk_fma_f32 v[36:37], v[36:37], s[60:61], v[12:13]
    v_pk_fma_f32 v[38:39], v[38:39], s[60:61], v[12:13]
    v_pk_fma_f32 v[40:41], v[40:41], s[60:61], v[12:13]
    v_pk_fma_f32 v[42:43], v[42:43], s[60:61], v[12:13]
    v_pk_fma_f32 v[44:45], v[44:45], s[60:61], v[12:13]
    v_pk_fma_f32 v[46:47], v[46:47], s[60:61], v[12:13]
    v_pk_fma_f32 v[48:49], v[48:49], s[60:61], v[12:13]
    v_pk_fma_f32 v[50:51], v[50:51], s[60:61], v[12:13]
    v_pk_fma_f32 v[52:53], v[52:53], s[60:61], v[12:13]
    v_pk_fma_f32 v[54:55], v[54:55], s[60:61], v[12:13]
    v_pk_fma_f32 v[56:57], v[56:57], s[60:61], v[12:13]
    v_pk_fma_f32 v[58:59], v[58:59], s[60:61], v[12:13]
    v_pk_fma_f32 v[60:61], v[60:61], s[60:61], v[12:13]
    v_pk_fma_f32 v[62:63], v[62:63], s[60:61], v[12:13]
    v_pk_mul_f32 v[32:33], v[32:33], v[80:81]
    v_pk_mul_f32 v[34:35], v[34:35], v[82:83]
    v_pk_mul_f32 v[36:37], v[36:37], v[84:85]
    v_pk_mul_f32 v[38:39], v[38:39], v[86:87]
    v_pk_mul_f32 v[40:41], v[40:41], v[88:89]
    v_pk_mul_f32 v[42:43], v[42:43], v[90:91]
    v_pk_mul_f32 v[44:45], v[44:45], v[92:93]
    v_pk_mul_f32 v[46:47], v[46:47], v[94:95]
    v_pk_mul_f32 v[48:49], v[48:49], v[96:97]
    v_pk_mul_f32 v[50:51], v[50:51], v[98:99]
    v_pk_mul_f32 v[52:53], v[52:53], v[100:101]
    v_pk_mul_f32 v[54:55], v[54:55], v[102:103]
    v_pk_mul_f32 v[56:57], v[56:57], v[104:105]
    v_pk_mul_f32 v[58:59], v[58:59], v[106:107]
    v_pk_mul_f32 v[60:61], v[60:61], v[108:109]
    v_pk_mul_f32 v[62:63], v[62:63], v[110:111]
    v_exp_f32 v32, v32
    v_exp_f32 v33, v33
    v_exp_f32 v34, v34
    v_exp_f32 v35, v35
    v_exp_f32 v36, v36
    v_exp_f32 v37, v37
    v_exp_f32 v38, v38
    v_exp_f32 v39, v39
    v_exp_f32 v40, v40
    v_exp_f32 v41, v41
    v_exp_f32 v42, v42
    v_exp_f32 v43, v43
    v_exp_f32 v44, v44
    v_exp_f32 v45, v45
    v_exp_f32 v46, v46
    v_exp_f32 v47, v47
    v_exp_f32 v48, v48
    v_exp_f32 v49, v49
    v_exp_f32 v50, v50
    v_exp_f32 v51, v51
    v_exp_f32 v52, v52
    v_exp_f32 v53, v53
    v_exp_f32 v54, v54
    v_exp_f32 v55, v55
    v_exp_f32 v56, v56
    v_exp_f32 v57, v57
    v_exp_f32 v58, v58
    v_exp_f32 v59, v59
    v_exp_f32 v60, v60
    v_exp_f32 v61, v61
    v_exp_f32 v62, v62
    v_exp_f32 v63, v63
    v_pk_add_f32 v[32:33], v[32:33], 1.0 op_sel_hi:[1,0]
    v_pk_add_f32 v[34:35], v[34:35], 1.0 op_sel_hi:[1,0]
    v_pk_add_f32 v[36:37], v[36:37], 1.0 op_sel_hi:[1,0]
    v_pk_add_f32 v[38:39], v[38:39], 1.0 op_sel_hi:[1,0]
    v_pk_add_f32 v[40:41], v[40:41], 1.0 op_sel_hi:[1,0]
    v_pk_add_f32 v[42:43], v[42:43], 1.0 op_sel_hi:[1,0]
    v_pk_add_f32 v[44:45], v[44:45], 1.0 op_sel_hi:[1,0]
    v_pk_add_f32 v[46:47], v[46:47], 1.0 op_sel_hi:[1,0]
    v_pk_add_f32 v[48:49], v[48:49], 1.0 op_sel_hi:[1,0]
    v_pk_add_f32 v[50:51], v[50:51], 1.0 op_sel_hi:[1,0]
    v_pk_add_f32 v[52:53], v[52:53], 1.0 op_sel_hi:[1,0]
    v_pk_add_f32 v[54:55], v[54:55], 1.0 op_sel_hi:[1,0]
    v_pk_add_f32 v[56:57], v[56:57], 1.0 op_sel_hi:[1,0]
    v_pk_add_f32 v[58:59], v[58:59], 1.0 op_sel_hi:[1,0]
    v_pk_add_f32 v[60:61], v[60:61], 1.0 op_sel_hi:[1,0]
    v_pk_add_f32 v[62:63], v[62:63], 1.0 op_sel_hi:[1,0]
    v_rcp_f32 v32, v32
    v_rcp_f32 v33, v33
    v_rcp_f32 v34, v34
    v_rcp_f32 v35, v35
    v_rcp_f32 v36, v36
    v_rcp_f32 v37, v37
    v_rcp_f32 v38, v38
    v_rcp_f32 v39, v39
    v_rcp_f32 v40, v40
    v_rcp_f32 v41, v41
    v_rcp_f32 v42, v42
    v_rcp_f32 v43, v43
    v_rcp_f32 v44, v44
    v_rcp_f32 v45, v45
    v_rcp_f32 v46, v46
    v_rcp_f32 v47, v47
    v_rcp_f32 v48, v48
    v_rcp_f32 v49, v49
    v_rcp_f32 v50, v50
    v_rcp_f32 v51, v51
    v_rcp_f32 v52, v52
    v_rcp_f32 v53, v53
    v_rcp_f32 v54, v54
    v_rcp_f32 v55, v55
    v_rcp_f32 v56, v56
    v_rcp_f32 v57, v57
    v_rcp_f32 v58, v58
    v_rcp_f32 v59, v59
    v_rcp_f32 v60, v60
    v_rcp_f32 v61, v61
    v_rcp_f32 v62, v62
    v_rcp_f32 v63, v63
    v_pk_mul_f32 v[80:81], v[80:81], v[32:33]
    v_pk_mul_f32 v[82:83], v[82:83], v[34:35]
    v_pk_mul_f32 v[84:85], v[84:85], v[36:37]
    v_pk_mul_f32 v[86:87], v[86:87], v[38:39]
    v_pk_mul_f32 v[88:89], v[88:89], v[40:41]
    v_pk_mul_f32 v[90:91], v[90:91], v[42:43]
    v_pk_mul_f32 v[92:93], v[92:93], v[44:45]
    v_pk_mul_f32 v[94:95], v[94:95], v[46:47]
    v_pk_mul_f32 v[96:97], v[96:97], v[48:49]
    v_pk_mul_f32 v[98:99], v[98:99], v[50:51]
    v_pk_mul_f32 v[100:101], v[100:101], v[52:53]
    v_pk_mul_f32 v[102:103], v[102:103], v[54:55]
    v_pk_mul_f32 v[104:105], v[104:105], v[56:57]
    v_pk_mul_f32 v[106:107], v[106:107], v[58:59]
    v_pk_mul_f32 v[108:109], v[108:109], v[60:61]
    v_pk_mul_f32 v[110:111], v[110:111], v[62:63]
    v_and_b32 v2, 19, v1
    v_lshlrev_b32 v15, 5, v2
    v_bfe_u32 v2, v1, 2, 1
    v_lshl_add_u32 v15, v2, 8, v15
    v_bfe_u32 v2, v1, 3, 1
    v_lshl_add_u32 v15, v2, 7, v15
    v_lshrrev_b32 v2, 5, v1
    v_lshl_add_u32 v15, v2, 4, v15
    s_mul_i32 s56, s3, 7168
    s_add_u32 s56, s56, 65536
    v_add_u32 v15, s56, v15
    v_lshlrev_b32 v8, 9, v2
    v_and_b32 v2, 31, v1
    v_lshl_add_u32 v8, v2, 3, v8
    v_add_u32 v8, s56, v8
    v_lshlrev_b32 v9, 4, v1
    v_add_u32 v10, s56, v9
    s_lshl_b32 s56, s21, 6
    s_add_u32 s56, s56, s57
    s_mul_i32 s56, s56, 7168
    s_add_u32 s58, s56, 4096
    s_mov_b32 s64, 0
L_mm_kernel_poll_54:
    s_sleep 3
    buffer_load_dwordx2 v[32:33], v14, s[44:47], s62 offen offset:0 sc1
    buffer_load_dwordx2 v[34:35], v14, s[44:47], s62 offen offset:512 sc1
    buffer_load_dwordx2 v[36:37], v14, s[44:47], s62 offen offset:1024 sc1
    buffer_load_dwordx2 v[38:39], v14, s[44:47], s62 offen offset:1536 sc1
    buffer_load_dwordx2 v[40:41], v14, s[44:47], s62 offen offset:2048 sc1
    buffer_load_dwordx2 v[42:43], v14, s[44:47], s62 offen offset:2560 sc1
    buffer_load_dwordx2 v[44:45], v14, s[44:47], s62 offen offset:3072 sc1
    buffer_load_dwordx2 v[46:47], v14, s[44:47], s62 offen offset:3584 sc1
    s_waitcnt vmcnt(0)
    v_mov_b32 v2, 0
    v_min3_f32 v2, v2, v33, v35
    v_min3_f32 v2, v2, v37, v39
    v_min3_f32 v2, v2, v41, v43
    v_min3_f32 v2, v2, v45, v47
    v_cmp_gt_f32 vcc, 0, v2
    s_cbranch_vccz L_mm_kernel_got_55
    s_add_u32 s64, s64, 1
    s_cmp_lt_u32 s64, 0x100000
    s_cbranch_scc1 L_mm_kernel_poll_54
L_mm_kernel_got_55:
    v_pk_add_f32 v[32:33], v[32:33], v[40:41]
    v_pk_add_f32 v[34:35], v[34:35], v[42:43]
    v_pk_add_f32 v[36:37], v[36:37], v[44:45]
    v_pk_add_f32 v[38:39], v[38:39], v[46:47]
    v_pk_add_f32 v[32:33], v[32:33], v[36:37]
    v_pk_add_f32 v[34:35], v[34:35], v[38:39]
    v_pk_add_f32 v[32:33], v[32:33], v[34:35]
    v_mov_b32 v34, v32
    s_nop 1
    v_permlane32_swap_b32 v32, v34
    v_add_f32 v32, v32, v34
    v_mov_b32 v35, v33
    s_nop 1
    v_permlane32_swap_b32 v33, v35
    v_add_f32 v33, v33, v35
    v_mul_f32 v2, 0x3a124925, v32
    v_mul_f32 v3, v2, v2
    v_mul_f32 v33, 0x3a124925, v33
    v_sub_f32 v3, v33, v3
    v_max_f32 v3, 0, v3
    v_add_f32 v3, 0x3727c5ac, v3
    v_rsq_f32 v32, v3
    s_nop 0
    v_mul_f32 v33, v2, v32
    v_sub_f32 v33, 0, v33
    v_mov_b32 v4, v32
    v_mov_b32 v5, v33
    v_mov_b32 v6, v4
    v_mov_b32 v7, v5
    s_nop 0
    v_permlane16_swap_b32 v4, v6
    s_nop 0
    v_permlane16_swap_b32 v5, v7
    v_pk_fma_f32 v[136:137], v[136:137], v[4:5], v[4:5] op_sel:[0,0,1] op_sel_hi:[1,0,1]
    v_pk_fma_f32 v[138:139], v[138:139], v[4:5], v[4:5] op_sel:[0,0,1] op_sel_hi:[1,0,1]
    v_pk_fma_f32 v[140:141], v[140:141], v[6:7], v[6:7] op_sel:[0,0,1] op_sel_hi:[1,0,1]
    v_pk_fma_f32 v[142:143], v[142:143], v[6:7], v[6:7] op_sel:[0,0,1] op_sel_hi:[1,0,1]
    v_cvt_pk_bf16_f32 v136, v136, v137
    v_cvt_pk_bf16_f32 v137, v138, v139
    v_cvt_pk_bf16_f32 v138, v140, v141
    v_cvt_pk_bf16_f32 v139, v142, v143
    s_nop 0
    v_permlane16_swap_b32 v136, v138
    s_nop 0
    v_permlane16_swap_b32 v137, v139
    ds_write_b128 v15, v[136:139] offset:0
    ds_read_b64_tr_b16 v[140:141], v8 offset:0
    ds_read_b64_tr_b16 v[142:143], v8 offset:256
    v_pk_fma_f32 v[144:145], v[144:145], v[4:5], v[4:5] op_sel:[0,0,1] op_sel_hi:[1,0,1]
    v_pk_fma_f32 v[146:147], v[146:147], v[4:5], v[4:5] op_sel:[0,0,1] op_sel_hi:[1,0,1]
    v_pk_fma_f32 v[148:149], v[148:149], v[6:7], v[6:7] op_sel:[0,0,1] op_sel_hi:[1,0,1]
    v_pk_fma_f32 v[150:151], v[150:151], v[6:7], v[6:7] op_sel:[0,0,1] op_sel_hi:[1,0,1]
    v_cvt_pk_bf16_f32 v144, v144, v145
    v_cvt_pk_bf16_f32 v145, v146, v147
    v_cvt_pk_bf16_f32 v146, v148, v149
    v_cvt_pk_bf16_f32 v147, v150, v151
    s_nop 0
    v_permlane16_swap_b32 v144, v146
    s_nop 0
    v_permlane16_swap_b32 v145, v147
    ds_write_b128 v15, v[144:147] offset:1024
    ds_read_b64_tr_b16 v[148:149], v8 offset:1024
    ds_read_b64_tr_b16 v[150:151], v8 offset:1280
    s_waitcnt lgkmcnt(3)
    buffer_store_dwordx4 v[140:143], v9, s[40:43], s56 offen offset:0 sc1
    ds_write_b128 v10, v[140:143] offset:0
    v_pk_fma_f32 v[152:153], v[152:153], v[4:5], v[4:5] op_sel:[0,0,1] op_sel_hi:[1,0,1]
    v_pk_fma_f32 v[154:155], v[154:155], v[4:5], v[4:5] op_sel:[0,0,1] op_sel_hi:[1,0,1]
    v_pk_fma_f32 v[156:157], v[156:157], v[6:7], v[6:7] op_sel:[0,0,1] op_sel_hi:[1,0,1]
    v_pk_fma_f32 v[158:159], v[158:159], v[6:7], v[6:7] op_sel:[0,0,1] op_sel_hi:[1,0,1]
    v_cvt_pk_bf16_f32 v152, v152, v153
    v_cvt_pk_bf16_f32 v153, v154, v155
    v_cvt_pk_bf16_f32 v154, v156, v157
    v_cvt_pk_bf16_f32 v155, v158, v159
    s_nop 0
    v_permlane16_swap_b32 v152, v154
    s_nop 0
    v_permlane16_swap_b32 v153, v155
    ds_write_b128 v15, v[152:155] offset:2048
    ds_read_b64_tr_b16 v[156:157], v8 offset:2048
    ds_read_b64_tr_b16 v[158:159], v8 offset:2304
    s_waitcnt lgkmcnt(3)
    buffer_store_dwordx4 v[148:151], v9, s[40:43], s56 offen offset:1024 sc1
    ds_write_b128 v10, v[148:151] offset:1024
    v_pk_fma_f32 v[160:161], v[160:161], v[4:5], v[4:5] op_sel:[0,0,1] op_sel_hi:[1,0,1]
    v_pk_fma_f32 v[162:163], v[162:163], v[4:5], v[4:5] op_sel:[0,0,1] op_sel_hi:[1,0,1]
    v_pk_fma_f32 v[164:165], v[164:165], v[6:7], v[6:7] op_sel:[0,0,1] op_sel_hi:[1,0,1]
    v_pk_fma_f32 v[166:167], v[166:167], v[6:7], v[6:7] op_sel:[0,0,1] op_sel_hi:[1,0,1]
    v_cvt_pk_bf16_f32 v160, v160, v161
    v_cvt_pk_bf16_f32 v161, v162, v163
    v_cvt_pk_bf16_f32 v162, v164, v165
    v_cvt_pk_bf16_f32 v163, v166, v167
    s_nop 0
    v_permlane16_swap_b32 v160, v162
    s_nop 0
    v_permlane16_swap_b32 v161, v163
    ds_write_b128 v15, v[160:163] offset:3072
    ds_read_b64_tr_b16 v[164:165], v8 offset:3072
    ds_read_b64_tr_b16 v[166:167], v8 offset:3328
    s_waitcnt lgkmcnt(3)
    buffer_store_dwordx4 v[156:159], v9, s[40:43], s56 offen offset:2048 sc1
    ds_write_b128 v10, v[156:159] offset:2048
    v_pk_fma_f32 v[168:169], v[168:169], v[4:5], v[4:5] op_sel:[0,0,1] op_sel_hi:[1,0,1]
    v_pk_fma_f32 v[170:171], v[170:171], v[4:5], v[4:5] op_sel:[0,0,1] op_sel_hi:[1,0,1]
    v_pk_fma_f32 v[172:173], v[172:173], v[6:7], v[6:7] op_sel:[0,0,1] op_sel_hi:[1,0,1]
    v_pk_fma_f32 v[174:175], v[174:175], v[6:7], v[6:7] op_sel:[0,0,1] op_sel_hi:[1,0,1]
    v_cvt_pk_bf16_f32 v168, v168, v169
    v_cvt_pk_bf16_f32 v169, v170, v171
    v_cvt_pk_bf16_f32 v170, v172, v173
    v_cvt_pk_bf16_f32 v171, v174, v175
    s_nop 0
    v_permlane16_swap_b32 v168, v170
    s_nop 0
    v_permlane16_swap_b32 v169, v171
    ds_write_b128 v15, v[168:171] offset:4096
    ds_read_b64_tr_b16 v[172:173], v8 offset:4096
    ds_read_b64_tr_b16 v[174:175], v8 offset:4352
    s_waitcnt lgkmcnt(3)
    buffer_store_dwordx4 v[164:167], v9, s[40:43], s56 offen offset:3072 sc1
    ds_write_b128 v10, v[164:167] offset:3072
    v_pk_fma_f32 v[176:177], v[176:177], v[4:5], v[4:5] op_sel:[0,0,1] op_sel_hi:[1,0,1]
    v_pk_fma_f32 v[178:179], v[178:179], v[4:5], v[4:5] op_sel:[0,0,1] op_sel_hi:[1,0,1]
    v_pk_fma_f32 v[180:181], v[180:181], v[6:7], v[6:7] op_sel:[0,0,1] op_sel_hi:[1,0,1]
    v_pk_fma_f32 v[182:183], v[182:183], v[6:7], v[6:7] op_sel:[0,0,1] op_sel_hi:[1,0,1]
    v_cvt_pk_bf16_f32 v176, v176, v177
    v_cvt_pk_bf16_f32 v177, v178, v179
    v_cvt_pk_bf16_f32 v178, v180, v181
    v_cvt_pk_bf16_f32 v179, v182, v183
    s_nop 0
    v_permlane16_swap_b32 v176, v178
    s_nop 0
    v_permlane16_swap_b32 v177, v179
    ds_write_b128 v15, v[176:179] offset:5120
    ds_read_b64_tr_b16 v[180:181], v8 offset:5120
    ds_read_b64_tr_b16 v[182:183], v8 offset:5376
    s_waitcnt lgkmcnt(3)
    buffer_store_dwordx4 v[172:175], v9, s[40:43], s58 offen offset:0 sc1
    ds_write_b128 v10, v[172:175] offset:4096
    v_pk_fma_f32 v[184:185], v[184:185], v[4:5], v[4:5] op_sel:[0,0,1] op_sel_hi:[1,0,1]
    v_pk_fma_f32 v[186:187], v[186:187], v[4:5], v[4:5] op_sel:[0,0,1] op_sel_hi:[1,0,1]
    v_pk_fma_f32 v[188:189], v[188:189], v[6:7], v[6:7] op_sel:[0,0,1] op_sel_hi:[1,0,1]
    v_pk_fma_f32 v[190:191], v[190:191], v[6:7], v[6:7] op_sel:[0,0,1] op_sel_hi:[1,0,1]
    v_cvt_pk_bf16_f32 v184, v184, v185
    v_cvt_pk_bf16_f32 v185, v186, v187
    v_cvt_pk_bf16_f32 v186, v188, v189
    v_cvt_pk_bf16_f32 v187, v190, v191
    s_nop 0
    v_permlane16_swap_b32 v184, v186
    s_nop 0
    v_permlane16_swap_b32 v185, v187
    ds_write_b128 v15, v[184:187] offset:6144
    ds_read_b64_tr_b16 v[188:189], v8 offset:6144
    ds_read_b64_tr_b16 v[190:191], v8 offset:6400
    s_waitcnt lgkmcnt(3)
    buffer_store_dwordx4 v[180:183], v9, s[40:43], s58 offen offset:1024 sc1
    ds_write_b128 v10, v[180:183] offset:5120
    s_waitcnt lgkmcnt(0)
    buffer_store_dwordx4 v[188:191], v9, s[40:43], s58 offen offset:2048 sc1
    ds_write_b128 v10, v[188:191] offset:6144
    v_pk_mul_f32 v[32:33], v[112:113], v[112:113]
    v_pk_mul_f32 v[34:35], v[114:115], v[114:115]
    v_pk_mul_f32 v[36:37], v[116:117], v[116:117]
    v_pk_mul_f32 v[38:39], v[118:119], v[118:119]
    v_pk_mul_f32 v[40:41], v[120:121], v[120:121]
    v_pk_mul_f32 v[42:43], v[122:123], v[122:123]
    v_pk_mul_f32 v[44:45], v[124:125], v[124:125]
    v_pk_mul_f32 v[46:47], v[126:127], v[126:127]
    v_pk_mul_f32 v[48:49], v[128:129], v[128:129]
    v_pk_mul_f32 v[50:51], v[130:131], v[130:131]
    v_pk_mul_f32 v[52:53], v[132:133], v[132:133]
    v_pk_mul_f32 v[54:55], v[134:135], v[134:135]
    v_pk_fma_f32 v[32:33], v[32:33], s[60:61], v[12:13]
    v_pk_fma_f32 v[34:35], v[34:35], s[60:61], v[12:13]
    v_pk_fma_f32 v[36:37], v[36:37], s[60:61], v[12:13]
    v_pk_fma_f32 v[38:39], v[38:39], s[60:61], v[12:13]
    v_pk_fma_f32 v[40:41], v[40:41], s[60:61], v[12:13]
    v_pk_fma_f32 v[42:43], v[42:43], s[60:61], v[12:13]
    v_pk_fma_f32 v[44:45], v[44:45], s[60:61], v[12:13]
    v_pk_fma_f32 v[46:47], v[46:47], s[60:61], v[12:13]
    v_pk_fma_f32 v[48:49], v[48:49], s[60:61], v[12:13]
    v_pk_fma_f32 v[50:51], v[50:51], s[60:61], v[12:13]
    v_pk_fma_f32 v[52:53], v[52:53], s[60:61], v[12:13]
    v_pk_fma_f32 v[54:55], v[54:55], s[60:61], v[12:13]
    v_pk_mul_f32 v[32:33], v[32:33], v[112:113]
    v_pk_mul_f32 v[34:35], v[34:35], v[114:115]
    v_pk_mul_f32 v[36:37], v[36:37], v[116:117]
    v_pk_mul_f32 v[38:39], v[38:39], v[118:119]
    v_pk_mul_f32 v[40:41], v[40:41], v[120:121]
    v_pk_mul_f32 v[42:43], v[42:43], v[122:123]
    v_pk_mul_f32 v[44:45], v[44:45], v[124:125]
    v_pk_mul_f32 v[46:47], v[46:47], v[126:127]
    v_pk_mul_f32 v[48:49], v[48:49], v[128:129]
    v_pk_mul_f32 v[50:51], v[50:51], v[130:131]
    v_pk_mul_f32 v[52:53], v[52:53], v[132:133]
    v_pk_mul_f32 v[54:55], v[54:55], v[134:135]
    v_exp_f32 v32, v32
    v_exp_f32 v33, v33
    v_exp_f32 v34, v34
    v_exp_f32 v35, v35
    v_exp_f32 v36, v36
    v_exp_f32 v37, v37
    v_exp_f32 v38, v38
    v_exp_f32 v39, v39
    v_exp_f32 v40, v40
    v_exp_f32 v41, v41
    v_exp_f32 v42, v42
    v_exp_f32 v43, v43
    v_exp_f32 v44, v44
    v_exp_f32 v45, v45
    v_exp_f32 v46, v46
    v_exp_f32 v47, v47
    v_exp_f32 v48, v48
    v_exp_f32 v49, v49
    v_exp_f32 v50, v50
    v_exp_f32 v51, v51
    v_exp_f32 v52, v52
    v_exp_f32 v53, v53
    v_exp_f32 v54, v54
    v_exp_f32 v55, v55
    v_pk_add_f32 v[32:33], v[32:33], 1.0 op_sel_hi:[1,0]
    v_pk_add_f32 v[34:35], v[34:35], 1.0 op_sel_hi:[1,0]
    v_pk_add_f32 v[36:37], v[36:37], 1.0 op_sel_hi:[1,0]
    v_pk_add_f32 v[38:39], v[38:39], 1.0 op_sel_hi:[1,0]
    v_pk_add_f32 v[40:41], v[40:41], 1.0 op_sel_hi:[1,0]
    v_pk_add_f32 v[42:43], v[42:43], 1.0 op_sel_hi:[1,0]
    v_pk_add_f32 v[44:45], v[44:45], 1.0 op_sel_hi:[1,0]
    v_pk_add_f32 v[46:47], v[46:47], 1.0 op_sel_hi:[1,0]
    v_pk_add_f32 v[48:49], v[48:49], 1.0 op_sel_hi:[1,0]
    v_pk_add_f32 v[50:51], v[50:51], 1.0 op_sel_hi:[1,0]
    v_pk_add_f32 v[52:53], v[52:53], 1.0 op_sel_hi:[1,0]
    v_pk_add_f32 v[54:55], v[54:55], 1.0 op_sel_hi:[1,0]
    v_rcp_f32 v32, v32
    v_rcp_f32 v33, v33
    v_rcp_f32 v34, v34
    v_rcp_f32 v35, v35
    v_rcp_f32 v36, v36
    v_rcp_f32 v37, v37
    v_rcp_f32 v38, v38
    v_rcp_f32 v39, v39
    v_rcp_f32 v40, v40
    v_rcp_f32 v41, v41
    v_rcp_f32 v42, v42
    v_rcp_f32 v43, v43
    v_rcp_f32 v44, v44
    v_rcp_f32 v45, v45
    v_rcp_f32 v46, v46
    v_rcp_f32 v47, v47
    v_rcp_f32 v48, v48
    v_rcp_f32 v49, v49
    v_rcp_f32 v50, v50
    v_rcp_f32 v51, v51
    v_rcp_f32 v52, v52
    v_rcp_f32 v53, v53
    v_rcp_f32 v54, v54
    v_rcp_f32 v55, v55
    v_pk_mul_f32 v[112:113], v[112:113], v[32:33]
    v_pk_mul_f32 v[114:115], v[114:115], v[34:35]
    v_pk_mul_f32 v[116:117], v[116:117], v[36:37]
    v_pk_mul_f32 v[118:119], v[118:119], v[38:39]
    v_pk_mul_f32 v[120:121], v[120:121], v[40:41]
    v_pk_mul_f32 v[122:123], v[122:123], v[42:43]
    v_pk_mul_f32 v[124:125], v[124:125], v[44:45]
    v_pk_mul_f32 v[126:127], v[126:127], v[46:47]
    v_pk_mul_f32 v[128:129], v[128:129], v[48:49]
    v_pk_mul_f32 v[130:131], v[130:131], v[50:51]
    v_pk_mul_f32 v[132:133], v[132:133], v[52:53]
    v_pk_mul_f32 v[134:135], v[134:135], v[54:55]
    s_add_u32 s40, s6, 40894464
    s_addc_u32 s41, s7, 0
    s_mov_b32 s42, 7340032
    s_mov_b32 s43, 0x20000
    v_bfe_u32 v2, v1, 4, 1
    v_lshlrev_b32 v12, 10, v2
    v_lshrrev_b32 v2, 5, v1
    v_lshl_add_u32 v12, v2, 8, v12
    v_and_b32 v2, 15, v1
    v_lshl_add_u32 v12, v2, 4, v12
    s_mul_i32 s61, s20, 458752
    s_lshl_b32 s62, s3, 11
    s_add_u32 s61, s61, s62
    s_mul_i32 s62, s21, 7
    s_add_u32 s63, s62, 0
    s_lshr_b32 s64, s63, 1
    s_lshl_b32 s64, s64, 13
    s_and_b32 s63, s63, 1
    s_lshl_b32 s63, s63, 9
    s_add_u32 s63, s63, s64
    s_add_u32 s66, s63, s61
    s_add_u32 s63, s62, 1
    s_lshr_b32 s64, s63, 1
    s_lshl_b32 s64, s64, 13
    s_and_b32 s63, s63, 1
    s_lshl_b32 s63, s63, 9
    s_add_u32 s63, s63, s64
    s_add_u32 s67, s63, s61
    s_add_u32 s63, s62, 2
    s_lshr_b32 s64, s63, 1
    s_lshl_b32 s64, s64, 13
    s_and_b32 s63, s63, 1
    s_lshl_b32 s63, s63, 9
    s_add_u32 s63, s63, s64
    s_add_u32 s68, s63, s61
    s_add_u32 s63, s62, 3
    s_lshr_b32 s64, s63, 1
    s_lshl_b32 s64, s64, 13
    s_and_b32 s63, s63, 1
    s_lshl_b32 s63, s63, 9
    s_add_u32 s63, s63, s64
    s_add_u32 s69, s63, s61
    s_add_u32 s63, s62, 4
    s_lshr_b32 s64, s63, 1
    s_lshl_b32 s64, s64, 13
    s_and_b32 s63, s63, 1
    s_lshl_b32 s63, s63, 9
    s_add_u32 s63, s63, s64
    s_add_u32 s70, s63, s61
    s_add_u32 s63, s62, 5
    s_lshr_b32 s64, s63, 1
    s_lshl_b32 s64, s64, 13
    s_and_b32 s63, s63, 1
    s_lshl_b32 s63, s63, 9
    s_add_u32 s63, s63, s64
    s_add_u32 s71, s63, s61
    s_add_u32 s63, s62, 6
    s_lshr_b32 s64, s63, 1
    s_lshl_b32 s64, s64, 13
    s_and_b32 s63, s63, 1
    s_lshl_b32 s63, s63, 9
    s_add_u32 s63, s63, s64
    s_add_u32 s72, s63, s61
    v_bfe_u32 v2, v1, 1, 3
    v_lshrrev_b32 v3, 4, v1
    v_xor_b32 v2, v2, v3
    v_lshlrev_b32 v2, 4, v2
    v_and_b32 v3, 15, v1
    v_lshl_add_u32 v2, v3, 7, v2
    s_lshl_b32 s50, s3, 12
    s_add_u32 s50, s50, 0
    v_add_u32 v4, s50, v2
    v_lshlrev_b32 v5, 4, v1
    v_add_u32 v5, 65536, v5
    v_mov_b32 v136, v192
    v_mov_b32 v137, v192
    v_mov_b32 v138, v192
    v_mov_b32 v139, v192
    v_mov_b32 v140, v193
    v_mov_b32 v141, v193
    v_mov_b32 v142, v193
    v_mov_b32 v143, v193
    v_mov_b32 v144, v192
    v_mov_b32 v145, v192
    v_mov_b32 v146, v192
    v_mov_b32 v147, v192
    v_mov_b32 v148, v193
    v_mov_b32 v149, v193
    v_mov_b32 v150, v193
    v_mov_b32 v151, v193
    v_mov_b32 v152, v192
    v_mov_b32 v153, v192
    v_mov_b32 v154, v192
    v_mov_b32 v155, v192
    v_mov_b32 v156, v193
    v_mov_b32 v157, v193
    v_mov_b32 v158, v193
    v_mov_b32 v159, v193
    v_mov_b32 v160, v192
    v_mov_b32 v161, v192
    v_mov_b32 v162, v192
    v_mov_b32 v163, v192
    v_mov_b32 v164, v193
    v_mov_b32 v165, v193
    v_mov_b32 v166, v193
    v_mov_b32 v167, v193
    v_mov_b32 v168, v192
    v_mov_b32 v169, v192
    v_mov_b32 v170, v192
    v_mov_b32 v171, v192
    v_mov_b32 v172, v193
    v_mov_b32 v173, v193
    v_mov_b32 v174, v193
    v_mov_b32 v175, v193
    v_mov_b32 v176, v192
    v_mov_b32 v177, v192
    v_mov_b32 v178, v192
    v_mov_b32 v179, v192
    v_mov_b32 v180, v193
    v_mov_b32 v181, v193
    v_mov_b32 v182, v193
    v_mov_b32 v183, v193
    v_mov_b32 v184, v192
    v_mov_b32 v185, v192
    v_mov_b32 v186, v192
    v_mov_b32 v187, v192
    v_mov_b32 v188, v193
    v_mov_b32 v189, v193
    v_mov_b32 v190, v193
    v_mov_b32 v191, v193
    s_mov_b32 s52, 0
    s_mov_b32 s53, 0
    s_mov_b32 s54, 0
    v_add_u32 v6, s52, v4
    v_add_u32 v10, s53, v5
    v_xor_b32 v7, 64, v6
    s_waitcnt lgkmcnt(0)
    s_add_u32 s32, s6, 57147392
    s_addc_u32 s33, s7, 0
    s_mov_b32 s34, 327680
    s_mov_b32 s35, 0x20000
    s_lshl_b32 s56, s21, 11
    s_lshl_b32 s57, s20, 7
    s_add_u32 s56, s56, s57
    s_add_u32 s56, s56, 32768
    v_mov_b32 v2, 0
    v_mov_b32 v3, 1.0
    s_waitcnt vmcnt(0)
    s_barrier
    s_cmp_lg_u32 s3, 0
    s_cbranch_scc1 L_mm_kernel_nosig_56
    s_mov_b64 exec, 1
    buffer_store_dword v3, v2, s[32:35], s56 offen sc1
    s_mov_b64 exec, -1
L_mm_kernel_nosig_56:
    ds_read_b128 v[32:35], v6 offset:0
    ds_read_b128 v[36:39], v6 offset:2048
    ds_read_b128 v[48:51], v10 offset:0
    ds_read_b128 v[52:55], v10 offset:1024
    ds_read_b128 v[56:59], v10 offset:2048
    ds_read_b128 v[60:63], v10 offset:3072
    ds_read_b128 v[64:67], v10 offset:4096
    ds_read_b128 v[68:71], v10 offset:5120
L_mm_kernel_cloop_57:
    s_waitcnt lgkmcnt(5)
    v_mfma_f32_16x16x32_bf16 v[136:139], v[48:51], v[32:35], v[136:139]
    ds_read_b128 v[72:75], v10 offset:6144
    v_mfma_f32_16x16x32_bf16 v[140:143], v[48:51], v[36:39], v[140:143]
    s_add_u32 s52, s52, 16384
    s_waitcnt lgkmcnt(5)
    v_mfma_f32_16x16x32_bf16 v[144:147], v[52:55], v[32:35], v[144:147]
    ds_read_b128 v[40:43], v7 offset:0
    ds_read_b128 v[44:47], v7 offset:2048
    v_mfma_f32_16x16x32_bf16 v[148:151], v[52:55], v[36:39], v[148:151]
    ds_read_b128 v[48:51], v10 offset:7168
    s_cmp_ge_u32 s52, 65536
    s_waitcnt lgkmcnt(7)
    v_mfma_f32_16x16x32_bf16 v[152:155], v[56:59], v[32:35], v[152:155]
    ds_read_b128 v[52:55], v10 offset:8192
    v_mfma_f32_16x16x32_bf16 v[156:159], v[56:59], v[36:39], v[156:159]
    s_cselect_b32 s52, 0, s52
    s_waitcnt lgkmcnt(7)
    v_mfma_f32_16x16x32_bf16 v[160:163], v[60:63], v[32:35], v[160:163]
    ds_read_b128 v[56:59], v10 offset:9216
    v_mfma_f32_16x16x32_bf16 v[164:167], v[60:63], v[36:39], v[164:167]
    s_add_u32 s53, s53, 14336
    s_waitcnt lgkmcnt(7)
    v_mfma_f32_16x16x32_bf16 v[168:171], v[64:67], v[32:35], v[168:171]
    ds_read_b128 v[60:63], v10 offset:10240
    v_mfma_f32_16x16x32_bf16 v[172:175], v[64:67], v[36:39], v[172:175]
    s_cmp_ge_u32 s53, 57344
    s_waitcnt lgkmcnt(7)
    v_mfma_f32_16x16x32_bf16 v[176:179], v[68:71], v[32:35], v[176:179]
    ds_read_b128 v[64:67], v10 offset:11264
    v_mfma_f32_16x16x32_bf16 v[180:183], v[68:71], v[36:39], v[180:183]
    s_cselect_b32 s53, 0, s53
    s_waitcnt lgkmcnt(7)
    v_mfma_f32_16x16x32_bf16 v[184:187], v[72:75], v[32:35], v[184:187]
    ds_read_b128 v[68:71], v10 offset:12288
    v_mfma_f32_16x16x32_bf16 v[188:191], v[72:75], v[36:39], v[188:191]
    s_add_u32 s54, s54, 1
    s_waitcnt lgkmcnt(5)
    v_mfma_f32_16x16x32_bf16 v[136:139], v[48:51], v[40:43], v[136:139]
    ds_read_b128 v[72:75], v10 offset:13312
    v_mfma_f32_16x16x32_bf16 v[140:143], v[48:51], v[44:47], v[140:143]
    s_cmp_lt_u32 s54, 32
    s_waitcnt lgkmcnt(5)
    v_mfma_f32_16x16x32_bf16 v[144:147], v[52:55], v[40:43], v[144:147]
    v_mfma_f32_16x16x32_bf16 v[148:151], v[52:55], v[44:47], v[148:151]
    s_waitcnt lgkmcnt(4)
    v_mfma_f32_16x16x32_bf16 v[152:155], v[56:59], v[40:43], v[152:155]
    v_mfma_f32_16x16x32_bf16 v[156:159], v[56:59], v[44:47], v[156:159]
    s_waitcnt lgkmcnt(3)
    v_mfma_f32_16x16x32_bf16 v[160:163], v[60:63], v[40:43], v[160:163]
    v_add_u32 v6, s52, v4
    v_add_u32 v10, s53, v5
    v_xor_b32 v7, 64, v6
    s_waitcnt lgkmcnt(0)
    s_barrier
    v_mfma_f32_16x16x32_bf16 v[164:167], v[60:63], v[44:47], v[164:167]
    ds_read_b128 v[32:35], v6 offset:0
    ds_read_b128 v[36:39], v6 offset:2048
    ds_read_b128 v[48:51], v10 offset:0
    ds_read_b128 v[52:55], v10 offset:1024
    v_mfma_f32_16x16x32_bf16 v[168:171], v[64:67], v[40:43], v[168:171]
    ds_read_b128 v[56:59], v10 offset:2048
    v_mfma_f32_16x16x32_bf16 v[172:175], v[64:67], v[44:47], v[172:175]
    ds_read_b128 v[60:63], v10 offset:3072
    v_mfma_f32_16x16x32_bf16 v[176:179], v[68:71], v[40:43], v[176:179]
    ds_read_b128 v[64:67], v10 offset:4096
    v_mfma_f32_16x16x32_bf16 v[180:183], v[68:71], v[44:47], v[180:183]
    v_mfma_f32_16x16x32_bf16 v[184:187], v[72:75], v[40:43], v[184:187]
    ds_read_b128 v[68:71], v10 offset:5120
    v_mfma_f32_16x16x32_bf16 v[188:191], v[72:75], v[44:47], v[188:191]
    s_cbranch_scc1 L_mm_kernel_cloop_57
    s_waitcnt lgkmcnt(0)
    v_pk_mul_f32 v[136:137], v[136:137], v[80:81]
    v_pk_mul_f32 v[138:139], v[138:139], v[82:83]
    v_pk_mul_f32 v[140:141], v[140:141], v[84:85]
    v_pk_mul_f32 v[142:143], v[142:143], v[86:87]
    v_cvt_pk_bf16_f32 v32, v136, v137
    v_cvt_pk_bf16_f32 v33, v138, v139
    v_cvt_pk_bf16_f32 v34, v140, v141
    v_cvt_pk_bf16_f32 v35, v142, v143
    s_nop 0
    v_permlane16_swap_b32 v32, v34
    s_nop 0
    v_permlane16_swap_b32 v33, v35
    buffer_store_dwordx4 v[32:35], v12, s[40:43], s66 offen sc1
    v_pk_mul_f32 v[144:145], v[144:145], v[88:89]
    v_pk_mul_f32 v[146:147], v[146:147], v[90:91]
    v_pk_mul_f32 v[148:149], v[148:149], v[92:93]
    v_pk_mul_f32 v[150:151], v[150:151], v[94:95]
    v_cvt_pk_bf16_f32 v36, v144, v145
    v_cvt_pk_bf16_f32 v37, v146, v147
    v_cvt_pk_bf16_f32 v38, v148, v149
    v_cvt_pk_bf16_f32 v39, v150, v151
    s_nop 0
    v_permlane16_swap_b32 v36, v38
    s_nop 0
    v_permlane16_swap_b32 v37, v39
    buffer_store_dwordx4 v[36:39], v12, s[40:43], s67 offen sc1
    v_pk_mul_f32 v[152:153], v[152:153], v[96:97]
    v_pk_mul_f32 v[154:155], v[154:155], v[98:99]
    v_pk_mul_f32 v[156:157], v[156:157], v[100:101]
    v_pk_mul_f32 v[158:159], v[158:159], v[102:103]
    v_cvt_pk_bf16_f32 v40, v152, v153
    v_cvt_pk_bf16_f32 v41, v154, v155
    v_cvt_pk_bf16_f32 v42, v156, v157
    v_cvt_pk_bf16_f32 v43, v158, v159
    s_nop 0
    v_permlane16_swap_b32 v40, v42
    s_nop 0
    v_permlane16_swap_b32 v41, v43
    buffer_store_dwordx4 v[40:43], v12, s[40:43], s68 offen sc1
    v_pk_mul_f32 v[160:161], v[160:161], v[104:105]
    v_pk_mul_f32 v[162:163], v[162:163], v[106:107]
    v_pk_mul_f32 v[164:165], v[164:165], v[108:109]
    v_pk_mul_f32 v[166:167], v[166:167], v[110:111]
    v_cvt_pk_bf16_f32 v44, v160, v161
    v_cvt_pk_bf16_f32 v45, v162, v163
    v_cvt_pk_bf16_f32 v46, v164, v165
    v_cvt_pk_bf16_f32 v47, v166, v167
    s_nop 0
    v_permlane16_swap_b32 v44, v46
    s_nop 0
    v_permlane16_swap_b32 v45, v47
    buffer_store_dwordx4 v[44:47], v12, s[40:43], s69 offen sc1
    v_pk_mul_f32 v[168:169], v[168:169], v[112:113]
    v_pk_mul_f32 v[170:171], v[170:171], v[114:115]
    v_pk_mul_f32 v[172:173], v[172:173], v[116:117]
    v_pk_mul_f32 v[174:175], v[174:175], v[118:119]
    v_cvt_pk_bf16_f32 v48, v168, v169
    v_cvt_pk_bf16_f32 v49, v170, v171
    v_cvt_pk_bf16_f32 v50, v172, v173
    v_cvt_pk_bf16_f32 v51, v174, v175
    s_nop 0
    v_permlane16_swap_b32 v48, v50
    s_nop 0
    v_permlane16_swap_b32 v49, v51
    buffer_store_dwordx4 v[48:51], v12, s[40:43], s70 offen sc1
    v_pk_mul_f32 v[176:177], v[176:177], v[120:121]
    v_pk_mul_f32 v[178:179], v[178:179], v[122:123]
    v_pk_mul_f32 v[180:181], v[180:181], v[124:125]
    v_pk_mul_f32 v[182:183], v[182:183], v[126:127]
    v_cvt_pk_bf16_f32 v52, v176, v177
    v_cvt_pk_bf16_f32 v53, v178, v179
    v_cvt_pk_bf16_f32 v54, v180, v181
    v_cvt_pk_bf16_f32 v55, v182, v183
    s_nop 0
    v_permlane16_swap_b32 v52, v54
    s_nop 0
    v_permlane16_swap_b32 v53, v55
    buffer_store_dwordx4 v[52:55], v12, s[40:43], s71 offen sc1
    v_pk_mul_f32 v[184:185], v[184:185], v[128:129]
    v_pk_mul_f32 v[186:187], v[186:187], v[130:131]
    v_pk_mul_f32 v[188:189], v[188:189], v[132:133]
    v_pk_mul_f32 v[190:191], v[190:191], v[134:135]
    v_cvt_pk_bf16_f32 v56, v184, v185
    v_cvt_pk_bf16_f32 v57, v186, v187
    v_cvt_pk_bf16_f32 v58, v188, v189
    v_cvt_pk_bf16_f32 v59, v190, v191
    s_nop 0
    v_permlane16_swap_b32 v56, v58
    s_nop 0
    v_permlane16_swap_b32 v57, v59
    buffer_store_dwordx4 v[56:59], v12, s[40:43], s72 offen sc1
    s_add_u32 s32, s6, 57147392
    s_addc_u32 s33, s7, 0
    s_mov_b32 s34, 327680
    s_mov_b32 s35, 0x20000
    s_lshl_b32 s56, s20, 11
    s_lshl_b32 s57, s21, 7
    s_add_u32 s56, s56, s57
    s_add_u32 s56, s56, 65536
    v_mov_b32 v2, 0
    v_mov_b32 v3, 1.0
    s_waitcnt vmcnt(0)
    s_barrier
    s_cmp_lg_u32 s3, 0
    s_cbranch_scc1 L_mm_kernel_nosig_58
    s_mov_b64 exec, 1
    buffer_store_dword v3, v2, s[32:35], s56 offen sc1
    s_mov_b64 exec, -1
L_mm_kernel_nosig_58:
    s_mov_b32 s40, s16
    s_mov_b32 s41, s17
    s_mov_b32 s42, 4194304
    s_mov_b32 s43, 0x20000
    v_lshrrev_b32 v3, 5, v1
    v_and_b32 v13, 48, v1
    v_add_u32 v13, 162688, v13
    v_and_b32 v2, 31, v1
    v_lshlrev_b32 v12, 11, v2
    v_lshl_add_u32 v12, v3, 4, v12
    s_lshl_b32 s58, s20, 18
    s_lshl_b32 s56, s3, 16
    s_add_u32 s58, s58, s56
    s_lshl_b32 s56, s21, 7
    s_add_u32 s58, s58, s56
    ds_read_b128 v[112:115], v13 offset:768
    ds_read_b128 v[116:119], v13 offset:832
    ds_read_b128 v[120:123], v13 offset:896
    ds_read_b128 v[124:127], v13 offset:960
    v_lshlrev_b32 v144, 16, v16
    v_and_b32 v145, 0xffff0000, v16
    v_lshlrev_b32 v146, 16, v17
    v_and_b32 v147, 0xffff0000, v17
    v_lshlrev_b32 v148, 16, v18
    v_and_b32 v149, 0xffff0000, v18
    v_lshlrev_b32 v150, 16, v19
    v_and_b32 v151, 0xffff0000, v19
    v_lshlrev_b32 v152, 16, v20
    v_and_b32 v153, 0xffff0000, v20
    v_lshlrev_b32 v154, 16, v21
    v_and_b32 v155, 0xffff0000, v21
    v_lshlrev_b32 v156, 16, v22
    v_and_b32 v157, 0xffff0000, v22
    v_lshlrev_b32 v158, 16, v23
    v_and_b32 v159, 0xffff0000, v23
    v_lshlrev_b32 v160, 16, v24
    v_and_b32 v161, 0xffff0000, v24
    v_lshlrev_b32 v162, 16, v25
    v_and_b32 v163, 0xffff0000, v25
    v_lshlrev_b32 v164, 16, v26
    v_and_b32 v165, 0xffff0000, v26
    v_lshlrev_b32 v166, 16, v27
    v_and_b32 v167, 0xffff0000, v27
    v_lshlrev_b32 v168, 16, v28
    v_and_b32 v169, 0xffff0000, v28
    v_lshlrev_b32 v170, 16, v29
    v_and_b32 v171, 0xffff0000, v29
    v_lshlrev_b32 v172, 16, v30
    v_and_b32 v173, 0xffff0000, v30
    v_lshlrev_b32 v174, 16, v31
    v_and_b32 v175, 0xffff0000, v31
    s_waitcnt lgkmcnt(0)
    s_mul_i32 s50, s3, 2048
    s_add_u32 s50, s50, 0
    v_lshl_add_u32 v4, v1, 4, s50
    v_lshlrev_b32 v5, 4, v1
    v_add_u32 v5, 81920, v5
    v_mov_b32 v80, 0
    v_mov_b32 v81, 0
    v_mov_b32 v82, 0
    v_mov_b32 v83, 0
    v_mov_b32 v84, 0
    v_mov_b32 v85, 0
    v_mov_b32 v86, 0
    v_mov_b32 v87, 0
    v_mov_b32 v88, 0
    v_mov_b32 v89, 0
    v_mov_b32 v90, 0
    v_mov_b32 v91, 0
    v_mov_b32 v92, 0
    v_mov_b32 v93, 0
    v_mov_b32 v94, 0
    v_mov_b32 v95, 0
    v_mov_b32 v96, 0
    v_mov_b32 v97, 0
    v_mov_b32 v98, 0
    v_mov_b32 v99, 0
    v_mov_b32 v100, 0
    v_mov_b32 v101, 0
    v_mov_b32 v102, 0
    v_mov_b32 v103, 0
    v_mov_b32 v104, 0
    v_mov_b32 v105, 0
    v_mov_b32 v106, 0
    v_mov_b32 v107, 0
    v_mov_b32 v108, 0
    v_mov_b32 v109, 0
    v_mov_b32 v110, 0
    v_mov_b32 v111, 0
    s_mov_b32 s52, 0
    s_mov_b32 s53, 0
    s_mov_b32 s54, 0
    v_add_u32 v6, s52, v4
    v_add_u32 v10, s53, v5
    s_barrier
    ds_read_b128 v[32:35], v6 offset:0
    ds_read_b128 v[36:39], v6 offset:1024
    ds_read_b128 v[48:51], v10 offset:0
    ds_read_b128 v[52:55], v10 offset:1024
    ds_read_b128 v[56:59], v10 offset:2048
    ds_read_b128 v[60:63], v10 offset:3072
L_mm_kernel_cloop_59:
    s_waitcnt lgkmcnt(3)
    v_mfma_f32_16x16x32_bf16 v[80:83], v[48:51], v[32:35], v[80:83]
    ds_read_b128 v[40:43], v6 offset:8192
    ds_read_b128 v[44:47], v6 offset:9216
    v_mfma_f32_16x16x32_bf16 v[84:87], v[48:51], v[36:39], v[84:87]
    ds_read_b128 v[64:67], v10 offset:4096
    s_add_u32 s52, s52, 16384
    s_cmp_ge_u32 s52, 81920
    s_waitcnt lgkmcnt(5)
    v_mfma_f32_16x16x32_bf16 v[88:91], v[52:55], v[32:35], v[88:91]
    ds_read_b128 v[68:71], v10 offset:5120
    v_mfma_f32_16x16x32_bf16 v[92:95], v[52:55], v[36:39], v[92:95]
    s_cselect_b32 s52, 0, s52
    s_add_u32 s53, s53, 8192
    s_waitcnt lgkmcnt(5)
    v_mfma_f32_16x16x32_bf16 v[96:99], v[56:59], v[32:35], v[96:99]
    ds_read_b128 v[72:75], v10 offset:6144
    v_mfma_f32_16x16x32_bf16 v[100:103], v[56:59], v[36:39], v[100:103]
    s_cmp_ge_u32 s53, 40960
    s_cselect_b32 s53, 0, s53
    s_waitcnt lgkmcnt(5)
    v_mfma_f32_16x16x32_bf16 v[104:107], v[60:63], v[32:35], v[104:107]
    ds_read_b128 v[76:79], v10 offset:7168
    v_mfma_f32_16x16x32_bf16 v[108:111], v[60:63], v[36:39], v[108:111]
    s_add_u32 s54, s54, 1
    s_cmp_lt_u32 s54, 28
    s_waitcnt lgkmcnt(3)
    v_mfma_f32_16x16x32_bf16 v[80:83], v[64:67], v[40:43], v[80:83]
    v_mfma_f32_16x16x32_bf16 v[84:87], v[64:67], v[44:47], v[84:87]
    s_waitcnt lgkmcnt(2)
    v_mfma_f32_16x16x32_bf16 v[88:91], v[68:71], v[40:43], v[88:91]
    v_add_u32 v6, s52, v4
    v_add_u32 v10, s53, v5
    s_waitcnt lgkmcnt(0)
    s_barrier
    v_mfma_f32_16x16x32_bf16 v[92:95], v[68:71], v[44:47], v[92:95]
    ds_read_b128 v[32:35], v6 offset:0
    ds_read_b128 v[36:39], v6 offset:1024
    ds_read_b128 v[48:51], v10 offset:0
    ds_read_b128 v[52:55], v10 offset:1024
    v_mfma_f32_16x16x32_bf16 v[96:99], v[72:75], v[40:43], v[96:99]
    ds_read_b128 v[56:59], v10 offset:2048
    v_mfma_f32_16x16x32_bf16 v[100:103], v[72:75], v[44:47], v[100:103]
    v_mfma_f32_16x16x32_bf16 v[104:107], v[76:79], v[40:43], v[104:107]
    ds_read_b128 v[60:63], v10 offset:3072
    v_mfma_f32_16x16x32_bf16 v[108:111], v[76:79], v[44:47], v[108:111]
    s_cbranch_scc1 L_mm_kernel_cloop_59
    s_waitcnt lgkmcnt(0)
    v_pk_fma_f32 v[80:81], v[80:81], v[112:113], v[144:145]
    v_pk_fma_f32 v[82:83], v[82:83], v[114:115], v[146:147]
    v_pk_fma_f32 v[84:85], v[84:85], v[112:113], v[148:149]
    v_pk_fma_f32 v[86:87], v[86:87], v[114:115], v[150:151]
    v_pk_fma_f32 v[88:89], v[88:89], v[116:117], v[152:153]
    v_pk_fma_f32 v[90:91], v[90:91], v[118:119], v[154:155]
    v_pk_fma_f32 v[92:93], v[92:93], v[116:117], v[156:157]
    v_pk_fma_f32 v[94:95], v[94:95], v[118:119], v[158:159]
    v_pk_fma_f32 v[96:97], v[96:97], v[120:121], v[160:161]
    v_pk_fma_f32 v[98:99], v[98:99], v[122:123], v[162:163]
    v_pk_fma_f32 v[100:101], v[100:101], v[120:121], v[164:165]
    v_pk_fma_f32 v[102:103], v[102:103], v[122:123], v[166:167]
    v_pk_fma_f32 v[104:105], v[104:105], v[124:125], v[168:169]
    v_pk_fma_f32 v[106:107], v[106:107], v[126:127], v[170:171]
    v_pk_fma_f32 v[108:109], v[108:109], v[124:125], v[172:173]
    v_pk_fma_f32 v[110:111], v[110:111], v[126:127], v[174:175]
    v_cvt_pk_bf16_f32 v32, v80, v81
    v_cvt_pk_bf16_f32 v33, v82, v83
    v_cvt_pk_bf16_f32 v34, v84, v85
    v_cvt_pk_bf16_f32 v35, v86, v87
    s_nop 0
    v_permlane16_swap_b32 v32, v34
    s_nop 0
    v_permlane16_swap_b32 v33, v35
    buffer_store_dwordx4 v[32:35], v12, s[40:43], s58 offen offset:0
    v_cvt_pk_bf16_f32 v36, v88, v89
    v_cvt_pk_bf16_f32 v37, v90, v91
    v_cvt_pk_bf16_f32 v38, v92, v93
    v_cvt_pk_bf16_f32 v39, v94, v95
    s_nop 0
    v_permlane16_swap_b32 v36, v38
    s_nop 0
    v_permlane16_swap_b32 v37, v39
    buffer_store_dwordx4 v[36:39], v12, s[40:43], s58 offen offset:32
    v_cvt_pk_bf16_f32 v40, v96, v97
    v_cvt_pk_bf16_f32 v41, v98, v99
    v_cvt_pk_bf16_f32 v42, v100, v101
    v_cvt_pk_bf16_f32 v43, v102, v103
    s_nop 0
    v_permlane16_swap_b32 v40, v42
    s_nop 0
    v_permlane16_swap_b32 v41, v43
    buffer_store_dwordx4 v[40:43], v12, s[40:43], s58 offen offset:64
    v_cvt_pk_bf16_f32 v44, v104, v105
    v_cvt_pk_bf16_f32 v45, v106, v107
    v_cvt_pk_bf16_f32 v46, v108, v109
    v_cvt_pk_bf16_f32 v47, v110, v111
    s_nop 0
    v_permlane16_swap_b32 v44, v46
    s_nop 0
    v_permlane16_swap_b32 v45, v47
    buffer_store_dwordx4 v[44:47], v12, s[40:43], s58 offen offset:96
    s_endpgm
L_mm_kernel_p2_8:
    s_load_dwordx2 s[4:5], s[0:1], 0
    s_load_dwordx4 s[8:11], s[0:1], 40
    s_load_dwordx2 s[12:13], s[0:1], 56
    s_load_dwordx2 s[16:17], s[0:1], 80
    s_and_b32 s48, s2, 7
    s_lshr_b32 s49, s2, 3
    s_and_b32 s50, s49, 3
    s_lshr_b32 s51, s49, 2
    s_and_b32 s52, s48, 3
    s_lshl_b32 s52, s52, 2
    s_add_u32 s20, s52, s50
    s_lshr_b32 s52, s48, 2
    s_mul_i32 s52, s52, 8
    s_add_u32 s21, s52, s51
    s_lshr_b32 s22, s20, 1
    s_lshl_b32 s23, s20, 1
    s_add_u32 s14, s21, 1
    s_add_u32 s15, s20, 1
    s_waitcnt lgkmcnt(0)
    s_lshl_b32 s50, s3, 11
    v_lshl_add_u32 v8, v1, 4, s50
    s_mul_i32 s80, s21, 131072
    s_mul_i32 s81, s20, 262144
    s_mov_b32 s82, 0
    s_lshl_b32 s50, s3, 12
    v_lshl_add_u32 v5, v1, 4, s50
    s_lshl_b32 s56, s21, 8
    s_add_u32 s56, s56, s50
    s_add_u32 s56, s56, 8192
    s_add_u32 s60, s56, 24576
    s_add_u32 s61, s56, 49152
    s_add_u32 s62, s56, 73728
    v_lshlrev_b32 v12, 2, v1
    s_cmp_eq_u32 s3, 2
    s_cselect_b32 s58, 1.0, 0
    s_lshl_b32 s59, s3, 8
    s_add_u32 s59, s59, 162688
    v_add_u32 v13, s59, v12
    s_mov_b32 s68, s82
    s_mul_i32 s72, s3, 4096
    s_add_u32 s72, s72, 0
    s_add_u32 s74, s72, 65536
    s_mov_b32 s69, s82
    s_mul_i32 s73, s3, 2048
    s_add_u32 s73, s73, 65536
    s_add_u32 s75, s73, 32768
    s_add_u32 s26, s81, 17825792
    s_add_u32 s24, s6, s26
    s_addc_u32 s25, s7, 0
    s_mov_b32 s26, 262144
    s_mov_b32 s27, 0x20000
    s_add_u32 s30, s80, 58720256
    s_add_u32 s28, s6, s30
    s_addc_u32 s29, s7, 0
    s_mov_b32 s30, 131072
    s_mov_b32 s31, 0x20000
    s_add_u32 s32, s6, 0
    s_addc_u32 s33, s7, 0
    s_mov_b32 s34, 98304
    s_mov_b32 s35, 0x20000
    s_mov_b32 s63, 13
    s_mov_b32 s4, 0
L_mm_kernel_w_63:
    ds_read_b128 v[100:103], v7 offset:16
    s_add_u32 s4, s4, 1
    s_waitcnt lgkmcnt(0)
    v_min_u32 v100, v100, v101
    v_min3_u32 v100, v100, v102, v103
    s_nop 0
    v_readfirstlane_b32 s5, v100
    s_nop 0
    s_cmp_gt_u32 s5, s63
    s_cbranch_scc1 L_mm_kernel_g_64
    s_sleep 6
    s_cmp_lt_u32 s4, 0x1000000
    s_cbranch_scc1 L_mm_kernel_w_63
L_mm_kernel_g_64:
    s_cmp_lg_u32 s3, 0
    s_cbranch_scc1 L_mm_kernel_hf_62
    s_add_u32 s36, s6, 57409536
    s_addc_u32 s37, s7, 0
    s_mov_b32 s38, 1024
    s_mov_b32 s39, 0x20000
    v_lshlrev_b32 v24, 4, v1
    s_mov_b32 s64, 0
L_mm_kernel_hw_60:
    buffer_load_dwordx4 v[28:31], v24, s[36:39], 0 offen sc1
    s_add_u32 s64, s64, 1
    s_waitcnt vmcnt(0)
    v_min_f32 v28, v28, v29
    v_min3_f32 v28, v28, v30, v31
    v_cmp_gt_f32 vcc, 0, v28
    s_cbranch_vccz L_mm_kernel_hg_61
    s_sleep 8
    s_cmp_lt_u32 s64, 0x100000
    s_cbranch_scc1 L_mm_kernel_hw_60
L_mm_kernel_hg_61:
    v_mov_b32 v28, 100
    ds_write_b32 v7, v28 offset:32
L_mm_kernel_hf_62:
    s_mov_b32 s63, 0
    s_mov_b32 s4, 0
L_mm_kernel_w_65:
    ds_read_b32 v100, v7 offset:32
    s_add_u32 s4, s4, 1
    s_waitcnt lgkmcnt(0)
    v_readfirstlane_b32 s5, v100
    s_nop 0
    s_cmp_gt_u32 s5, s63
    s_cbranch_scc1 L_mm_kernel_g_66
    s_sleep 2
    s_cmp_lt_u32 s4, 0x1000000
    s_cbranch_scc1 L_mm_kernel_w_65
L_mm_kernel_g_66:
    buffer_load_dword v14, v12, s[32:35], s56 offen sc1
    buffer_load_dword v21, v12, s[32:35], s60 offen sc1
    buffer_load_dword v22, v12, s[32:35], s61 offen sc1
    buffer_load_dword v23, v12, s[32:35], s62 offen sc1
    s_mov_b32 s65, s58
    s_mov_b32 m0, s73
    s_nop 0
    buffer_load_dwordx4 v8, s[28:31], s69 offen offset:0 sc1 lds
    buffer_load_dwordx4 v8, s[28:31], s69 offen offset:1024 sc1 lds
    s_add_u32 s69, s69, 8192
    s_add_u32 s73, s73, 8192
    s_cmp_ge_u32 s73, s75
    s_cselect_b32 s66, 32768, 0
    s_sub_u32 s73, s73, s66
    s_mov_b32 m0, s73
    s_nop 0
    buffer_load_dwordx4 v8, s[28:31], s69 offen offset:0 sc1 lds
    buffer_load_dwordx4 v8, s[28:31], s69 offen offset:1024 sc1 lds
    s_add_u32 s69, s69, 8192
    s_add_u32 s73, s73, 8192
    s_cmp_ge_u32 s73, s75
    s_cselect_b32 s66, 32768, 0
    s_sub_u32 s73, s73, s66
    s_mov_b32 m0, s73
    s_nop 0
    buffer_load_dwordx4 v8, s[28:31], s69 offen offset:0 sc1 lds
    buffer_load_dwordx4 v8, s[28:31], s69 offen offset:1024 sc1 lds
    s_add_u32 s69, s69, 8192
    s_add_u32 s73, s73, 8192
    s_cmp_ge_u32 s73, s75
    s_cselect_b32 s66, 32768, 0
    s_sub_u32 s73, s73, s66
    s_add_u32 s32, s6, 57147392
    s_addc_u32 s33, s7, 0
    s_mov_b32 s34, 327680
    s_mov_b32 s35, 0x20000
    s_lshl_b32 s56, s22, 12
    s_add_u32 s56, s56, 98304
    v_min_u32 v16, 31, v1
    v_lshlrev_b32 v16, 7, v16
    s_mov_b32 s58, 0
    s_mov_b32 s60, 1024
    v_mov_b32 v18, 163712
    v_mov_b32 v17, 0
    ds_write_b32 v18, v17
    s_waitcnt lgkmcnt(0)
    s_barrier
    s_lshr_b32 s59, s60, 10
    s_add_u32 s60, s60, 2048
    s_cmp_gt_u32 s58, s59
    s_cbranch_scc1 L_mm_kernel_go_68
    s_mov_b32 s64, 0
    s_cmp_lg_u32 s3, 0
    s_cbranch_scc1 L_mm_kernel_follow_69
L_mm_kernel_wait_67:
    s_sleep 6
    buffer_load_dword v17, v16, s[32:35], s56 offen sc1
    s_waitcnt vmcnt(0)
    v_cmp_gt_f32 vcc, 0, v17
    s_add_u32 s64, s64, 1
    s_nop 3
    s_ff1_i32_b64 s58, vcc
    v_mov_b32 v17, s58
    ds_write_b32 v18, v17
    s_cmp_gt_u32 s58, s59
    s_cbranch_scc1 L_mm_kernel_go_68
    s_cmp_lt_u32 s64, 0x100000
    s_cbranch_scc1 L_mm_kernel_wait_67
    s_branch L_mm_kernel_go_68
L_mm_kernel_follow_69:
    ds_read_b32 v17, v18
    s_add_u32 s64, s64, 1
    s_waitcnt lgkmcnt(0)
    v_readfirstlane_b32 s58, v17
    s_nop 3
    s_cmp_gt_u32 s58, s59
    s_cbranch_scc1 L_mm_kernel_go_68
    s_sleep 1
    s_cmp_lt_u32 s64, 0x1000000
    s_cbranch_scc1 L_mm_kernel_follow_69
L_mm_kernel_go_68:
    s_mov_b32 m0, s72
    s_nop 0
    buffer_load_dwordx4 v5, s[24:27], s68 offen offset:0 sc1 lds
    buffer_load_dwordx4 v5, s[24:27], s68 offen offset:1024 sc1 lds
    buffer_load_dwordx4 v5, s[24:27], s68 offen offset:2048 sc1 lds
    buffer_load_dwordx4 v5, s[24:27], s68 offen offset:3072 sc1 lds
    s_add_u32 s68, s68, 16384
    s_add_u32 s72, s72, 16384
    s_cmp_ge_u32 s72, s74
    s_cselect_b32 s66, 65536, 0
    s_sub_u32 s72, s72, s66
    s_lshr_b32 s59, s60, 10
    s_add_u32 s60, s60, 2048
    s_cmp_gt_u32 s58, s59
    s_cbranch_scc1 L_mm_kernel_go_71
    s_mov_b32 s64, 0
    s_cmp_lg_u32 s3, 0
    s_cbranch_scc1 L_mm_kernel_follow_72
L_mm_kernel_wait_70:
    s_sleep 6
    buffer_load_dword v17, v16, s[32:35], s56 offen sc1
    s_waitcnt vmcnt(0)
    v_cmp_gt_f32 vcc, 0, v17
    s_add_u32 s64, s64, 1
    s_nop 3
    s_ff1_i32_b64 s58, vcc
    v_mov_b32 v17, s58
    ds_write_b32 v18, v17
    s_cmp_gt_u32 s58, s59
    s_cbranch_scc1 L_mm_kernel_go_71
    s_cmp_lt_u32 s64, 0x100000
    s_cbranch_scc1 L_mm_kernel_wait_70
    s_branch L_mm_kernel_go_71
L_mm_kernel_follow_72:
    ds_read_b32 v17, v18
    s_add_u32 s64, s64, 1
    s_waitcnt lgkmcnt(0)
    v_readfirstlane_b32 s58, v17
    s_nop 3
    s_cmp_gt_u32 s58, s59
    s_cbranch_scc1 L_mm_kernel_go_71
    s_sleep 1
    s_cmp_lt_u32 s64, 0x1000000
    s_cbranch_scc1 L_mm_kernel_follow_72
L_mm_kernel_go_71:
    s_mov_b32 m0, s72
    s_nop 0
    buffer_load_dwordx4 v5, s[24:27], s68 offen offset:0 sc1 lds
    buffer_load_dwordx4 v5, s[24:27], s68 offen offset:1024 sc1 lds
    buffer_load_dwordx4 v5, s[24:27], s68 offen offset:2048 sc1 lds
    buffer_load_dwordx4 v5, s[24:27], s68 offen offset:3072 sc1 lds
    s_add_u32 s68, s68, 16384
    s_add_u32 s72, s72, 16384
    s_cmp_ge_u32 s72, s74
    s_cselect_b32 s66, 65536, 0
    s_sub_u32 s72, s72, s66
    s_lshr_b32 s59, s60, 10
    s_add_u32 s60, s60, 2048
    s_cmp_gt_u32 s58, s59
    s_cbranch_scc1 L_mm_kernel_go_74
    s_mov_b32 s64, 0
    s_cmp_lg_u32 s3, 0
    s_cbranch_scc1 L_mm_kernel_follow_75
L_mm_kernel_wait_73:
    s_sleep 6
    buffer_load_dword v17, v16, s[32:35], s56 offen sc1
    s_waitcnt vmcnt(0)
    v_cmp_gt_f32 vcc, 0, v17
    s_add_u32 s64, s64, 1
    s_nop 3
    s_ff1_i32_b64 s58, vcc
    v_mov_b32 v17, s58
    ds_write_b32 v18, v17
    s_cmp_gt_u32 s58, s59
    s_cbranch_scc1 L_mm_kernel_go_74
    s_cmp_lt_u32 s64, 0x100000
    s_cbranch_scc1 L_mm_kernel_wait_73
    s_branch L_mm_kernel_go_74
L_mm_kernel_follow_75:
    ds_read_b32 v17, v18
    s_add_u32 s64, s64, 1
    s_waitcnt lgkmcnt(0)
    v_readfirstlane_b32 s58, v17
    s_nop 3
    s_cmp_gt_u32 s58, s59
    s_cbranch_scc1 L_mm_kernel_go_74
    s_sleep 1
    s_cmp_lt_u32 s64, 0x1000000
    s_cbranch_scc1 L_mm_kernel_follow_75
L_mm_kernel_go_74:
    s_mov_b32 m0, s72
    s_nop 0
    buffer_load_dwordx4 v5, s[24:27], s68 offen offset:0 sc1 lds
    buffer_load_dwordx4 v5, s[24:27], s68 offen offset:1024 sc1 lds
    buffer_load_dwordx4 v5, s[24:27], s68 offen offset:2048 sc1 lds
    buffer_load_dwordx4 v5, s[24:27], s68 offen offset:3072 sc1 lds
    s_add_u32 s68, s68, 16384
    s_add_u32 s72, s72, 16384
    s_cmp_ge_u32 s72, s74
    s_cselect_b32 s66, 65536, 0
    s_sub_u32 s72, s72, s66
    s_waitcnt vmcnt(8)
    v_add_f32 v14, v14, v21
    v_add_f32 v22, v22, v23
    v_add_f32 v14, v14, v22
    v_cvt_pk_bf16_f32 v14, v14, v14
    v_lshlrev_b32 v14, 16, v14
    v_add_f32 v14, s65, v14
    v_cvt_pk_bf16_f32 v14, v14, v14
    v_lshlrev_b32 v14, 16, v14
    ds_write_b32 v13, v14
    s_waitcnt lgkmcnt(0)
    s_barrier
    s_lshr_b32 s59, s60, 10
    s_add_u32 s60, s60, 2048
    s_cmp_gt_u32 s58, s59
    s_cbranch_scc1 L_mm_kernel_go_77
    s_mov_b32 s64, 0
    s_cmp_lg_u32 s3, 0
    s_cbranch_scc1 L_mm_kernel_follow_78
L_mm_kernel_wait_76:
    s_sleep 6
    buffer_load_dword v17, v16, s[32:35], s56 offen sc1
    s_waitcnt vmcnt(0)
    v_cmp_gt_f32 vcc, 0, v17
    s_add_u32 s64, s64, 1
    s_nop 3
    s_ff1_i32_b64 s58, vcc
    v_mov_b32 v17, s58
    ds_write_b32 v18, v17
    s_cmp_gt_u32 s58, s59
    s_cbranch_scc1 L_mm_kernel_go_77
    s_cmp_lt_u32 s64, 0x100000
    s_cbranch_scc1 L_mm_kernel_wait_76
    s_branch L_mm_kernel_go_77
L_mm_kernel_follow_78:
    ds_read_b32 v17, v18
    s_add_u32 s64, s64, 1
    s_waitcnt lgkmcnt(0)
    v_readfirstlane_b32 s58, v17
    s_nop 3
    s_cmp_gt_u32 s58, s59
    s_cbranch_scc1 L_mm_kernel_go_77
    s_sleep 1
    s_cmp_lt_u32 s64, 0x1000000
    s_cbranch_scc1 L_mm_kernel_follow_78
L_mm_kernel_go_77:
    s_mov_b32 m0, s72
    s_nop 0
    buffer_load_dwordx4 v5, s[24:27], s68 offen offset:0 sc1 lds
    buffer_load_dwordx4 v5, s[24:27], s68 offen offset:1024 sc1 lds
    buffer_load_dwordx4 v5, s[24:27], s68 offen offset:2048 sc1 lds
    buffer_load_dwordx4 v5, s[24:27], s68 offen offset:3072 sc1 lds
    s_add_u32 s68, s68, 16384
    s_add_u32 s72, s72, 16384
    s_cmp_ge_u32 s72, s74
    s_cselect_b32 s66, 65536, 0
    s_sub_u32 s72, s72, s66
    s_mov_b32 m0, s73
    s_nop 0
    buffer_load_dwordx4 v8, s[28:31], s69 offen offset:0 sc1 lds
    buffer_load_dwordx4 v8, s[28:31], s69 offen offset:1024 sc1 lds
    s_add_u32 s69, s69, 8192
    s_add_u32 s73, s73, 8192
    s_cmp_ge_u32 s73, s75
    s_cselect_b32 s66, 32768, 0
    s_sub_u32 s73, s73, s66
    s_waitcnt vmcnt(10)
    s_barrier
    s_mov_b32 s77, 1
L_mm_kernel_ploop_79:
    s_lshr_b32 s59, s60, 10
    s_add_u32 s60, s60, 2048
    s_cmp_gt_u32 s58, s59
    s_cbranch_scc1 L_mm_kernel_go_81
    s_mov_b32 s64, 0
    s_cmp_lg_u32 s3, 0
    s_cbranch_scc1 L_mm_kernel_follow_82
L_mm_kernel_wait_80:
    s_sleep 6
    buffer_load_dword v17, v16, s[32:35], s56 offen sc1
    s_waitcnt vmcnt(0)
    v_cmp_gt_f32 vcc, 0, v17
    s_add_u32 s64, s64, 1
    s_nop 3
    s_ff1_i32_b64 s58, vcc
    v_mov_b32 v17, s58
    ds_write_b32 v18, v17
    s_cmp_gt_u32 s58, s59
    s_cbranch_scc1 L_mm_kernel_go_81
    s_cmp_lt_u32 s64, 0x100000
    s_cbranch_scc1 L_mm_kernel_wait_80
    s_branch L_mm_kernel_go_81
L_mm_kernel_follow_82:
    ds_read_b32 v17, v18
    s_add_u32 s64, s64, 1
    s_waitcnt lgkmcnt(0)
    v_readfirstlane_b32 s58, v17
    s_nop 3
    s_cmp_gt_u32 s58, s59
    s_cbranch_scc1 L_mm_kernel_go_81
    s_sleep 1
    s_cmp_lt_u32 s64, 0x1000000
    s_cbranch_scc1 L_mm_kernel_follow_82
L_mm_kernel_go_81:
    s_mov_b32 m0, s72
    s_nop 0
    buffer_load_dwordx4 v5, s[24:27], s68 offen offset:0 sc1 lds
    buffer_load_dwordx4 v5, s[24:27], s68 offen offset:1024 sc1 lds
    buffer_load_dwordx4 v5, s[24:27], s68 offen offset:2048 sc1 lds
    buffer_load_dwordx4 v5, s[24:27], s68 offen offset:3072 sc1 lds
    s_add_u32 s68, s68, 16384
    s_add_u32 s72, s72, 16384
    s_cmp_ge_u32 s72, s74
    s_cselect_b32 s66, 65536, 0
    s_sub_u32 s72, s72, s66
    s_mov_b32 m0, s73
    s_nop 0
    buffer_load_dwordx4 v8, s[28:31], s69 offen offset:0 sc1 lds
    buffer_load_dwordx4 v8, s[28:31], s69 offen offset:1024 sc1 lds
    s_add_u32 s69, s69, 8192
    s_add_u32 s73, s73, 8192
    s_cmp_ge_u32 s73, s75
    s_cselect_b32 s66, 32768, 0
    s_sub_u32 s73, s73, s66
    s_add_u32 s77, s77, 1
    s_cmp_lt_u32 s77, 13
    s_waitcnt vmcnt(12)
    s_barrier
    s_cbranch_scc1 L_mm_kernel_ploop_79
    s_mul_i32 s50, s3, 7168
    v_lshl_add_u32 v8, v1, 4, s50
    v_add_u32 v9, 4096, v8
    s_mul_i32 s80, s21, 458752
    s_lshl_b32 s81, s20, 18
    s_mov_b32 s82, 0
    s_lshl_b32 s50, s3, 12
    v_lshl_add_u32 v5, v1, 4, s50
    s_mov_b32 s68, s82
    s_mul_i32 s72, s3, 4096
    s_add_u32 s72, s72, 0
    s_add_u32 s74, s72, 49152
    s_mov_b32 s69, s82
    s_mul_i32 s73, s3, 7168
    s_add_u32 s73, s73, 69632
    s_add_u32 s75, s73, 86016
    s_add_u32 s73, s73, 28672
    s_add_u32 s78, s82, 262144
    s_add_u32 s66, s21, 1
    s_and_b32 s66, s66, 15
    s_mul_i32 s66, s66, 16384
    s_add_u32 s68, s68, s66
    s_add_u32 s72, s72, 16384
    s_add_u32 s79, s82, 458752
    s_add_u32 s66, s21, 0
    s_and_b32 s66, s66, 15
    s_mul_i32 s66, s66, 28672
    s_add_u32 s69, s69, s66
    s_add_u32 s26, s81, 52428800
    s_add_u32 s24, s6, s26
    s_addc_u32 s25, s7, 0
    s_mov_b32 s26, 262144
    s_mov_b32 s27, 0x20000
    s_add_u32 s30, s80, 65011712
    s_add_u32 s28, s6, s30
    s_addc_u32 s29, s7, 0
    s_mov_b32 s30, 458752
    s_mov_b32 s31, 0x20000
    s_mov_b32 m0, s73
    s_nop 0
    buffer_load_dwordx4 v8, s[28:31], s69 offen offset:0 sc1 lds
    buffer_load_dwordx4 v8, s[28:31], s69 offen offset:1024 sc1 lds
    buffer_load_dwordx4 v8, s[28:31], s69 offen offset:2048 sc1 lds
    buffer_load_dwordx4 v8, s[28:31], s69 offen offset:3072 sc1 lds
    s_add_u32 m0, s73, 4096
    s_nop 0
    buffer_load_dwordx4 v9, s[28:31], s69 offen offset:0 sc1 lds
    buffer_load_dwordx4 v9, s[28:31], s69 offen offset:1024 sc1 lds
    buffer_load_dwordx4 v9, s[28:31], s69 offen offset:2048 sc1 lds
    s_add_u32 s69, s69, 28672
    s_cmp_ge_u32 s69, s79
    s_cselect_b32 s69, s82, s69
    s_add_u32 s73, s73, 28672
    s_cmp_ge_u32 s73, s75
    s_cselect_b32 s66, 86016, 0
    s_sub_u32 s73, s73, s66
    s_mov_b32 m0, s73
    s_nop 0
    buffer_load_dwordx4 v8, s[28:31], s69 offen offset:0 sc1 lds
    buffer_load_dwordx4 v8, s[28:31], s69 offen offset:1024 sc1 lds
    buffer_load_dwordx4 v8, s[28:31], s69 offen offset:2048 sc1 lds
    buffer_load_dwordx4 v8, s[28:31], s69 offen offset:3072 sc1 lds
    s_add_u32 m0, s73, 4096
    s_nop 0
    buffer_load_dwordx4 v9, s[28:31], s69 offen offset:0 sc1 lds
    buffer_load_dwordx4 v9, s[28:31], s69 offen offset:1024 sc1 lds
    buffer_load_dwordx4 v9, s[28:31], s69 offen offset:2048 sc1 lds
    s_add_u32 s69, s69, 28672
    s_cmp_ge_u32 s69, s79
    s_cselect_b32 s69, s82, s69
    s_add_u32 s73, s73, 28672
    s_cmp_ge_u32 s73, s75
    s_cselect_b32 s66, 86016, 0
    s_sub_u32 s73, s73, s66
    s_waitcnt vmcnt(20)
    s_barrier
    s_waitcnt vmcnt(14)
    s_barrier
    s_barrier
    s_waitcnt vmcnt(0)
    s_mul_i32 s55, s3, 3
    s_add_u32 s55, s55, 4
    s_add_u32 s55, s55, s83
    s_add_u32 s65, s83, 7
    s_add_u32 s61, s83, 2
    s_add_u32 s32, s6, 57147392
    s_addc_u32 s33, s7, 0
    s_mov_b32 s34, 327680
    s_mov_b32 s35, 0x20000
    s_lshl_b32 s56, s20, 11
    s_add_u32 s56, s56, 0
    v_min_u32 v16, 15, v1
    v_add_u32 v16, s14, v16
    v_and_b32 v16, 15, v16
    v_lshlrev_b32 v16, 7, v16
    s_mov_b32 s58, 0
    s_mov_b32 s60, 0
    v_mov_b32 v18, 163712
    v_mov_b32 v17, 0
    ds_write_b32 v18, v17
    s_waitcnt lgkmcnt(0)
    s_barrier
    s_mov_b32 m0, s73
    s_nop 0
    buffer_load_dwordx4 v8, s[28:31], s69 offen offset:0 sc1 lds
    buffer_load_dwordx4 v8, s[28:31], s69 offen offset:1024 sc1 lds
    buffer_load_dwordx4 v8, s[28:31], s69 offen offset:2048 sc1 lds
    buffer_load_dwordx4 v8, s[28:31], s69 offen offset:3072 sc1 lds
    s_add_u32 m0, s73, 4096
    s_nop 0
    buffer_load_dwordx4 v9, s[28:31], s69 offen offset:0 sc1 lds
    buffer_load_dwordx4 v9, s[28:31], s69 offen offset:1024 sc1 lds
    buffer_load_dwordx4 v9, s[28:31], s69 offen offset:2048 sc1 lds
    s_add_u32 s69, s69, 28672
    s_cmp_ge_u32 s69, s79
    s_cselect_b32 s69, s82, s69
    s_add_u32 s73, s73, 28672
    s_cmp_ge_u32 s73, s75
    s_cselect_b32 s66, 86016, 0
    s_sub_u32 s73, s73, s66
    s_lshr_b32 s59, s60, 10
    s_add_u32 s60, s60, 1024
    s_cmp_gt_u32 s58, s59
    s_cbranch_scc1 L_mm_kernel_go_84
    s_mov_b32 s64, 0
    s_cmp_lg_u32 s3, 0
    s_cbranch_scc1 L_mm_kernel_follow_85
L_mm_kernel_wait_83:
    s_sleep 6
    buffer_load_dword v17, v16, s[32:35], s56 offen sc1
    s_waitcnt vmcnt(0)
    v_cmp_gt_f32 vcc, 0, v17
    s_add_u32 s64, s64, 1
    s_nop 3
    s_ff1_i32_b64 s58, vcc
    v_mov_b32 v17, s58
    ds_write_b32 v18, v17
    s_cmp_gt_u32 s58, s59
    s_cbranch_scc1 L_mm_kernel_go_84
    s_cmp_lt_u32 s64, 0x100000
    s_cbranch_scc1 L_mm_kernel_wait_83
    s_branch L_mm_kernel_go_84
L_mm_kernel_follow_85:
    ds_read_b32 v17, v18
    s_add_u32 s64, s64, 1
    s_waitcnt lgkmcnt(0)
    v_readfirstlane_b32 s58, v17
    s_nop 3
    s_cmp_gt_u32 s58, s59
    s_cbranch_scc1 L_mm_kernel_go_84
    s_sleep 1
    s_cmp_lt_u32 s64, 0x1000000
    s_cbranch_scc1 L_mm_kernel_follow_85
L_mm_kernel_go_84:
    s_mov_b32 m0, s72
    s_nop 0
    buffer_load_dwordx4 v5, s[24:27], s68 offen offset:0 sc1 lds
    buffer_load_dwordx4 v5, s[24:27], s68 offen offset:1024 sc1 lds
    buffer_load_dwordx4 v5, s[24:27], s68 offen offset:2048 sc1 lds
    buffer_load_dwordx4 v5, s[24:27], s68 offen offset:3072 sc1 lds
    s_add_u32 s68, s68, 16384
    s_cmp_ge_u32 s68, s78
    s_cselect_b32 s68, s82, s68
    s_add_u32 s72, s72, 16384
    s_cmp_ge_u32 s72, s74
    s_cselect_b32 s66, 49152, 0
    s_sub_u32 s72, s72, s66
    s_lshr_b32 s59, s60, 10
    s_add_u32 s60, s60, 1024
    s_cmp_gt_u32 s58, s59
    s_cbranch_scc1 L_mm_kernel_go_87
    s_mov_b32 s64, 0
    s_cmp_lg_u32 s3, 0
    s_cbranch_scc1 L_mm_kernel_follow_88
L_mm_kernel_wait_86:
    s_sleep 6
    buffer_load_dword v17, v16, s[32:35], s56 offen sc1
    s_waitcnt vmcnt(0)
    v_cmp_gt_f32 vcc, 0, v17
    s_add_u32 s64, s64, 1
    s_nop 3
    s_ff1_i32_b64 s58, vcc
    v_mov_b32 v17, s58
    ds_write_b32 v18, v17
    s_cmp_gt_u32 s58, s59
    s_cbranch_scc1 L_mm_kernel_go_87
    s_cmp_lt_u32 s64, 0x100000
    s_cbranch_scc1 L_mm_kernel_wait_86
    s_branch L_mm_kernel_go_87
L_mm_kernel_follow_88:
    ds_read_b32 v17, v18
    s_add_u32 s64, s64, 1
    s_waitcnt lgkmcnt(0)
    v_readfirstlane_b32 s58, v17
    s_nop 3
    s_cmp_gt_u32 s58, s59
    s_cbranch_scc1 L_mm_kernel_go_87
    s_sleep 1
    s_cmp_lt_u32 s64, 0x1000000
    s_cbranch_scc1 L_mm_kernel_follow_88
L_mm_kernel_go_87:
    s_mov_b32 m0, s72
    s_nop 0
    buffer_load_dwordx4 v5, s[24:27], s68 offen offset:0 sc1 lds
    buffer_load_dwordx4 v5, s[24:27], s68 offen offset:1024 sc1 lds
    buffer_load_dwordx4 v5, s[24:27], s68 offen offset:2048 sc1 lds
    buffer_load_dwordx4 v5, s[24:27], s68 offen offset:3072 sc1 lds
    s_add_u32 s68, s68, 16384
    s_cmp_ge_u32 s68, s78
    s_cselect_b32 s68, s82, s68
    s_add_u32 s72, s72, 16384
    s_cmp_ge_u32 s72, s74
    s_cselect_b32 s66, 49152, 0
    s_sub_u32 s72, s72, s66
    s_waitcnt vmcnt(4)
    s_barrier
    s_lshr_b32 s59, s60, 10
    s_add_u32 s60, s60, 1024
    s_cmp_gt_u32 s58, s59
    s_cbranch_scc1 L_mm_kernel_go_90
    s_mov_b32 s64, 0
    s_cmp_lg_u32 s3, 0
    s_cbranch_scc1 L_mm_kernel_follow_91
L_mm_kernel_wait_89:
    s_sleep 6
    buffer_load_dword v17, v16, s[32:35], s56 offen sc1
    s_waitcnt vmcnt(0)
    v_cmp_gt_f32 vcc, 0, v17
    s_add_u32 s64, s64, 1
    s_nop 3
    s_ff1_i32_b64 s58, vcc
    v_mov_b32 v17, s58
    ds_write_b32 v18, v17
    s_cmp_gt_u32 s58, s59
    s_cbranch_scc1 L_mm_kernel_go_90
    s_cmp_lt_u32 s64, 0x100000
    s_cbranch_scc1 L_mm_kernel_wait_89
    s_branch L_mm_kernel_go_90
L_mm_kernel_follow_91:
    ds_read_b32 v17, v18
    s_add_u32 s64, s64, 1
    s_waitcnt lgkmcnt(0)
    v_readfirstlane_b32 s58, v17
    s_nop 3
    s_cmp_gt_u32 s58, s59
    s_cbranch_scc1 L_mm_kernel_go_90
    s_sleep 1
    s_cmp_lt_u32 s64, 0x1000000
    s_cbranch_scc1 L_mm_kernel_follow_91
L_mm_kernel_go_90:
    s_mov_b32 m0, s72
    s_nop 0
    buffer_load_dwordx4 v5, s[24:27], s68 offen offset:0 sc1 lds
    buffer_load_dwordx4 v5, s[24:27], s68 offen offset:1024 sc1 lds
    buffer_load_dwordx4 v5, s[24:27], s68 offen offset:2048 sc1 lds
    buffer_load_dwordx4 v5, s[24:27], s68 offen offset:3072 sc1 lds
    s_add_u32 s68, s68, 16384
    s_cmp_ge_u32 s68, s78
    s_cselect_b32 s68, s82, s68
    s_add_u32 s72, s72, 16384
    s_cmp_ge_u32 s72, s74
    s_cselect_b32 s66, 49152, 0
    s_sub_u32 s72, s72, s66
    s_mov_b32 m0, s73
    s_nop 0
    buffer_load_dwordx4 v8, s[28:31], s69 offen offset:0 sc1 lds
    buffer_load_dwordx4 v8, s[28:31], s69 offen offset:1024 sc1 lds
    buffer_load_dwordx4 v8, s[28:31], s69 offen offset:2048 sc1 lds
    buffer_load_dwordx4 v8, s[28:31], s69 offen offset:3072 sc1 lds
    s_add_u32 m0, s73, 4096
    s_nop 0
    buffer_load_dwordx4 v9, s[28:31], s69 offen offset:0 sc1 lds
    buffer_load_dwordx4 v9, s[28:31], s69 offen offset:1024 sc1 lds
    buffer_load_dwordx4 v9, s[28:31], s69 offen offset:2048 sc1 lds
    s_add_u32 s69, s69, 28672
    s_cmp_ge_u32 s69, s79
    s_cselect_b32 s69, s82, s69
    s_add_u32 s73, s73, 28672
    s_cmp_ge_u32 s73, s75
    s_cselect_b32 s66, 86016, 0
    s_sub_u32 s73, s73, s66
    s_waitcnt vmcnt(11)
    s_barrier
    s_mov_b32 s77, 2
L_mm_kernel_ploop_92:
    s_lshr_b32 s59, s60, 10
    s_add_u32 s60, s60, 1024
    s_cmp_gt_u32 s58, s59
    s_cbranch_scc1 L_mm_kernel_go_94
    s_mov_b32 s64, 0
    s_cmp_lg_u32 s3, 0
    s_cbranch_scc1 L_mm_kernel_follow_95
L_mm_kernel_wait_93:
    s_sleep 6
    buffer_load_dword v17, v16, s[32:35], s56 offen sc1
    s_waitcnt vmcnt(0)
    v_cmp_gt_f32 vcc, 0, v17
    s_add_u32 s64, s64, 1
    s_nop 3
    s_ff1_i32_b64 s58, vcc
    v_mov_b32 v17, s58
    ds_write_b32 v18, v17
    s_cmp_gt_u32 s58, s59
    s_cbranch_scc1 L_mm_kernel_go_94
    s_cmp_lt_u32 s64, 0x100000
    s_cbranch_scc1 L_mm_kernel_wait_93
    s_branch L_mm_kernel_go_94
L_mm_kernel_follow_95:
    ds_read_b32 v17, v18
    s_add_u32 s64, s64, 1
    s_waitcnt lgkmcnt(0)
    v_readfirstlane_b32 s58, v17
    s_nop 3
    s_cmp_gt_u32 s58, s59
    s_cbranch_scc1 L_mm_kernel_go_94
    s_sleep 1
    s_cmp_lt_u32 s64, 0x1000000
    s_cbranch_scc1 L_mm_kernel_follow_95
L_mm_kernel_go_94:
    s_mov_b32 m0, s72
    s_nop 0
    buffer_load_dwordx4 v5, s[24:27], s68 offen offset:0 sc1 lds
    buffer_load_dwordx4 v5, s[24:27], s68 offen offset:1024 sc1 lds
    buffer_load_dwordx4 v5, s[24:27], s68 offen offset:2048 sc1 lds
    buffer_load_dwordx4 v5, s[24:27], s68 offen offset:3072 sc1 lds
    s_add_u32 s68, s68, 16384
    s_cmp_ge_u32 s68, s78
    s_cselect_b32 s68, s82, s68
    s_add_u32 s72, s72, 16384
    s_cmp_ge_u32 s72, s74
    s_cselect_b32 s66, 49152, 0
    s_sub_u32 s72, s72, s66
    s_mov_b32 m0, s73
    s_nop 0
    buffer_load_dwordx4 v8, s[28:31], s69 offen offset:0 sc1 lds
    buffer_load_dwordx4 v8, s[28:31], s69 offen offset:1024 sc1 lds
    buffer_load_dwordx4 v8, s[28:31], s69 offen offset:2048 sc1 lds
    buffer_load_dwordx4 v8, s[28:31], s69 offen offset:3072 sc1 lds
    s_add_u32 m0, s73, 4096
    s_nop 0
    buffer_load_dwordx4 v9, s[28:31], s69 offen offset:0 sc1 lds
    buffer_load_dwordx4 v9, s[28:31], s69 offen offset:1024 sc1 lds
    buffer_load_dwordx4 v9, s[28:31], s69 offen offset:2048 sc1 lds
    s_add_u32 s69, s69, 28672
    s_cmp_ge_u32 s69, s79
    s_cselect_b32 s69, s82, s69
    s_add_u32 s73, s73, 28672
    s_cmp_ge_u32 s73, s75
    s_cselect_b32 s66, 86016, 0
    s_sub_u32 s73, s73, s66
    s_cmp_lg_u32 s77, s61
    s_cbranch_scc1 L_mm_kernel_nomid_96
    s_lshl_b32 s48, s2, 2
    s_add_u32 s48, s48, s3
    s_lshr_b32 s49, s48, 4
    s_and_b32 s50, s48, 15
    s_cmp_ge_u32 s48, 896
    s_cselect_b32 s51, 0x7f000000, 0
    s_lshl_b32 s52, s3, 12
    s_add_u32 s52, s52, 49152
    s_mov_b32 s36, s12
    s_mov_b32 s37, s13
    s_mov_b32 s38, 3670016
    s_mov_b32 s39, 0x20000
    v_lshrrev_b32 v20, 3, v1
    v_lshlrev_b32 v20, 11, v20
    v_and_b32 v21, 7, v1
    v_lshl_add_u32 v20, v21, 4, v20
    s_lshl_b32 s53, s49, 16
    s_lshl_b32 s54, s50, 7
    s_add_u32 s53, s53, s54
    s_or_b32 s53, s53, s51
    s_add_u32 m0, s52, 0
    s_add_u32 s54, s53, 0
    buffer_load_dwordx4 v20, s[36:39], s54 offen lds
    s_add_u32 m0, s52, 1024
    s_add_u32 s54, s53, 16384
    buffer_load_dwordx4 v20, s[36:39], s54 offen lds
    s_add_u32 m0, s52, 2048
    s_add_u32 s54, s53, 32768
    buffer_load_dwordx4 v20, s[36:39], s54 offen lds
    s_add_u32 m0, s52, 3072
    s_add_u32 s54, s53, 49152
    buffer_load_dwordx4 v20, s[36:39], s54 offen lds
L_mm_kernel_nomid_96:
    s_cmp_lg_u32 s77, s55
    s_cbranch_scc1 L_mm_kernel_nomid_97
    s_mov_b32 s40, s8
    s_mov_b32 s41, s9
    s_mov_b32 s42, 8388608
    s_mov_b32 s43, 0x20000
    v_lshlrev_b32 v22, 7, v1
    s_lshl_b32 s48, s2, 2
    s_add_u32 s48, s48, s3
    s_lshl_b32 s48, s48, 13
    buffer_load_dword v23, v22, s[40:43], s48 offen
L_mm_kernel_nomid_97:
    s_cmp_lg_u32 s77, s65
    s_cbranch_scc1 L_mm_kernel_nomid_98
    s_lshl_b32 s48, s2, 2
    s_add_u32 s48, s48, s3
    s_lshr_b32 s49, s48, 4
    s_and_b32 s50, s48, 15
    s_cmp_ge_u32 s48, 896
    s_cselect_b32 s51, 0x7f000000, 0
    s_lshl_b32 s52, s3, 12
    s_add_u32 s52, s52, 49152
    v_bfe_u32 v20, v1, 2, 2
    v_and_b32 v21, 3, v1
    v_lshlrev_b32 v21, 3, v21
    v_lshl_add_u32 v21, v20, 7, v21
    v_lshrrev_b32 v20, 4, v1
    v_lshl_add_u32 v21, v20, 10, v21
    v_add_u32 v21, s52, v21
    ds_read_b64_tr_b16 v[24:25], v21 offset:0
    ds_read_b64_tr_b16 v[26:27], v21 offset:512
    ds_read_b64_tr_b16 v[28:29], v21 offset:32
    ds_read_b64_tr_b16 v[30:31], v21 offset:544
    ds_read_b64_tr_b16 v[32:33], v21 offset:64
    ds_read_b64_tr_b16 v[34:35], v21 offset:576
    ds_read_b64_tr_b16 v[36:37], v21 offset:96
    ds_read_b64_tr_b16 v[38:39], v21 offset:608
    s_add_u32 s36, s6, 60817408
    s_addc_u32 s37, s7, 0
    s_mov_b32 s38, 3670016
    s_mov_b32 s39, 0x20000
    s_mul_i32 s53, s50, 229376
    s_lshl_b32 s54, s49, 12
    s_add_u32 s53, s53, s54
    s_or_b32 s53, s53, s51
    v_lshlrev_b32 v20, 4, v1
    s_waitcnt lgkmcnt(0)
    buffer_store_dwordx4 v[24:27], v20, s[36:39], s53 offen offset:0 sc1
    buffer_store_dwordx4 v[28:31], v20, s[36:39], s53 offen offset:1024 sc1
    buffer_store_dwordx4 v[32:35], v20, s[36:39], s53 offen offset:2048 sc1
    buffer_store_dwordx4 v[36:39], v20, s[36:39], s53 offen offset:3072 sc1
L_mm_kernel_nomid_98:
    s_add_u32 s77, s77, 1
    s_cmp_lt_u32 s77, 14
    s_waitcnt vmcnt(11)
    s_barrier
    s_cbranch_scc1 L_mm_kernel_ploop_92
    s_waitcnt vmcnt(0)
    s_barrier
    s_barrier
    s_lshl_b32 s51, s3, 12
    s_cmp_eq_u32 s3, 3
    s_cselect_b32 s51, 11264, s51
    v_lshl_add_u32 v8, v1, 4, s51
    s_lshl_b32 s80, s20, 19
    s_mul_i32 s81, s21, 458752
    s_mov_b32 s82, 0
    v_lshrrev_b32 v2, 3, v1
    s_lshl_b32 s50, s3, 5
    v_add_u32 v2, s50, v2
    v_bfe_u32 v3, v2, 1, 3
    v_and_b32 v4, 7, v1
    v_xor_b32 v3, v3, v4
    v_lshlrev_b32 v3, 4, v3
    v_lshl_add_u32 v10, v2, 12, v3
    v_xor_b32 v11, 64, v10
    v_add_u32 v11, 31744, v11
    v_add_u32 v12, 63488, v10
    v_add_u32 v13, 63488, v11
    s_mov_b32 s68, s80
    s_mul_i32 s72, s3, 4096
    s_add_u32 s72, s72, 0
    s_add_u32 s74, s72, 65536
    s_mov_b32 s69, s82
    s_mov_b32 s73, s51
    s_add_u32 s73, s73, 65536
    s_add_u32 s75, s73, 57344
    s_mul_i32 s66, s23, 128
    s_add_u32 s78, s80, s66
    s_mov_b32 s68, s78
    s_mul_i32 s66, s23, 14336
    s_add_u32 s79, s82, s66
    s_cmp_eq_u32 s69, s79
    s_cselect_b32 s66, 28672, 0
    s_add_u32 s69, s69, s66
    s_add_u32 s73, s73, 28672
    s_mov_b32 s24, s8
    s_mov_b32 s25, s9
    s_mov_b32 s26, 8388608
    s_mov_b32 s27, 0x20000
    s_add_u32 s30, s81, 33554432
    s_add_u32 s28, s6, s30
    s_addc_u32 s29, s7, 0
    s_mov_b32 s30, 458752
    s_mov_b32 s31, 0x20000
    s_mov_b32 m0, s72
    s_nop 0
    buffer_load_dwordx4 v10, s[24:27], s68 offen offset:0 lds
    buffer_load_dwordx4 v11, s[24:27], s68 offen offset:1024 lds
    buffer_load_dwordx4 v12, s[24:27], s68 offen offset:2048 lds
    buffer_load_dwordx4 v13, s[24:27], s68 offen offset:3072 lds
    s_add_u32 s68, s68, 128
    s_cmp_eq_u32 s68, s78
    s_cselect_b32 s66, 256, 0
    s_add_u32 s68, s68, s66
    s_add_u32 s72, s72, 16384
    s_cmp_ge_u32 s72, s74
    s_cselect_b32 s66, 65536, 0
    s_sub_u32 s72, s72, s66
    s_mov_b32 m0, s72
    s_nop 0
    buffer_load_dwordx4 v10, s[24:27], s68 offen offset:0 lds
    buffer_load_dwordx4 v11, s[24:27], s68 offen offset:1024 lds
    buffer_load_dwordx4 v12, s[24:27], s68 offen offset:2048 lds
    buffer_load_dwordx4 v13, s[24:27], s68 offen offset:3072 lds
    s_add_u32 s68, s68, 128
    s_cmp_eq_u32 s68, s78
    s_cselect_b32 s66, 256, 0
    s_add_u32 s68, s68, s66
    s_add_u32 s72, s72, 16384
    s_cmp_ge_u32 s72, s74
    s_cselect_b32 s66, 65536, 0
    s_sub_u32 s72, s72, s66
    s_mov_b32 s68, s80
    s_cmp_eq_u32 s68, s78
    s_cselect_b32 s66, 256, 0
    s_add_u32 s68, s68, s66
    s_mov_b32 m0, s72
    s_nop 0
    buffer_load_dwordx4 v10, s[24:27], s68 offen offset:0 lds
    buffer_load_dwordx4 v11, s[24:27], s68 offen offset:1024 lds
    buffer_load_dwordx4 v12, s[24:27], s68 offen offset:2048 lds
    buffer_load_dwordx4 v13, s[24:27], s68 offen offset:3072 lds
    s_add_u32 s68, s68, 128
    s_cmp_eq_u32 s68, s78
    s_cselect_b32 s66, 256, 0
    s_add_u32 s68, s68, s66
    s_add_u32 s72, s72, 16384
    s_cmp_ge_u32 s72, s74
    s_cselect_b32 s66, 65536, 0
    s_sub_u32 s72, s72, s66
    s_waitcnt vmcnt(0)
    s_add_u32 s32, s6, 57147392
    s_addc_u32 s33, s7, 0
    s_mov_b32 s34, 327680
    s_mov_b32 s35, 0x20000
    s_lshl_b32 s56, s21, 11
    s_add_u32 s56, s56, 32768
    v_min_u32 v16, 15, v1
    v_lshlrev_b32 v16, 7, v16
    s_mov_b32 s58, 0
    s_mov_b32 s60, 1024
    v_mov_b32 v18, 163712
    v_mov_b32 v17, 0
    ds_write_b32 v18, v17
    s_waitcnt lgkmcnt(0)
    s_barrier
    s_mov_b32 m0, s72
    s_nop 0
    buffer_load_dwordx4 v10, s[24:27], s68 offen offset:0 lds
    buffer_load_dwordx4 v11, s[24:27], s68 offen offset:1024 lds
    buffer_load_dwordx4 v12, s[24:27], s68 offen offset:2048 lds
    buffer_load_dwordx4 v13, s[24:27], s68 offen offset:3072 lds
    s_add_u32 s68, s68, 128
    s_cmp_eq_u32 s68, s78
    s_cselect_b32 s66, 256, 0
    s_add_u32 s68, s68, s66
    s_add_u32 s72, s72, 16384
    s_cmp_ge_u32 s72, s74
    s_cselect_b32 s66, 65536, 0
    s_sub_u32 s72, s72, s66
    s_barrier
    s_lshr_b32 s59, s60, 10
    s_add_u32 s60, s60, 512
    s_cmp_gt_u32 s58, s59
    s_cbranch_scc1 L_mm_kernel_go_100
    s_mov_b32 s64, 0
    s_cmp_lg_u32 s3, 0
    s_cbranch_scc1 L_mm_kernel_follow_101
L_mm_kernel_wait_99:
    s_sleep 6
    buffer_load_dword v17, v16, s[32:35], s56 offen sc1
    s_waitcnt vmcnt(0)
    v_cmp_gt_f32 vcc, 0, v17
    s_add_u32 s64, s64, 1
    s_nop 3
    s_ff1_i32_b64 s58, vcc
    v_mov_b32 v17, s58
    ds_write_b32 v18, v17
    s_cmp_gt_u32 s58, s59
    s_cbranch_scc1 L_mm_kernel_go_100
    s_cmp_lt_u32 s64, 0x100000
    s_cbranch_scc1 L_mm_kernel_wait_99
    s_branch L_mm_kernel_go_100
L_mm_kernel_follow_101:
    ds_read_b32 v17, v18
    s_add_u32 s64, s64, 1
    s_waitcnt lgkmcnt(0)
    v_readfirstlane_b32 s58, v17
    s_nop 3
    s_cmp_gt_u32 s58, s59
    s_cbranch_scc1 L_mm_kernel_go_100
    s_sleep 1
    s_cmp_lt_u32 s64, 0x1000000
    s_cbranch_scc1 L_mm_kernel_follow_101
L_mm_kernel_go_100:
    s_mov_b32 m0, s73
    s_nop 0
    buffer_load_dwordx4 v8, s[28:31], s69 offen offset:0 sc1 lds
    buffer_load_dwordx4 v8, s[28:31], s69 offen offset:1024 sc1 lds
    buffer_load_dwordx4 v8, s[28:31], s69 offen offset:2048 sc1 lds
    s_cmp_ge_u32 s3, 2
    s_cbranch_scc1 L_mm_kernel_skp_102
    buffer_load_dwordx4 v8, s[28:31], s69 offen offset:3072 sc1 lds
L_mm_kernel_skp_102:
    s_add_u32 s69, s69, 14336
    s_cmp_eq_u32 s69, s79
    s_cselect_b32 s66, 28672, 0
    s_add_u32 s69, s69, s66
    s_add_u32 s73, s73, 14336
    s_cmp_ge_u32 s73, s75
    s_cselect_b32 s66, 57344, 0
    s_sub_u32 s73, s73, s66
    s_lshr_b32 s59, s60, 10
    s_add_u32 s60, s60, 512
    s_cmp_gt_u32 s58, s59
    s_cbranch_scc1 L_mm_kernel_go_104
    s_mov_b32 s64, 0
    s_cmp_lg_u32 s3, 0
    s_cbranch_scc1 L_mm_kernel_follow_105
L_mm_kernel_wait_103:
    s_sleep 6
    buffer_load_dword v17, v16, s[32:35], s56 offen sc1
    s_waitcnt vmcnt(0)
    v_cmp_gt_f32 vcc, 0, v17
    s_add_u32 s64, s64, 1
    s_nop 3
    s_ff1_i32_b64 s58, vcc
    v_mov_b32 v17, s58
    ds_write_b32 v18, v17
    s_cmp_gt_u32 s58, s59
    s_cbranch_scc1 L_mm_kernel_go_104
    s_cmp_lt_u32 s64, 0x100000
    s_cbranch_scc1 L_mm_kernel_wait_103
    s_branch L_mm_kernel_go_104
L_mm_kernel_follow_105:
    ds_read_b32 v17, v18
    s_add_u32 s64, s64, 1
    s_waitcnt lgkmcnt(0)
    v_readfirstlane_b32 s58, v17
    s_nop 3
    s_cmp_gt_u32 s58, s59
    s_cbranch_scc1 L_mm_kernel_go_104
    s_sleep 1
    s_cmp_lt_u32 s64, 0x1000000
    s_cbranch_scc1 L_mm_kernel_follow_105
L_mm_kernel_go_104:
    s_mov_b32 m0, s73
    s_nop 0
    buffer_load_dwordx4 v8, s[28:31], s69 offen offset:0 sc1 lds
    buffer_load_dwordx4 v8, s[28:31], s69 offen offset:1024 sc1 lds
    buffer_load_dwordx4 v8, s[28:31], s69 offen offset:2048 sc1 lds
    s_cmp_ge_u32 s3, 2
    s_cbranch_scc1 L_mm_kernel_skp_106
    buffer_load_dwordx4 v8, s[28:31], s69 offen offset:3072 sc1 lds
L_mm_kernel_skp_106:
    s_add_u32 s69, s69, 14336
    s_cmp_eq_u32 s69, s79
    s_cselect_b32 s66, 28672, 0
    s_add_u32 s69, s69, s66
    s_add_u32 s73, s73, 14336
    s_cmp_ge_u32 s73, s75
    s_cselect_b32 s66, 57344, 0
    s_sub_u32 s73, s73, s66
    s_waitcnt vmcnt(3)
    s_barrier
    s_lshr_b32 s59, s60, 10
    s_add_u32 s60, s60, 512
    s_cmp_gt_u32 s58, s59
    s_cbranch_scc1 L_mm_kernel_go_108
    s_mov_b32 s64, 0
    s_cmp_lg_u32 s3, 0
    s_cbranch_scc1 L_mm_kernel_follow_109
L_mm_kernel_wait_107:
    s_sleep 6
    buffer_load_dword v17, v16, s[32:35], s56 offen sc1
    s_waitcnt vmcnt(0)
    v_cmp_gt_f32 vcc, 0, v17
    s_add_u32 s64, s64, 1
    s_nop 3
    s_ff1_i32_b64 s58, vcc
    v_mov_b32 v17, s58
    ds_write_b32 v18, v17
    s_cmp_gt_u32 s58, s59
    s_cbranch_scc1 L_mm_kernel_go_108
    s_cmp_lt_u32 s64, 0x100000
    s_cbranch_scc1 L_mm_kernel_wait_107
    s_branch L_mm_kernel_go_108
L_mm_kernel_follow_109:
    ds_read_b32 v17, v18
    s_add_u32 s64, s64, 1
    s_waitcnt lgkmcnt(0)
    v_readfirstlane_b32 s58, v17
    s_nop 3
    s_cmp_gt_u32 s58, s59
    s_cbranch_scc1 L_mm_kernel_go_108
    s_sleep 1
    s_cmp_lt_u32 s64, 0x1000000
    s_cbranch_scc1 L_mm_kernel_follow_109
L_mm_kernel_go_108:
    s_mov_b32 m0, s72
    s_nop 0
    buffer_load_dwordx4 v10, s[24:27], s68 offen offset:0 lds
    buffer_load_dwordx4 v11, s[24:27], s68 offen offset:1024 lds
    buffer_load_dwordx4 v12, s[24:27], s68 offen offset:2048 lds
    buffer_load_dwordx4 v13, s[24:27], s68 offen offset:3072 lds
    s_add_u32 s68, s68, 128
    s_cmp_eq_u32 s68, s78
    s_cselect_b32 s66, 256, 0
    s_add_u32 s68, s68, s66
    s_add_u32 s72, s72, 16384
    s_cmp_ge_u32 s72, s74
    s_cselect_b32 s66, 65536, 0
    s_sub_u32 s72, s72, s66
    s_mov_b32 m0, s73
    s_nop 0
    buffer_load_dwordx4 v8, s[28:31], s69 offen offset:0 sc1 lds
    buffer_load_dwordx4 v8, s[28:31], s69 offen offset:1024 sc1 lds
    buffer_load_dwordx4 v8, s[28:31], s69 offen offset:2048 sc1 lds
    s_cmp_ge_u32 s3, 2
    s_cbranch_scc1 L_mm_kernel_skp_110
    buffer_load_dwordx4 v8, s[28:31], s69 offen offset:3072 sc1 lds
L_mm_kernel_skp_110:
    s_add_u32 s69, s69, 14336
    s_cmp_eq_u32 s69, s79
    s_cselect_b32 s66, 28672, 0
    s_add_u32 s69, s69, s66
    s_add_u32 s73, s73, 14336
    s_cmp_ge_u32 s73, s75
    s_cselect_b32 s66, 57344, 0
    s_sub_u32 s73, s73, s66
    s_lshr_b32 s59, s60, 10
    s_add_u32 s60, s60, 512
    s_cmp_gt_u32 s58, s59
    s_cbranch_scc1 L_mm_kernel_go_112
    s_mov_b32 s64, 0
    s_cmp_lg_u32 s3, 0
    s_cbranch_scc1 L_mm_kernel_follow_113
L_mm_kernel_wait_111:
    s_sleep 6
    buffer_load_dword v17, v16, s[32:35], s56 offen sc1
    s_waitcnt vmcnt(0)
    v_cmp_gt_f32 vcc, 0, v17
    s_add_u32 s64, s64, 1
    s_nop 3
    s_ff1_i32_b64 s58, vcc
    v_mov_b32 v17, s58
    ds_write_b32 v18, v17
    s_cmp_gt_u32 s58, s59
    s_cbranch_scc1 L_mm_kernel_go_112
    s_cmp_lt_u32 s64, 0x100000
    s_cbranch_scc1 L_mm_kernel_wait_111
    s_branch L_mm_kernel_go_112
L_mm_kernel_follow_113:
    ds_read_b32 v17, v18
    s_add_u32 s64, s64, 1
    s_waitcnt lgkmcnt(0)
    v_readfirstlane_b32 s58, v17
    s_nop 3
    s_cmp_gt_u32 s58, s59
    s_cbranch_scc1 L_mm_kernel_go_112
    s_sleep 1
    s_cmp_lt_u32 s64, 0x1000000
    s_cbranch_scc1 L_mm_kernel_follow_113
L_mm_kernel_go_112:
    s_mov_b32 m0, s72
    s_nop 0
    buffer_load_dwordx4 v10, s[24:27], s68 offen offset:0 lds
    buffer_load_dwordx4 v11, s[24:27], s68 offen offset:1024 lds
    buffer_load_dwordx4 v12, s[24:27], s68 offen offset:2048 lds
    buffer_load_dwordx4 v13, s[24:27], s68 offen offset:3072 lds
    s_add_u32 s68, s68, 128
    s_cmp_eq_u32 s68, s78
    s_cselect_b32 s66, 256, 0
    s_add_u32 s68, s68, s66
    s_add_u32 s72, s72, 16384
    s_cmp_ge_u32 s72, s74
    s_cselect_b32 s66, 65536, 0
    s_sub_u32 s72, s72, s66
    s_mov_b32 m0, s73
    s_nop 0
    buffer_load_dwordx4 v8, s[28:31], s69 offen offset:0 sc1 lds
    buffer_load_dwordx4 v8, s[28:31], s69 offen offset:1024 sc1 lds
    buffer_load_dwordx4 v8, s[28:31], s69 offen offset:2048 sc1 lds
    s_cmp_ge_u32 s3, 2
    s_cbranch_scc1 L_mm_kernel_skp_114
    buffer_load_dwordx4 v8, s[28:31], s69 offen offset:3072 sc1 lds
L_mm_kernel_skp_114:
    s_add_u32 s69, s69, 14336
    s_cmp_eq_u32 s69, s79
    s_cselect_b32 s66, 28672, 0
    s_add_u32 s69, s69, s66
    s_add_u32 s73, s73, 14336
    s_cmp_ge_u32 s73, s75
    s_cselect_b32 s66, 57344, 0
    s_sub_u32 s73, s73, s66
    s_waitcnt vmcnt(14)
    s_barrier
    s_lshr_b32 s59, s60, 10
    s_add_u32 s60, s60, 512
    s_cmp_gt_u32 s58, s59
    s_cbranch_scc1 L_mm_kernel_go_116
    s_mov_b32 s64, 0
    s_cmp_lg_u32 s3, 0
    s_cbranch_scc1 L_mm_kernel_follow_117
L_mm_kernel_wait_115:
    s_sleep 6
    buffer_load_dword v17, v16, s[32:35], s56 offen sc1
    s_waitcnt vmcnt(0)
    v_cmp_gt_f32 vcc, 0, v17
    s_add_u32 s64, s64, 1
    s_nop 3
    s_ff1_i32_b64 s58, vcc
    v_mov_b32 v17, s58
    ds_write_b32 v18, v17
    s_cmp_gt_u32 s58, s59
    s_cbranch_scc1 L_mm_kernel_go_116
    s_cmp_lt_u32 s64, 0x100000
    s_cbranch_scc1 L_mm_kernel_wait_115
    s_branch L_mm_kernel_go_116
L_mm_kernel_follow_117:
    ds_read_b32 v17, v18
    s_add_u32 s64, s64, 1
    s_waitcnt lgkmcnt(0)
    v_readfirstlane_b32 s58, v17
    s_nop 3
    s_cmp_gt_u32 s58, s59
    s_cbranch_scc1 L_mm_kernel_go_116
    s_sleep 1
    s_cmp_lt_u32 s64, 0x1000000
    s_cbranch_scc1 L_mm_kernel_follow_117
L_mm_kernel_go_116:
    s_mov_b32 m0, s72
    s_nop 0
    buffer_load_dwordx4 v10, s[24:27], s68 offen offset:0 lds
    buffer_load_dwordx4 v11, s[24:27], s68 offen offset:1024 lds
    buffer_load_dwordx4 v12, s[24:27], s68 offen offset:2048 lds
    buffer_load_dwordx4 v13, s[24:27], s68 offen offset:3072 lds
    s_add_u32 s68, s68, 128
    s_cmp_eq_u32 s68, s78
    s_cselect_b32 s66, 256, 0
    s_add_u32 s68, s68, s66
    s_add_u32 s72, s72, 16384
    s_cmp_ge_u32 s72, s74
    s_cselect_b32 s66, 65536, 0
    s_sub_u32 s72, s72, s66
    s_mov_b32 m0, s73
    s_nop 0
    buffer_load_dwordx4 v8, s[28:31], s69 offen offset:0 sc1 lds
    buffer_load_dwordx4 v8, s[28:31], s69 offen offset:1024 sc1 lds
    buffer_load_dwordx4 v8, s[28:31], s69 offen offset:2048 sc1 lds
    s_cmp_ge_u32 s3, 2
    s_cbranch_scc1 L_mm_kernel_skp_118
    buffer_load_dwordx4 v8, s[28:31], s69 offen offset:3072 sc1 lds
L_mm_kernel_skp_118:
    s_add_u32 s69, s69, 14336
    s_cmp_eq_u32 s69, s79
    s_cselect_b32 s66, 28672, 0
    s_add_u32 s69, s69, s66
    s_add_u32 s73, s73, 14336
    s_cmp_ge_u32 s73, s75
    s_cselect_b32 s66, 57344, 0
    s_sub_u32 s73, s73, s66
    s_waitcnt vmcnt(14)
    s_barrier
    s_mov_b32 s77, 4
L_mm_kernel_ploop_119:
    s_lshr_b32 s59, s60, 10
    s_add_u32 s60, s60, 512
    s_cmp_gt_u32 s58, s59
    s_cbranch_scc1 L_mm_kernel_go_121
    s_mov_b32 s64, 0
    s_cmp_lg_u32 s3, 0
    s_cbranch_scc1 L_mm_kernel_follow_122
L_mm_kernel_wait_120:
    s_sleep 6
    buffer_load_dword v17, v16, s[32:35], s56 offen sc1
    s_waitcnt vmcnt(0)
    v_cmp_gt_f32 vcc, 0, v17
    s_add_u32 s64, s64, 1
    s_nop 3
    s_ff1_i32_b64 s58, vcc
    v_mov_b32 v17, s58
    ds_write_b32 v18, v17
    s_cmp_gt_u32 s58, s59
    s_cbranch_scc1 L_mm_kernel_go_121
    s_cmp_lt_u32 s64, 0x100000
    s_cbranch_scc1 L_mm_kernel_wait_120
    s_branch L_mm_kernel_go_121
L_mm_kernel_follow_122:
    ds_read_b32 v17, v18
    s_add_u32 s64, s64, 1
    s_waitcnt lgkmcnt(0)
    v_readfirstlane_b32 s58, v17
    s_nop 3
    s_cmp_gt_u32 s58, s59
    s_cbranch_scc1 L_mm_kernel_go_121
    s_sleep 1
    s_cmp_lt_u32 s64, 0x1000000
    s_cbranch_scc1 L_mm_kernel_follow_122
L_mm_kernel_go_121:
    s_mov_b32 m0, s72
    s_nop 0
    buffer_load_dwordx4 v10, s[24:27], s68 offen offset:0 lds
    buffer_load_dwordx4 v11, s[24:27], s68 offen offset:1024 lds
    buffer_load_dwordx4 v12, s[24:27], s68 offen offset:2048 lds
    buffer_load_dwordx4 v13, s[24:27], s68 offen offset:3072 lds
    s_add_u32 s68, s68, 128
    s_cmp_eq_u32 s68, s78
    s_cselect_b32 s66, 256, 0
    s_add_u32 s68, s68, s66
    s_add_u32 s72, s72, 16384
    s_cmp_ge_u32 s72, s74
    s_cselect_b32 s66, 65536, 0
    s_sub_u32 s72, s72, s66
    s_mov_b32 m0, s73
    s_nop 0
    buffer_load_dwordx4 v8, s[28:31], s69 offen offset:0 sc1 lds
    buffer_load_dwordx4 v8, s[28:31], s69 offen offset:1024 sc1 lds
    buffer_load_dwordx4 v8, s[28:31], s69 offen offset:2048 sc1 lds
    s_cmp_ge_u32 s3, 2
    s_cbranch_scc1 L_mm_kernel_skp_123
    buffer_load_dwordx4 v8, s[28:31], s69 offen offset:3072 sc1 lds
L_mm_kernel_skp_123:
    s_add_u32 s69, s69, 14336
    s_cmp_eq_u32 s69, s79
    s_cselect_b32 s66, 28672, 0
    s_add_u32 s69, s69, s66
    s_add_u32 s73, s73, 14336
    s_cmp_ge_u32 s73, s75
    s_cselect_b32 s66, 57344, 0
    s_sub_u32 s73, s73, s66
    s_add_u32 s77, s77, 1
    s_cmp_lt_u32 s77, 29
    s_waitcnt vmcnt(14)
    s_barrier
    s_cbranch_scc1 L_mm_kernel_ploop_119
    s_waitcnt vmcnt(7)
    s_barrier
    s_waitcnt vmcnt(0)
    s_barrier
    s_barrier
    s_lshl_b32 s50, s3, 11
    v_lshl_add_u32 v8, v1, 4, s50
    s_mul_i32 s80, s21, 229376
    s_mul_i32 s81, s20, 458752
    s_mov_b32 s82, 0
    s_lshl_b32 s50, s3, 12
    v_lshl_add_u32 v5, v1, 4, s50
    s_mov_b32 s68, s82
    s_mul_i32 s72, s3, 4096
    s_add_u32 s72, s72, 0
    s_add_u32 s74, s72, 81920
    s_mov_b32 s69, s82
    s_mul_i32 s73, s3, 2048
    s_add_u32 s73, s73, 81920
    s_add_u32 s75, s73, 40960
    s_add_u32 s26, s81, 40894464
    s_add_u32 s24, s6, s26
    s_addc_u32 s25, s7, 0
    s_mov_b32 s26, 458752
    s_mov_b32 s27, 0x20000
    s_add_u32 s30, s80, 60817408
    s_add_u32 s28, s6, s30
    s_addc_u32 s29, s7, 0
    s_mov_b32 s30, 229376
    s_mov_b32 s31, 0x20000
    s_mov_b32 m0, s73
    s_nop 0
    buffer_load_dwordx4 v8, s[28:31], s69 offen offset:0 sc1 lds
    buffer_load_dwordx4 v8, s[28:31], s69 offen offset:1024 sc1 lds
    s_add_u32 s69, s69, 8192
    s_add_u32 s73, s73, 8192
    s_cmp_ge_u32 s73, s75
    s_cselect_b32 s66, 40960, 0
    s_sub_u32 s73, s73, s66
    s_mov_b32 m0, s73
    s_nop 0
    buffer_load_dwordx4 v8, s[28:31], s69 offen offset:0 sc1 lds
    buffer_load_dwordx4 v8, s[28:31], s69 offen offset:1024 sc1 lds
    s_add_u32 s69, s69, 8192
    s_add_u32 s73, s73, 8192
    s_cmp_ge_u32 s73, s75
    s_cselect_b32 s66, 40960, 0
    s_sub_u32 s73, s73, s66
    s_mov_b32 m0, s73
    s_nop 0
    buffer_load_dwordx4 v8, s[28:31], s69 offen offset:0 sc1 lds
    buffer_load_dwordx4 v8, s[28:31], s69 offen offset:1024 sc1 lds
    s_add_u32 s69, s69, 8192
    s_add_u32 s73, s73, 8192
    s_cmp_ge_u32 s73, s75
    s_cselect_b32 s66, 40960, 0
    s_sub_u32 s73, s73, s66
    s_mov_b32 m0, s73
    s_nop 0
    buffer_load_dwordx4 v8, s[28:31], s69 offen offset:0 sc1 lds
    buffer_load_dwordx4 v8, s[28:31], s69 offen offset:1024 sc1 lds
    s_add_u32 s69, s69, 8192
    s_add_u32 s73, s73, 8192
    s_cmp_ge_u32 s73, s75
    s_cselect_b32 s66, 40960, 0
    s_sub_u32 s73, s73, s66
    s_add_u32 s32, s6, 57147392
    s_addc_u32 s33, s7, 0
    s_mov_b32 s34, 327680
    s_mov_b32 s35, 0x20000
    s_lshl_b32 s56, s20, 11
    s_add_u32 s56, s56, 65536
    v_min_u32 v16, 15, v1
    v_lshlrev_b32 v16, 7, v16
    s_mov_b32 s58, 0
    s_mov_b32 s60, 441
    v_mov_b32 v18, 163712
    v_mov_b32 v17, 0
    ds_write_b32 v18, v17
    s_waitcnt lgkmcnt(0)
    s_barrier
    s_lshr_b32 s59, s60, 10
    s_add_u32 s60, s60, 588
    s_cmp_gt_u32 s58, s59
    s_cbranch_scc1 L_mm_kernel_go_125
    s_mov_b32 s64, 0
    s_cmp_lg_u32 s3, 0
    s_cbranch_scc1 L_mm_kernel_follow_126
L_mm_kernel_wait_124:
    s_sleep 6
    buffer_load_dword v17, v16, s[32:35], s56 offen sc1
    s_waitcnt vmcnt(0)
    v_cmp_gt_f32 vcc, 0, v17
    s_add_u32 s64, s64, 1
    s_nop 3
    s_ff1_i32_b64 s58, vcc
    v_mov_b32 v17, s58
    ds_write_b32 v18, v17
    s_cmp_gt_u32 s58, s59
    s_cbranch_scc1 L_mm_kernel_go_125
    s_cmp_lt_u32 s64, 0x100000
    s_cbranch_scc1 L_mm_kernel_wait_124
    s_branch L_mm_kernel_go_125
L_mm_kernel_follow_126:
    ds_read_b32 v17, v18
    s_add_u32 s64, s64, 1
    s_waitcnt lgkmcnt(0)
    v_readfirstlane_b32 s58, v17
    s_nop 3
    s_cmp_gt_u32 s58, s59
    s_cbranch_scc1 L_mm_kernel_go_125
    s_sleep 1
    s_cmp_lt_u32 s64, 0x1000000
    s_cbranch_scc1 L_mm_kernel_follow_126
L_mm_kernel_go_125:
    s_mov_b32 m0, s72
    s_nop 0
    buffer_load_dwordx4 v5, s[24:27], s68 offen offset:0 sc1 lds
    buffer_load_dwordx4 v5, s[24:27], s68 offen offset:1024 sc1 lds
    buffer_load_dwordx4 v5, s[24:27], s68 offen offset:2048 sc1 lds
    buffer_load_dwordx4 v5, s[24:27], s68 offen offset:3072 sc1 lds
    s_add_u32 s68, s68, 16384
    s_add_u32 s72, s72, 16384
    s_cmp_ge_u32 s72, s74
    s_cselect_b32 s66, 81920, 0
    s_sub_u32 s72, s72, s66
    s_lshr_b32 s59, s60, 10
    s_add_u32 s60, s60, 588
    s_cmp_gt_u32 s58, s59
    s_cbranch_scc1 L_mm_kernel_go_128
    s_mov_b32 s64, 0
    s_cmp_lg_u32 s3, 0
    s_cbranch_scc1 L_mm_kernel_follow_129
L_mm_kernel_wait_127:
    s_sleep 6
    buffer_load_dword v17, v16, s[32:35], s56 offen sc1
    s_waitcnt vmcnt(0)
    v_cmp_gt_f32 vcc, 0, v17
    s_add_u32 s64, s64, 1
    s_nop 3
    s_ff1_i32_b64 s58, vcc
    v_mov_b32 v17, s58
    ds_write_b32 v18, v17
    s_cmp_gt_u32 s58, s59
    s_cbranch_scc1 L_mm_kernel_go_128
    s_cmp_lt_u32 s64, 0x100000
    s_cbranch_scc1 L_mm_kernel_wait_127
    s_branch L_mm_kernel_go_128
L_mm_kernel_follow_129:
    ds_read_b32 v17, v18
    s_add_u32 s64, s64, 1
    s_waitcnt lgkmcnt(0)
    v_readfirstlane_b32 s58, v17
    s_nop 3
    s_cmp_gt_u32 s58, s59
    s_cbranch_scc1 L_mm_kernel_go_128
    s_sleep 1
    s_cmp_lt_u32 s64, 0x1000000
    s_cbranch_scc1 L_mm_kernel_follow_129
L_mm_kernel_go_128:
    s_mov_b32 m0, s72
    s_nop 0
    buffer_load_dwordx4 v5, s[24:27], s68 offen offset:0 sc1 lds
    buffer_load_dwordx4 v5, s[24:27], s68 offen offset:1024 sc1 lds
    buffer_load_dwordx4 v5, s[24:27], s68 offen offset:2048 sc1 lds
    buffer_load_dwordx4 v5, s[24:27], s68 offen offset:3072 sc1 lds
    s_add_u32 s68, s68, 16384
    s_add_u32 s72, s72, 16384
    s_cmp_ge_u32 s72, s74
    s_cselect_b32 s66, 81920, 0
    s_sub_u32 s72, s72, s66
    s_lshr_b32 s59, s60, 10
    s_add_u32 s60, s60, 588
    s_cmp_gt_u32 s58, s59
    s_cbranch_scc1 L_mm_kernel_go_131
    s_mov_b32 s64, 0
    s_cmp_lg_u32 s3, 0
    s_cbranch_scc1 L_mm_kernel_follow_132
L_mm_kernel_wait_130:
    s_sleep 6
    buffer_load_dword v17, v16, s[32:35], s56 offen sc1
    s_waitcnt vmcnt(0)
    v_cmp_gt_f32 vcc, 0, v17
    s_add_u32 s64, s64, 1
    s_nop 3
    s_ff1_i32_b64 s58, vcc
    v_mov_b32 v17, s58
    ds_write_b32 v18, v17
    s_cmp_gt_u32 s58, s59
    s_cbranch_scc1 L_mm_kernel_go_131
    s_cmp_lt_u32 s64, 0x100000
    s_cbranch_scc1 L_mm_kernel_wait_130
    s_branch L_mm_kernel_go_131
L_mm_kernel_follow_132:
    ds_read_b32 v17, v18
    s_add_u32 s64, s64, 1
    s_waitcnt lgkmcnt(0)
    v_readfirstlane_b32 s58, v17
    s_nop 3
    s_cmp_gt_u32 s58, s59
    s_cbranch_scc1 L_mm_kernel_go_131
    s_sleep 1
    s_cmp_lt_u32 s64, 0x1000000
    s_cbranch_scc1 L_mm_kernel_follow_132
L_mm_kernel_go_131:
    s_mov_b32 m0, s72
    s_nop 0
    buffer_load_dwordx4 v5, s[24:27], s68 offen offset:0 sc1 lds
    buffer_load_dwordx4 v5, s[24:27], s68 offen offset:1024 sc1 lds
    buffer_load_dwordx4 v5, s[24:27], s68 offen offset:2048 sc1 lds
    buffer_load_dwordx4 v5, s[24:27], s68 offen offset:3072 sc1 lds
    s_add_u32 s68, s68, 16384
    s_add_u32 s72, s72, 16384
    s_cmp_ge_u32 s72, s74
    s_cselect_b32 s66, 81920, 0
    s_sub_u32 s72, s72, s66
    s_lshr_b32 s59, s60, 10
    s_add_u32 s60, s60, 588
    s_cmp_gt_u32 s58, s59
    s_cbranch_scc1 L_mm_kernel_go_134
    s_mov_b32 s64, 0
    s_cmp_lg_u32 s3, 0
    s_cbranch_scc1 L_mm_kernel_follow_135
L_mm_kernel_wait_133:
    s_sleep 6
    buffer_load_dword v17, v16, s[32:35], s56 offen sc1
    s_waitcnt vmcnt(0)
    v_cmp_gt_f32 vcc, 0, v17
    s_add_u32 s64, s64, 1
    s_nop 3
    s_ff1_i32_b64 s58, vcc
    v_mov_b32 v17, s58
    ds_write_b32 v18, v17
    s_cmp_gt_u32 s58, s59
    s_cbranch_scc1 L_mm_kernel_go_134
    s_cmp_lt_u32 s64, 0x100000
    s_cbranch_scc1 L_mm_kernel_wait_133
    s_branch L_mm_kernel_go_134
L_mm_kernel_follow_135:
    ds_read_b32 v17, v18
    s_add_u32 s64, s64, 1
    s_waitcnt lgkmcnt(0)
    v_readfirstlane_b32 s58, v17
    s_nop 3
    s_cmp_gt_u32 s58, s59
    s_cbranch_scc1 L_mm_kernel_go_134
    s_sleep 1
    s_cmp_lt_u32 s64, 0x1000000
    s_cbranch_scc1 L_mm_kernel_follow_135
L_mm_kernel_go_134:
    s_mov_b32 m0, s72
    s_nop 0
    buffer_load_dwordx4 v5, s[24:27], s68 offen offset:0 sc1 lds
    buffer_load_dwordx4 v5, s[24:27], s68 offen offset:1024 sc1 lds
    buffer_load_dwordx4 v5, s[24:27], s68 offen offset:2048 sc1 lds
    buffer_load_dwordx4 v5, s[24:27], s68 offen offset:3072 sc1 lds
    s_add_u32 s68, s68, 16384
    s_add_u32 s72, s72, 16384
    s_cmp_ge_u32 s72, s74
    s_cselect_b32 s66, 81920, 0
    s_sub_u32 s72, s72, s66
    s_waitcnt vmcnt(12)
    s_barrier
    s_lshr_b32 s59, s60, 10
    s_add_u32 s60, s60, 588
    s_cmp_gt_u32 s58, s59
    s_cbranch_scc1 L_mm_kernel_go_137
    s_mov_b32 s64, 0
    s_cmp_lg_u32 s3, 0
    s_cbranch_scc1 L_mm_kernel_follow_138
L_mm_kernel_wait_136:
    s_sleep 6
    buffer_load_dword v17, v16, s[32:35], s56 offen sc1
    s_waitcnt vmcnt(0)
    v_cmp_gt_f32 vcc, 0, v17
    s_add_u32 s64, s64, 1
    s_nop 3
    s_ff1_i32_b64 s58, vcc
    v_mov_b32 v17, s58
    ds_write_b32 v18, v17
    s_cmp_gt_u32 s58, s59
    s_cbranch_scc1 L_mm_kernel_go_137
    s_cmp_lt_u32 s64, 0x100000
    s_cbranch_scc1 L_mm_kernel_wait_136
    s_branch L_mm_kernel_go_137
L_mm_kernel_follow_138:
    ds_read_b32 v17, v18
    s_add_u32 s64, s64, 1
    s_waitcnt lgkmcnt(0)
    v_readfirstlane_b32 s58, v17
    s_nop 3
    s_cmp_gt_u32 s58, s59
    s_cbranch_scc1 L_mm_kernel_go_137
    s_sleep 1
    s_cmp_lt_u32 s64, 0x1000000
    s_cbranch_scc1 L_mm_kernel_follow_138
L_mm_kernel_go_137:
    s_mov_b32 m0, s72
    s_nop 0
    buffer_load_dwordx4 v5, s[24:27], s68 offen offset:0 sc1 lds
    buffer_load_dwordx4 v5, s[24:27], s68 offen offset:1024 sc1 lds
    buffer_load_dwordx4 v5, s[24:27], s68 offen offset:2048 sc1 lds
    buffer_load_dwordx4 v5, s[24:27], s68 offen offset:3072 sc1 lds
    s_add_u32 s68, s68, 16384
    s_add_u32 s72, s72, 16384
    s_cmp_ge_u32 s72, s74
    s_cselect_b32 s66, 81920, 0
    s_sub_u32 s72, s72, s66
    s_mov_b32 m0, s73
    s_nop 0
    buffer_load_dwordx4 v8, s[28:31], s69 offen offset:0 sc1 lds
    buffer_load_dwordx4 v8, s[28:31], s69 offen offset:1024 sc1 lds
    s_add_u32 s69, s69, 8192
    s_add_u32 s73, s73, 8192
    s_cmp_ge_u32 s73, s75
    s_cselect_b32 s66, 40960, 0
    s_sub_u32 s73, s73, s66
    s_waitcnt vmcnt(14)
    s_barrier
    s_lshr_b32 s59, s60, 10
    s_add_u32 s60, s60, 588
    s_cmp_gt_u32 s58, s59
    s_cbranch_scc1 L_mm_kernel_go_140
    s_mov_b32 s64, 0
    s_cmp_lg_u32 s3, 0
    s_cbranch_scc1 L_mm_kernel_follow_141
L_mm_kernel_wait_139:
    s_sleep 6
    buffer_load_dword v17, v16, s[32:35], s56 offen sc1
    s_waitcnt vmcnt(0)
    v_cmp_gt_f32 vcc, 0, v17
    s_add_u32 s64, s64, 1
    s_nop 3
    s_ff1_i32_b64 s58, vcc
    v_mov_b32 v17, s58
    ds_write_b32 v18, v17
    s_cmp_gt_u32 s58, s59
    s_cbranch_scc1 L_mm_kernel_go_140
    s_cmp_lt_u32 s64, 0x100000
    s_cbranch_scc1 L_mm_kernel_wait_139
    s_branch L_mm_kernel_go_140
L_mm_kernel_follow_141:
    ds_read_b32 v17, v18
    s_add_u32 s64, s64, 1
    s_waitcnt lgkmcnt(0)
    v_readfirstlane_b32 s58, v17
    s_nop 3
    s_cmp_gt_u32 s58, s59
    s_cbranch_scc1 L_mm_kernel_go_140
    s_sleep 1
    s_cmp_lt_u32 s64, 0x1000000
    s_cbranch_scc1 L_mm_kernel_follow_141
L_mm_kernel_go_140:
    s_mov_b32 m0, s72
    s_nop 0
    buffer_load_dwordx4 v5, s[24:27], s68 offen offset:0 sc1 lds
    buffer_load_dwordx4 v5, s[24:27], s68 offen offset:1024 sc1 lds
    buffer_load_dwordx4 v5, s[24:27], s68 offen offset:2048 sc1 lds
    buffer_load_dwordx4 v5, s[24:27], s68 offen offset:3072 sc1 lds
    s_add_u32 s68, s68, 16384
    s_add_u32 s72, s72, 16384
    s_cmp_ge_u32 s72, s74
    s_cselect_b32 s66, 81920, 0
    s_sub_u32 s72, s72, s66
    s_mov_b32 m0, s73
    s_nop 0
    buffer_load_dwordx4 v8, s[28:31], s69 offen offset:0 sc1 lds
    buffer_load_dwordx4 v8, s[28:31], s69 offen offset:1024 sc1 lds
    s_add_u32 s69, s69, 8192
    s_add_u32 s73, s73, 8192
    s_cmp_ge_u32 s73, s75
    s_cselect_b32 s66, 40960, 0
    s_sub_u32 s73, s73, s66
    s_waitcnt vmcnt(16)
    s_barrier
    s_mov_b32 s77, 2
L_mm_kernel_ploop_142:
    s_lshr_b32 s59, s60, 10
    s_add_u32 s60, s60, 588
    s_cmp_gt_u32 s58, s59
    s_cbranch_scc1 L_mm_kernel_go_144
    s_mov_b32 s64, 0
    s_cmp_lg_u32 s3, 0
    s_cbranch_scc1 L_mm_kernel_follow_145
L_mm_kernel_wait_143:
    s_sleep 6
    buffer_load_dword v17, v16, s[32:35], s56 offen sc1
    s_waitcnt vmcnt(0)
    v_cmp_gt_f32 vcc, 0, v17
    s_add_u32 s64, s64, 1
    s_nop 3
    s_ff1_i32_b64 s58, vcc
    v_mov_b32 v17, s58
    ds_write_b32 v18, v17
    s_cmp_gt_u32 s58, s59
    s_cbranch_scc1 L_mm_kernel_go_144
    s_cmp_lt_u32 s64, 0x100000
    s_cbranch_scc1 L_mm_kernel_wait_143
    s_branch L_mm_kernel_go_144
L_mm_kernel_follow_145:
    ds_read_b32 v17, v18
    s_add_u32 s64, s64, 1
    s_waitcnt lgkmcnt(0)
    v_readfirstlane_b32 s58, v17
    s_nop 3
    s_cmp_gt_u32 s58, s59
    s_cbranch_scc1 L_mm_kernel_go_144
    s_sleep 1
    s_cmp_lt_u32 s64, 0x1000000
    s_cbranch_scc1 L_mm_kernel_follow_145
L_mm_kernel_go_144:
    s_mov_b32 m0, s72
    s_nop 0
    buffer_load_dwordx4 v5, s[24:27], s68 offen offset:0 sc1 lds
    buffer_load_dwordx4 v5, s[24:27], s68 offen offset:1024 sc1 lds
    buffer_load_dwordx4 v5, s[24:27], s68 offen offset:2048 sc1 lds
    buffer_load_dwordx4 v5, s[24:27], s68 offen offset:3072 sc1 lds
    s_add_u32 s68, s68, 16384
    s_add_u32 s72, s72, 16384
    s_cmp_ge_u32 s72, s74
    s_cselect_b32 s66, 81920, 0
    s_sub_u32 s72, s72, s66
    s_mov_b32 m0, s73
    s_nop 0
    buffer_load_dwordx4 v8, s[28:31], s69 offen offset:0 sc1 lds
    buffer_load_dwordx4 v8, s[28:31], s69 offen offset:1024 sc1 lds
    s_add_u32 s69, s69, 8192
    s_add_u32 s73, s73, 8192
    s_cmp_ge_u32 s73, s75
    s_cselect_b32 s66, 40960, 0
    s_sub_u32 s73, s73, s66
    s_add_u32 s77, s77, 1
    s_cmp_lt_u32 s77, 24
    s_waitcnt vmcnt(18)
    s_barrier
    s_cbranch_scc1 L_mm_kernel_ploop_142
    s_waitcnt vmcnt(12)
    s_barrier
    s_waitcnt vmcnt(6)
    s_barrier
    s_waitcnt vmcnt(0)
    s_barrier
    s_barrier
    s_endpgm
L_mm_kernel_end_1:
    s_endpgm
L_mm_kernel_codeend:
.section .rodata,"a"
.p2align 6
.amdhsa_kernel mm_kernel
  .amdhsa_next_free_vgpr 228
  .amdhsa_next_free_sgpr 102
  .amdhsa_accum_offset 228
  .amdhsa_group_segment_fixed_size 0
  .amdhsa_kernarg_size 104
  .amdhsa_user_sgpr_count 2
  .amdhsa_user_sgpr_kernarg_segment_ptr 1
  .amdhsa_system_sgpr_workgroup_id_x 1
  .amdhsa_float_denorm_mode_32 3
  .amdhsa_float_denorm_mode_16_64 3
.end_amdhsa_kernel
```
